```python
import torch

def _softmax(x, axis=-1):
    return torch.softmax(x, dim=axis)
def _gelu(x):
    return torch.nn.functional.gelu(x, approximate="tanh")
def _silu(x):
    return torch.nn.functional.silu(x)
def _sigmoid(x):
    return torch.sigmoid(x)
def _layernorm(x, axis=-1, eps=1e-5):
    m = x.mean(dim=axis, keepdim=True)
    v = x.var(dim=axis, keepdim=True, unbiased=False)
    return (x - m) / torch.sqrt(v + eps)
def _scatter_add(tgt, idx, src, axis=0):
    return tgt.clone().index_add_(axis, idx, src)
def _segment_sum(src, seg, n):
    out = torch.zeros((n,) + src.shape[1:], dtype=src.dtype)
    return out.index_add_(0, seg, src)
def _pad(x, pw):
    flat = tuple(v for pair in reversed(pw) for v in pair)
    return torch.nn.functional.pad(x, flat)

kernel_name = 'parallel_sum__compressed_kv_cla__swiglu_ffn__prompt'

def setup_inputs():

    _w = (lambda a: (lambda t: t.to(torch.bfloat16) if t.is_floating_point() else t)(torch.as_tensor(a)))
    def _A_setup():
        B, H, Sq, Sk, D, M = 1, 32, 2048, 2048, 128, 512
        Dc = 4 * D
        return {
            "x": _w((lambda *s: torch.randn(*s, dtype=torch.bfloat16) * 0.05)(B, Sq, M)),
            "c_kv": _w((lambda *s: torch.randn(*s, dtype=torch.bfloat16) * 1.6)(B, Sk, Dc)),
            "w_q": _w((lambda *s: torch.randn(*s, dtype=torch.bfloat16) * 0.8)(M, H, D) * (M ** -0.5)),
            "w_uk": _w((lambda *s: torch.randn(*s, dtype=torch.bfloat16) * 0.8)(Dc, H, D) * (Dc ** -0.5)),
            "w_uv": _w((lambda *s: torch.randn(*s, dtype=torch.bfloat16) * 1.6)(Dc, H, D) * (Dc ** -0.5)),
            "w_o": _w((lambda *s: torch.randn(*s, dtype=torch.bfloat16) * 1.6)(H, D, M) * ((H * D) ** -0.5)),
        }
    _A_in = _A_setup()

    def _B_setup():
        B, S, D, F = 1, 2048, 512, 1376
        return {
            "x": _w((lambda *s: torch.randn(*s, dtype=torch.bfloat16) * 0.05)(B, S, D)),
            "w_gate": _w((lambda *s: torch.randn(*s, dtype=torch.bfloat16) * 0.05)(D, F)),
            "w_up": _w((lambda *s: torch.randn(*s, dtype=torch.bfloat16) * 0.05)(D, F)),
            "w_down": _w((lambda *s: torch.randn(*s, dtype=torch.bfloat16) * 0.05)(F, D)),
        }
    _B_in = _B_setup()

    return {
        "A_x": _A_in["x"],
        "A_c_kv": _A_in["c_kv"],
        "A_w_q": _A_in["w_q"],
        "A_w_uk": _A_in["w_uk"],
        "A_w_uv": _A_in["w_uv"],
        "A_w_o": _A_in["w_o"],
        "B_x": _B_in["x"],
        "B_w_gate": _B_in["w_gate"],
        "B_w_up": _B_in["w_up"],
        "B_w_down": _B_in["w_down"],
    }

def reference(A_x, A_c_kv, A_w_q, A_w_uk, A_w_uv, A_w_o, B_x, B_w_gate, B_w_up, B_w_down):
    def _A_ref(x, c_kv, w_q, w_uk, w_uv, w_o):
        B, Sq, M = x.shape[0], x.shape[1], x.shape[2]
        Sk = c_kv.shape[1]
        H, D = w_q.shape[1], w_q.shape[2]
        q = torch.einsum("bqm,mhd->bhqd", x, w_q)
        k = torch.einsum("bkc,chd->bhkd", c_kv, w_uk)
        v = torch.einsum("bkc,chd->bhkd", c_kv, w_uv)
        scores = torch.einsum("bhqd,bhkd->bhqk", q, k) * (D ** -0.5)
        off = Sk - Sq
        qi = torch.arange(Sq)[:, None]
        kj = torch.arange(Sk)[None, :]
        cmask = kj <= (qi + off)
        scores = torch.where(cmask[None, None], scores, -1e9)
        p = _softmax(scores, axis=-1)
        ctx = torch.einsum("bhqk,bhkd->bhqd", p, v)
        return torch.einsum("bhqd,hdm->bqm", ctx, w_o)

    def _B_ref(x, w_gate, w_up, w_down):
        g = _silu(x @ w_gate)
        u = x @ w_up
        return (g * u) @ w_down

    x = A_x
    xn = _layernorm(x, axis=-1)
    return x + _A_ref(xn, A_c_kv, A_w_q, A_w_uk, A_w_uv, A_w_o) + _B_ref(xn, B_w_gate, B_w_up, B_w_down)
```

```asm
; @launch kernel=ln_kernel grid=(256,1,1) block=(256,1,1) lds=0
; @launch kernel=proj_kernel grid=(256,1,1) block=(256,1,1) lds=163840
; @launch kernel=attn_kernel grid=(256,1,1) block=(256,1,1) lds=163840
.amdgcn_target "amdgcn-amd-amdhsa--gfx950"
.text
.globl ln_kernel
.p2align 8
.type ln_kernel,@function
ln_kernel:
    s_cmp_ge_u32 s2, 256
    s_cbranch_scc1 K0_END
    s_load_dwordx2 s[4:5], s[0:1], 0
    s_load_dwordx2 s[6:7], s[0:1], 96
    s_load_dwordx2 s[24:25], s[0:1], 8
    s_load_dwordx2 s[26:27], s[0:1], 24
    s_load_dwordx2 s[28:29], s[0:1], 32
    s_load_dwordx2 s[30:31], s[0:1], 16
    s_load_dwordx4 s[32:35], s[0:1], 56
    v_lshrrev_b32 v3, 6, v0
    v_lshrrev_b32 v1, 6, v0
    v_and_b32 v2, 63, v0
    v_lshlrev_b32 v1, 11, v1
    v_lshl_add_u32 v1, v2, 4, v1
    s_lshl_b32 s3, s2, 13
    s_waitcnt lgkmcnt(0)
    s_mov_b32 s8, s4
    s_and_b32 s9, s5, 0xffff
    s_mov_b32 s10, 2097152
    s_mov_b32 s11, 0x20000
    s_mov_b32 s12, s6
    s_and_b32 s13, s7, 0xffff
    s_mov_b32 s14, 2097152
    s_mov_b32 s15, 0x20000
    buffer_load_dwordx4 v[4:7], v1, s[8:11], s3 offen
    buffer_load_dwordx4 v[8:11], v1, s[8:11], s3 offen offset:1024
    s_lshl_b32 s40, s2, 2
    v_readfirstlane_b32 s41, v3
    s_add_u32 s40, s40, s41
    v_lshlrev_b32 v60, 6, v2
    s_mov_b32 s44, s24
    s_and_b32 s45, s25, 0xffff
    s_mov_b32 s46, 2097152
    s_mov_b32 s47, 0x20000
    s_lshl_b32 s42, s40, 11
    v_and_b32 v62, 0x7ff, v60
    buffer_load_dword v54, v62, s[44:47], s42 offen
    s_mov_b32 s44, s26
    s_and_b32 s45, s27, 0xffff
    s_mov_b32 s46, 4194304
    s_mov_b32 s47, 0x20000
    s_lshl_b32 s42, s40, 12
    buffer_load_dword v55, v60, s[44:47], s42 offen
    s_mov_b32 s44, s28
    s_and_b32 s45, s29, 0xffff
    s_mov_b32 s46, 4194304
    s_mov_b32 s47, 0x20000
    s_lshl_b32 s42, s40, 12
    buffer_load_dword v56, v60, s[44:47], s42 offen
    s_mov_b32 s44, s30
    s_and_b32 s45, s31, 0xffff
    s_mov_b32 s46, 4194304
    s_mov_b32 s47, 0x20000
    s_lshl_b32 s42, s40, 12
    buffer_load_dword v57, v60, s[44:47], s42 offen
    s_mov_b32 s44, s32
    s_and_b32 s45, s33, 0xffff
    s_mov_b32 s46, 1409024
    s_mov_b32 s47, 0x20000
    s_lshl_b32 s42, s40, 11
    v_and_b32 v62, 0x7ff, v60
    buffer_load_dword v58, v62, s[44:47], s42 offen
    s_mov_b32 s44, s34
    s_and_b32 s45, s35, 0xffff
    s_mov_b32 s46, 1409024
    s_mov_b32 s47, 0x20000
    s_lshl_b32 s42, s40, 11
    v_and_b32 v62, 0x7ff, v60
    buffer_load_dword v59, v62, s[44:47], s42 offen
    s_getpc_b64 s[50:51]
K0_PC:
    s_sub_u32 s50, s50, K0_PC-ln_kernel
    s_subb_u32 s51, s51, 0
    s_lshl_b32 s52, s2, 2
    v_readfirstlane_b32 s53, v3
    s_add_u32 s52, s52, s53
    s_lshl_b32 s52, s52, 12
    s_cmp_ge_u32 s52, TEXT_END-ln_kernel
    s_cbranch_scc1 K0_NOCODE
    v_lshlrev_b32 v52, 6, v2
    v_add_u32 v52, s52, v52
    v_min_u32 v52, TEXT_END-ln_kernel-4, v52
    global_load_dword v53, v52, s[50:51]
K0_NOCODE:
    s_waitcnt vmcnt(6)
    v_lshlrev_b32 v16, 16, v4
    v_and_b32 v17, 0xffff0000, v4
    v_lshlrev_b32 v18, 16, v5
    v_and_b32 v19, 0xffff0000, v5
    v_lshlrev_b32 v20, 16, v6
    v_and_b32 v21, 0xffff0000, v6
    v_lshlrev_b32 v22, 16, v7
    v_and_b32 v23, 0xffff0000, v7
    v_lshlrev_b32 v36, 16, v8
    v_and_b32 v37, 0xffff0000, v8
    v_lshlrev_b32 v38, 16, v9
    v_and_b32 v39, 0xffff0000, v9
    v_lshlrev_b32 v40, 16, v10
    v_and_b32 v41, 0xffff0000, v10
    v_lshlrev_b32 v42, 16, v11
    v_and_b32 v43, 0xffff0000, v11
    v_add_f32 v24, v16, v17
    v_add_f32 v24, v24, v18
    v_add_f32 v24, v24, v19
    v_add_f32 v24, v24, v20
    v_add_f32 v24, v24, v21
    v_add_f32 v24, v24, v22
    v_add_f32 v24, v24, v23
    v_add_f32 v44, v36, v37
    v_add_f32 v44, v44, v38
    v_add_f32 v44, v44, v39
    v_add_f32 v44, v44, v40
    v_add_f32 v44, v44, v41
    v_add_f32 v44, v44, v42
    v_add_f32 v44, v44, v43
    s_nop 1
    v_add_f32_dpp v24, v24, v24 row_ror:8 row_mask:0xf bank_mask:0xf
    s_nop 1
    v_add_f32_dpp v44, v44, v44 row_ror:8 row_mask:0xf bank_mask:0xf
    s_nop 1
    v_add_f32_dpp v24, v24, v24 row_ror:4 row_mask:0xf bank_mask:0xf
    s_nop 1
    v_add_f32_dpp v44, v44, v44 row_ror:4 row_mask:0xf bank_mask:0xf
    s_nop 1
    v_add_f32_dpp v24, v24, v24 row_ror:2 row_mask:0xf bank_mask:0xf
    s_nop 1
    v_add_f32_dpp v44, v44, v44 row_ror:2 row_mask:0xf bank_mask:0xf
    s_nop 1
    v_add_f32_dpp v24, v24, v24 row_ror:1 row_mask:0xf bank_mask:0xf
    s_nop 1
    v_add_f32_dpp v44, v44, v44 row_ror:1 row_mask:0xf bank_mask:0xf
    s_nop 1
    v_readlane_b32 s48, v24, 0
    v_readlane_b32 s49, v24, 16
    v_readlane_b32 s50, v24, 32
    v_readlane_b32 s51, v24, 48
    v_readlane_b32 s52, v44, 0
    v_readlane_b32 s53, v44, 16
    v_readlane_b32 s54, v44, 32
    v_readlane_b32 s55, v44, 48
    s_nop 1
    v_mov_b32 v24, s48
    v_add_f32 v24, s49, v24
    v_add_f32 v24, s50, v24
    v_add_f32 v24, s51, v24
    v_mov_b32 v44, s52
    v_add_f32 v44, s53, v44
    v_add_f32 v44, s54, v44
    v_add_f32 v44, s55, v44
    v_mul_f32 v24, 0x3b000000, v24
    v_mul_f32 v44, 0x3b000000, v44
    v_sub_f32 v26, v16, v24
    v_mul_f32 v25, v26, v26
    v_sub_f32 v26, v17, v24
    v_fmac_f32 v25, v26, v26
    v_sub_f32 v26, v18, v24
    v_fmac_f32 v25, v26, v26
    v_sub_f32 v26, v19, v24
    v_fmac_f32 v25, v26, v26
    v_sub_f32 v26, v20, v24
    v_fmac_f32 v25, v26, v26
    v_sub_f32 v26, v21, v24
    v_fmac_f32 v25, v26, v26
    v_sub_f32 v26, v22, v24
    v_fmac_f32 v25, v26, v26
    v_sub_f32 v26, v23, v24
    v_fmac_f32 v25, v26, v26
    v_sub_f32 v46, v36, v44
    v_mul_f32 v45, v46, v46
    v_sub_f32 v46, v37, v44
    v_fmac_f32 v45, v46, v46
    v_sub_f32 v46, v38, v44
    v_fmac_f32 v45, v46, v46
    v_sub_f32 v46, v39, v44
    v_fmac_f32 v45, v46, v46
    v_sub_f32 v46, v40, v44
    v_fmac_f32 v45, v46, v46
    v_sub_f32 v46, v41, v44
    v_fmac_f32 v45, v46, v46
    v_sub_f32 v46, v42, v44
    v_fmac_f32 v45, v46, v46
    v_sub_f32 v46, v43, v44
    v_fmac_f32 v45, v46, v46
    s_nop 1
    v_add_f32_dpp v25, v25, v25 row_ror:8 row_mask:0xf bank_mask:0xf
    s_nop 1
    v_add_f32_dpp v45, v45, v45 row_ror:8 row_mask:0xf bank_mask:0xf
    s_nop 1
    v_add_f32_dpp v25, v25, v25 row_ror:4 row_mask:0xf bank_mask:0xf
    s_nop 1
    v_add_f32_dpp v45, v45, v45 row_ror:4 row_mask:0xf bank_mask:0xf
    s_nop 1
    v_add_f32_dpp v25, v25, v25 row_ror:2 row_mask:0xf bank_mask:0xf
    s_nop 1
    v_add_f32_dpp v45, v45, v45 row_ror:2 row_mask:0xf bank_mask:0xf
    s_nop 1
    v_add_f32_dpp v25, v25, v25 row_ror:1 row_mask:0xf bank_mask:0xf
    s_nop 1
    v_add_f32_dpp v45, v45, v45 row_ror:1 row_mask:0xf bank_mask:0xf
    s_nop 1
    v_readlane_b32 s48, v25, 0
    v_readlane_b32 s49, v25, 16
    v_readlane_b32 s50, v25, 32
    v_readlane_b32 s51, v25, 48
    v_readlane_b32 s52, v45, 0
    v_readlane_b32 s53, v45, 16
    v_readlane_b32 s54, v45, 32
    v_readlane_b32 s55, v45, 48
    s_nop 1
    v_mov_b32 v25, s48
    v_add_f32 v25, s49, v25
    v_add_f32 v25, s50, v25
    v_add_f32 v25, s51, v25
    v_mov_b32 v45, s52
    v_add_f32 v45, s53, v45
    v_add_f32 v45, s54, v45
    v_add_f32 v45, s55, v45
    v_mul_f32 v25, 0x3b000000, v25
    v_cvt_pk_bf16_f32 v26, v24, v25
    v_and_b32 v25, 0xffff0000, v26
    v_lshlrev_b32 v24, 16, v26
    v_add_f32 v25, 0x3727c5ac, v25
    v_cvt_pk_bf16_f32 v25, v25, v25
    v_and_b32 v25, 0xffff0000, v25
    v_sqrt_f32 v25, v25
    s_nop 0
    v_cvt_pk_bf16_f32 v25, v25, v25
    v_and_b32 v25, 0xffff0000, v25
    v_rcp_f32 v25, v25
    s_nop 0
    v_sub_f32 v16, v16, v24
    v_sub_f32 v17, v17, v24
    v_cvt_pk_bf16_f32 v26, v16, v17
    v_lshlrev_b32 v16, 16, v26
    v_and_b32 v17, 0xffff0000, v26
    v_mul_f32 v16, v16, v25
    v_mul_f32 v17, v17, v25
    v_cvt_pk_bf16_f32 v4, v16, v17
    v_sub_f32 v18, v18, v24
    v_sub_f32 v19, v19, v24
    v_cvt_pk_bf16_f32 v26, v18, v19
    v_lshlrev_b32 v18, 16, v26
    v_and_b32 v19, 0xffff0000, v26
    v_mul_f32 v18, v18, v25
    v_mul_f32 v19, v19, v25
    v_cvt_pk_bf16_f32 v5, v18, v19
    v_sub_f32 v20, v20, v24
    v_sub_f32 v21, v21, v24
    v_cvt_pk_bf16_f32 v26, v20, v21
    v_lshlrev_b32 v20, 16, v26
    v_and_b32 v21, 0xffff0000, v26
    v_mul_f32 v20, v20, v25
    v_mul_f32 v21, v21, v25
    v_cvt_pk_bf16_f32 v6, v20, v21
    v_sub_f32 v22, v22, v24
    v_sub_f32 v23, v23, v24
    v_cvt_pk_bf16_f32 v26, v22, v23
    v_lshlrev_b32 v22, 16, v26
    v_and_b32 v23, 0xffff0000, v26
    v_mul_f32 v22, v22, v25
    v_mul_f32 v23, v23, v25
    v_cvt_pk_bf16_f32 v7, v22, v23
    v_mul_f32 v45, 0x3b000000, v45
    v_cvt_pk_bf16_f32 v46, v44, v45
    v_and_b32 v45, 0xffff0000, v46
    v_lshlrev_b32 v44, 16, v46
    v_add_f32 v45, 0x3727c5ac, v45
    v_cvt_pk_bf16_f32 v45, v45, v45
    v_and_b32 v45, 0xffff0000, v45
    v_sqrt_f32 v45, v45
    s_nop 0
    v_cvt_pk_bf16_f32 v45, v45, v45
    v_and_b32 v45, 0xffff0000, v45
    v_rcp_f32 v45, v45
    s_nop 0
    v_sub_f32 v36, v36, v44
    v_sub_f32 v37, v37, v44
    v_cvt_pk_bf16_f32 v46, v36, v37
    v_lshlrev_b32 v36, 16, v46
    v_and_b32 v37, 0xffff0000, v46
    v_mul_f32 v36, v36, v45
    v_mul_f32 v37, v37, v45
    v_cvt_pk_bf16_f32 v8, v36, v37
    v_sub_f32 v38, v38, v44
    v_sub_f32 v39, v39, v44
    v_cvt_pk_bf16_f32 v46, v38, v39
    v_lshlrev_b32 v38, 16, v46
    v_and_b32 v39, 0xffff0000, v46
    v_mul_f32 v38, v38, v45
    v_mul_f32 v39, v39, v45
    v_cvt_pk_bf16_f32 v9, v38, v39
    v_sub_f32 v40, v40, v44
    v_sub_f32 v41, v41, v44
    v_cvt_pk_bf16_f32 v46, v40, v41
    v_lshlrev_b32 v40, 16, v46
    v_and_b32 v41, 0xffff0000, v46
    v_mul_f32 v40, v40, v45
    v_mul_f32 v41, v41, v45
    v_cvt_pk_bf16_f32 v10, v40, v41
    v_sub_f32 v42, v42, v44
    v_sub_f32 v43, v43, v44
    v_cvt_pk_bf16_f32 v46, v42, v43
    v_lshlrev_b32 v42, 16, v46
    v_and_b32 v43, 0xffff0000, v46
    v_mul_f32 v42, v42, v45
    v_mul_f32 v43, v43, v45
    v_cvt_pk_bf16_f32 v11, v42, v43
    s_cmp_lt_u32 s2, 64
    s_cbranch_scc0 K0_NOZ
    v_cmp_gt_u32 vcc, 64, v0
    s_and_saveexec_b64 s[56:57], vcc
    s_cbranch_execz K0_NOZ2
    s_lshl_b32 s58, s2, 8
    v_lshl_add_u32 v50, v0, 2, s58
    v_mov_b32 v51, 0
    s_add_u32 s58, s6, 0x7000000
    s_addc_u32 s59, s7, 0
    global_store_dword v50, v51, s[58:59]
K0_NOZ2:
    s_mov_b64 exec, s[56:57]
K0_NOZ:
    buffer_store_dwordx4 v[4:7], v1, s[12:15], s3 offen
    buffer_store_dwordx4 v[8:11], v1, s[12:15], s3 offen offset:1024
K0_END:
    s_endpgm
.globl proj_kernel
.p2align 8
.type proj_kernel,@function
proj_kernel:
    s_cmp_ge_u32 s2, 256
    s_cbranch_scc1 K1_END
    s_load_dwordx4 s[36:39], s[0:1], 0
    s_load_dwordx4 s[40:43], s[0:1], 16
    s_load_dwordx2 s[44:45], s[0:1], 32
    s_load_dwordx4 s[48:51], s[0:1], 56
    s_load_dwordx2 s[52:53], s[0:1], 96
    s_load_dwordx2 s[34:35], s[0:1], 88
    v_lshrrev_b32 v1, 6, v0
    s_nop 0
    v_readfirstlane_b32 s20, v1
    v_and_b32 v1, 63, v0
    s_and_b32 s54, s2, 7
    s_lshr_b32 s55, s2, 3
    s_and_b32 s56, s55, 3
    s_lshr_b32 s55, s55, 2
    s_waitcnt lgkmcnt(0)
    s_cmp_ge_u32 s54, 4
    s_cbranch_scc1 K1_XN
    s_lshl_b32 s57, s54, 3
    s_add_u32 s57, s57, s55
    s_mov_b32 s60, s38
    s_mov_b32 s61, s39
    s_cmp_lt_u32 s57, 16
    s_cselect_b32 s21, 0, 1
    s_cselect_b32 s62, s42, s44
    s_cselect_b32 s63, s43, s45
    s_mov_b32 s59, 50331648
    s_cselect_b32 s58, 33554432, s59
    s_and_b32 s57, s57, 15
    s_branch K1_QKV
K1_XN:
    s_cmp_eq_u32 s55, 7
    s_cbranch_scc1 K1_AUX
    s_sub_u32 s57, s54, 4
    s_mul_i32 s57, s57, 7
    s_add_u32 s57, s57, s55
    s_cmp_ge_u32 s57, 27
    s_cbranch_scc1 K1_AUX
    s_add_u32 s60, s52, 0
    s_addc_u32 s61, s53, 0
    s_cmp_ge_u32 s57, 16
    s_cbranch_scc1 K1_GU
    s_mov_b32 s21, 2
    s_mov_b32 s62, s40
    s_mov_b32 s63, s41
    s_mov_b32 s58, 16777216
K1_QKV:
    s_mov_b32 s22, 8192
    s_lshl_b32 s59, s57, 9
    s_lshl_b32 s64, s20, 7
    s_add_u32 s59, s59, s64
    s_add_u32 s8, s62, s59
    s_addc_u32 s9, s63, 0
    s_and_b32 s9, s9, 0xffff
    s_sub_u32 s10, 0x400000, s59
    s_mov_b32 s11, 0x20000
    s_add_u32 s12, s8, 64
    s_addc_u32 s13, s9, 0
    s_sub_u32 s14, s10, 64
    s_mov_b32 s15, 0x20000
    s_lshl_b32 s25, s57, 1
    s_lshr_b32 s64, s20, 1
    s_add_u32 s25, s25, s64
    s_lshl_b32 s25, s25, 19
    s_and_b32 s64, s20, 1
    s_lshl_b32 s64, s64, 12
    s_add_u32 s25, s25, s64
    s_lshl_b32 s64, s56, 17
    s_add_u32 s25, s25, s64
    s_mov_b32 s65, 0x1000000
    s_branch K1_COMMON
K1_GU:
    s_mov_b32 s21, 3
    s_sub_u32 s57, s57, 16
    s_lshl_b32 s57, s57, 2
    s_add_u32 s57, s57, s20
    s_min_u32 s57, s57, 42
    s_mov_b32 s22, 2752
    s_lshl_b32 s59, s57, 6
    s_add_u32 s8, s48, s59
    s_addc_u32 s9, s49, 0
    s_and_b32 s9, s9, 0xffff
    s_sub_u32 s10, 1409024, s59
    s_mov_b32 s11, 0x20000
    s_add_u32 s12, s50, s59
    s_addc_u32 s13, s51, 0
    s_and_b32 s13, s13, 0xffff
    s_mov_b32 s14, s10
    s_mov_b32 s15, 0x20000
    s_mov_b32 s58, 83886080
    s_mul_i32 s25, s56, 1409024
    s_lshl_b32 s64, s57, 10
    s_add_u32 s25, s25, s64
    s_mov_b32 s65, 5636096
K1_COMMON:
    s_lshl_b32 s64, s56, 19
    s_add_u32 s4, s60, s64
    s_addc_u32 s5, s61, 0
    s_and_b32 s5, s5, 0xffff
    s_mov_b32 s6, 0x80000
    s_mov_b32 s7, 0x20000
    s_add_u32 s16, s52, s58
    s_addc_u32 s17, s53, 0
    s_and_b32 s17, s17, 0xffff
    s_mov_b32 s18, s65
    s_mov_b32 s19, 0x20000
    s_mov_b32 s27, 0x80000000
    s_mov_b32 s29, 0x80000000
    s_mov_b32 s30, 0x3e0293ee
    s_mov_b32 s31, 0xbfb8aa3b
    v_lshrrev_b32 v9, 3, v1
    s_lshl_b32 s64, s20, 3
    v_add_u32 v9, s64, v9
    v_lshlrev_b32 v2, 10, v9
    s_and_b32 s64, s20, 1
    s_lshl_b32 s64, s64, 2
    v_lshrrev_b32 v9, 4, v1
    v_add_u32 v9, s64, v9
    v_and_b32 v10, 7, v1
    v_xor_b32 v9, v9, v10
    v_and_b32 v9, 7, v9
    v_lshl_add_u32 v2, v9, 4, v2
    v_and_b32 v9, 15, v1
    v_lshrrev_b32 v10, 4, v1
    v_lshrrev_b32 v11, 1, v9
    v_xor_b32 v11, v11, v10
    v_lshlrev_b32 v11, 4, v11
    v_lshl_add_u32 v3, v9, 7, v11
    v_xor_b32 v4, 64, v3
    v_lshrrev_b32 v11, 2, v9
    v_lshl_add_u32 v11, v10, 3, v11
    v_lshlrev_b32 v11, 6, v11
    v_and_b32 v12, 3, v9
    v_lshl_add_u32 v11, v12, 3, v11
    v_and_b32 v12, 1, v10
    v_lshl_add_u32 v5, v12, 5, v11
    s_mul_i32 s64, s20, 24576
    s_add_u32 s64, s64, 0x10000
    v_add_u32 v5, s64, v5
    v_xor_b32 v6, 32, v5
    v_lshlrev_b32 v14, 4, v1
    v_add_u32 v14, s64, v14
    v_add_u32 v12, 0x10000, v3
    v_add_u32 v13, 0x10000, v4
    v_lshrrev_b32 v11, 2, v1
    v_mul_lo_u32 v7, v11, s22
    v_lshrrev_b32 v11, 1, v1
    v_lshrrev_b32 v15, 5, v1
    v_xor_b32 v11, v11, v15
    v_and_b32 v11, 1, v11
    v_lshl_add_u32 v7, v11, 5, v7
    v_and_b32 v11, 1, v1
    v_lshl_add_u32 v7, v11, 4, v7
    s_lshl_b32 s66, s22, 4
    s_mov_b32 s67, 0
    s_lshl_b32 s26, s20, 10
    s_mov_b32 s24, 0
    s_add_u32 m0, s64, 0
    s_mov_b32 s73, s67
    buffer_load_dwordx4 v7, s[8:11], s73 offen lds
    s_add_u32 m0, s64, 1024
    s_add_u32 s73, s67, s66
    buffer_load_dwordx4 v7, s[8:11], s73 offen lds
    s_add_u32 m0, s64, 2048
    s_mov_b32 s73, s67
    buffer_load_dwordx4 v7, s[12:15], s73 offen lds
    s_add_u32 m0, s64, 3072
    s_add_u32 s73, s67, s66
    buffer_load_dwordx4 v7, s[12:15], s73 offen lds
    s_add_u32 s67, s67, s66
    s_add_u32 s67, s67, s66
    s_add_u32 m0, s64, 4096
    s_mov_b32 s73, s67
    buffer_load_dwordx4 v7, s[8:11], s73 offen lds
    s_add_u32 m0, s64, 5120
    s_add_u32 s73, s67, s66
    buffer_load_dwordx4 v7, s[8:11], s73 offen lds
    s_add_u32 m0, s64, 6144
    s_mov_b32 s73, s67
    buffer_load_dwordx4 v7, s[12:15], s73 offen lds
    s_add_u32 m0, s64, 7168
    s_add_u32 s73, s67, s66
    buffer_load_dwordx4 v7, s[12:15], s73 offen lds
    s_add_u32 s67, s67, s66
    s_add_u32 s67, s67, s66
    s_add_u32 m0, s64, 8192
    s_mov_b32 s73, s67
    buffer_load_dwordx4 v7, s[8:11], s73 offen lds
    s_add_u32 m0, s64, 9216
    s_add_u32 s73, s67, s66
    buffer_load_dwordx4 v7, s[8:11], s73 offen lds
    s_add_u32 m0, s64, 10240
    s_mov_b32 s73, s67
    buffer_load_dwordx4 v7, s[12:15], s73 offen lds
    s_add_u32 m0, s64, 11264
    s_add_u32 s73, s67, s66
    buffer_load_dwordx4 v7, s[12:15], s73 offen lds
    s_add_u32 s67, s67, s66
    s_add_u32 s67, s67, s66
    s_add_u32 m0, s64, 12288
    s_mov_b32 s73, s67
    buffer_load_dwordx4 v7, s[8:11], s73 offen lds
    s_add_u32 m0, s64, 13312
    s_add_u32 s73, s67, s66
    buffer_load_dwordx4 v7, s[8:11], s73 offen lds
    s_add_u32 m0, s64, 14336
    s_mov_b32 s73, s67
    buffer_load_dwordx4 v7, s[12:15], s73 offen lds
    s_add_u32 m0, s64, 15360
    s_add_u32 s73, s67, s66
    buffer_load_dwordx4 v7, s[12:15], s73 offen lds
    s_add_u32 s67, s67, s66
    s_add_u32 s67, s67, s66
    s_add_u32 m0, s64, 16384
    s_mov_b32 s73, s67
    buffer_load_dwordx4 v7, s[8:11], s73 offen lds
    s_add_u32 m0, s64, 17408
    s_add_u32 s73, s67, s66
    buffer_load_dwordx4 v7, s[8:11], s73 offen lds
    s_add_u32 m0, s64, 18432
    s_mov_b32 s73, s67
    buffer_load_dwordx4 v7, s[12:15], s73 offen lds
    s_add_u32 m0, s64, 19456
    s_add_u32 s73, s67, s66
    buffer_load_dwordx4 v7, s[12:15], s73 offen lds
    s_add_u32 s67, s67, s66
    s_add_u32 s67, s67, s66
    s_add_u32 m0, s64, 20480
    s_mov_b32 s73, s67
    buffer_load_dwordx4 v7, s[8:11], s73 offen lds
    s_add_u32 m0, s64, 21504
    s_add_u32 s73, s67, s66
    buffer_load_dwordx4 v7, s[8:11], s73 offen lds
    s_add_u32 m0, s64, 22528
    s_mov_b32 s73, s67
    buffer_load_dwordx4 v7, s[12:15], s73 offen lds
    s_add_u32 m0, s64, 23552
    s_add_u32 s73, s67, s66
    buffer_load_dwordx4 v7, s[12:15], s73 offen lds
    s_add_u32 s67, s67, s66
    s_add_u32 s67, s67, s66
    s_mov_b32 m0, s26
    s_nop 0
    buffer_load_dwordx4 v2, s[4:7], s24 offen offset:0 lds
    s_add_u32 m0, m0, 3968
    s_nop 0
    buffer_load_dwordx4 v2, s[4:7], s24 offen offset:128 lds
    s_add_u32 m0, m0, 3968
    s_nop 0
    buffer_load_dwordx4 v2, s[4:7], s24 offen offset:256 lds
    s_add_u32 m0, m0, 3968
    s_nop 0
    buffer_load_dwordx4 v2, s[4:7], s24 offen offset:384 lds
    s_add_u32 m0, m0, 3968
    s_nop 0
    buffer_load_dwordx4 v2, s[4:7], s24 offen offset:512 lds
    s_add_u32 m0, m0, 3968
    s_nop 0
    buffer_load_dwordx4 v2, s[4:7], s24 offen offset:640 lds
    s_add_u32 m0, m0, 3968
    s_nop 0
    buffer_load_dwordx4 v2, s[4:7], s24 offen offset:768 lds
    s_add_u32 m0, m0, 3968
    s_nop 0
    buffer_load_dwordx4 v2, s[4:7], s24 offen offset:896 lds
    s_add_u32 s24, s24, 0x8000
    s_add_u32 s26, s26, 0x8000
    s_and_b32 s26, s26, 0x1ffff
    s_mov_b32 m0, s26
    s_nop 0
    buffer_load_dwordx4 v2, s[4:7], s24 offen offset:0 lds
    s_add_u32 m0, m0, 3968
    s_nop 0
    buffer_load_dwordx4 v2, s[4:7], s24 offen offset:128 lds
    s_add_u32 m0, m0, 3968
    s_nop 0
    buffer_load_dwordx4 v2, s[4:7], s24 offen offset:256 lds
    s_add_u32 m0, m0, 3968
    s_nop 0
    buffer_load_dwordx4 v2, s[4:7], s24 offen offset:384 lds
    s_add_u32 m0, m0, 3968
    s_nop 0
    buffer_load_dwordx4 v2, s[4:7], s24 offen offset:512 lds
    s_add_u32 m0, m0, 3968
    s_nop 0
    buffer_load_dwordx4 v2, s[4:7], s24 offen offset:640 lds
    s_add_u32 m0, m0, 3968
    s_nop 0
    buffer_load_dwordx4 v2, s[4:7], s24 offen offset:768 lds
    s_add_u32 m0, m0, 3968
    s_nop 0
    buffer_load_dwordx4 v2, s[4:7], s24 offen offset:896 lds
    s_add_u32 s24, s24, 0x8000
    s_add_u32 s26, s26, 0x8000
    s_and_b32 s26, s26, 0x1ffff
    v_lshrrev_b32 v11, 1, v10
    v_lshlrev_b32 v8, 10, v11
    v_and_b32 v11, 1, v10
    v_lshl_add_u32 v8, v11, 9, v8
    s_cmp_eq_u32 s21, 0
    s_cbranch_scc0 K1_A1
    v_lshrrev_b32 v11, 3, v9
    v_lshlrev_b32 v11, 4, v11
    v_and_b32 v15, 7, v9
    v_add_u32 v11, v11, v15
    v_lshl_add_u32 v8, v11, 4, v8
    s_branch K1_A3
K1_A1:
    s_cmp_eq_u32 s21, 3
    s_cbranch_scc1 K1_A2
    v_lshl_add_u32 v8, v9, 4, v8
    s_branch K1_A3
K1_A2:
    v_lshlrev_b32 v8, 4, v1
K1_A3:
    s_waitcnt vmcnt(36)
    ds_read_b64_tr_b16 a[0:1], v5 offset:0
    ds_read_b64_tr_b16 a[2:3], v5 offset:256
    ds_read_b64_tr_b16 a[4:5], v6 offset:0
    ds_read_b64_tr_b16 a[6:7], v6 offset:256
    ds_read_b64_tr_b16 a[8:9], v5 offset:2048
    ds_read_b64_tr_b16 a[10:11], v5 offset:2304
    ds_read_b64_tr_b16 a[12:13], v6 offset:2048
    ds_read_b64_tr_b16 a[14:15], v6 offset:2304
    s_waitcnt lgkmcnt(0)
    s_add_u32 m0, s64, 0
    s_mov_b32 s73, s67
    buffer_load_dwordx4 v7, s[8:11], s73 offen lds
    s_add_u32 m0, s64, 1024
    s_add_u32 s73, s67, s66
    buffer_load_dwordx4 v7, s[8:11], s73 offen lds
    s_add_u32 m0, s64, 2048
    s_mov_b32 s73, s67
    buffer_load_dwordx4 v7, s[12:15], s73 offen lds
    s_add_u32 m0, s64, 3072
    s_add_u32 s73, s67, s66
    buffer_load_dwordx4 v7, s[12:15], s73 offen lds
    s_add_u32 s67, s67, s66
    s_add_u32 s67, s67, s66
    s_waitcnt vmcnt(36)
    ds_read_b64_tr_b16 a[16:17], v5 offset:4096
    ds_read_b64_tr_b16 a[18:19], v5 offset:4352
    ds_read_b64_tr_b16 a[20:21], v6 offset:4096
    ds_read_b64_tr_b16 a[22:23], v6 offset:4352
    ds_read_b64_tr_b16 a[24:25], v5 offset:6144
    ds_read_b64_tr_b16 a[26:27], v5 offset:6400
    ds_read_b64_tr_b16 a[28:29], v6 offset:6144
    ds_read_b64_tr_b16 a[30:31], v6 offset:6400
    s_waitcnt lgkmcnt(0)
    s_add_u32 m0, s64, 4096
    s_mov_b32 s73, s67
    buffer_load_dwordx4 v7, s[8:11], s73 offen lds
    s_add_u32 m0, s64, 5120
    s_add_u32 s73, s67, s66
    buffer_load_dwordx4 v7, s[8:11], s73 offen lds
    s_add_u32 m0, s64, 6144
    s_mov_b32 s73, s67
    buffer_load_dwordx4 v7, s[12:15], s73 offen lds
    s_add_u32 m0, s64, 7168
    s_add_u32 s73, s67, s66
    buffer_load_dwordx4 v7, s[12:15], s73 offen lds
    s_add_u32 s67, s67, s66
    s_add_u32 s67, s67, s66
    s_waitcnt vmcnt(36)
    ds_read_b64_tr_b16 a[32:33], v5 offset:8192
    ds_read_b64_tr_b16 a[34:35], v5 offset:8448
    ds_read_b64_tr_b16 a[36:37], v6 offset:8192
    ds_read_b64_tr_b16 a[38:39], v6 offset:8448
    ds_read_b64_tr_b16 a[40:41], v5 offset:10240
    ds_read_b64_tr_b16 a[42:43], v5 offset:10496
    ds_read_b64_tr_b16 a[44:45], v6 offset:10240
    ds_read_b64_tr_b16 a[46:47], v6 offset:10496
    s_waitcnt lgkmcnt(0)
    s_add_u32 m0, s64, 8192
    s_mov_b32 s73, s67
    buffer_load_dwordx4 v7, s[8:11], s73 offen lds
    s_add_u32 m0, s64, 9216
    s_add_u32 s73, s67, s66
    buffer_load_dwordx4 v7, s[8:11], s73 offen lds
    s_add_u32 m0, s64, 10240
    s_mov_b32 s73, s67
    buffer_load_dwordx4 v7, s[12:15], s73 offen lds
    s_add_u32 m0, s64, 11264
    s_add_u32 s73, s67, s66
    buffer_load_dwordx4 v7, s[12:15], s73 offen lds
    s_add_u32 s67, s67, s66
    s_add_u32 s67, s67, s66
    s_waitcnt vmcnt(36)
    ds_read_b64_tr_b16 a[48:49], v5 offset:12288
    ds_read_b64_tr_b16 a[50:51], v5 offset:12544
    ds_read_b64_tr_b16 a[52:53], v6 offset:12288
    ds_read_b64_tr_b16 a[54:55], v6 offset:12544
    ds_read_b64_tr_b16 a[56:57], v5 offset:14336
    ds_read_b64_tr_b16 a[58:59], v5 offset:14592
    ds_read_b64_tr_b16 a[60:61], v6 offset:14336
    ds_read_b64_tr_b16 a[62:63], v6 offset:14592
    s_waitcnt lgkmcnt(0)
    s_add_u32 m0, s64, 12288
    s_mov_b32 s73, s67
    buffer_load_dwordx4 v7, s[8:11], s73 offen lds
    s_add_u32 m0, s64, 13312
    s_add_u32 s73, s67, s66
    buffer_load_dwordx4 v7, s[8:11], s73 offen lds
    s_add_u32 m0, s64, 14336
    s_mov_b32 s73, s67
    buffer_load_dwordx4 v7, s[12:15], s73 offen lds
    s_add_u32 m0, s64, 15360
    s_add_u32 s73, s67, s66
    buffer_load_dwordx4 v7, s[12:15], s73 offen lds
    s_add_u32 s67, s67, s66
    s_add_u32 s67, s67, s66
    s_waitcnt vmcnt(36)
    ds_read_b64_tr_b16 a[64:65], v5 offset:16384
    ds_read_b64_tr_b16 a[66:67], v5 offset:16640
    ds_read_b64_tr_b16 a[68:69], v6 offset:16384
    ds_read_b64_tr_b16 a[70:71], v6 offset:16640
    ds_read_b64_tr_b16 a[72:73], v5 offset:18432
    ds_read_b64_tr_b16 a[74:75], v5 offset:18688
    ds_read_b64_tr_b16 a[76:77], v6 offset:18432
    ds_read_b64_tr_b16 a[78:79], v6 offset:18688
    s_waitcnt lgkmcnt(0)
    s_add_u32 m0, s64, 16384
    s_mov_b32 s73, s67
    buffer_load_dwordx4 v7, s[8:11], s73 offen lds
    s_add_u32 m0, s64, 17408
    s_add_u32 s73, s67, s66
    buffer_load_dwordx4 v7, s[8:11], s73 offen lds
    s_add_u32 m0, s64, 18432
    s_mov_b32 s73, s67
    buffer_load_dwordx4 v7, s[12:15], s73 offen lds
    s_add_u32 m0, s64, 19456
    s_add_u32 s73, s67, s66
    buffer_load_dwordx4 v7, s[12:15], s73 offen lds
    s_add_u32 s67, s67, s66
    s_add_u32 s67, s67, s66
    s_waitcnt vmcnt(36)
    ds_read_b64_tr_b16 a[80:81], v5 offset:20480
    ds_read_b64_tr_b16 a[82:83], v5 offset:20736
    ds_read_b64_tr_b16 a[84:85], v6 offset:20480
    ds_read_b64_tr_b16 a[86:87], v6 offset:20736
    ds_read_b64_tr_b16 a[88:89], v5 offset:22528
    ds_read_b64_tr_b16 a[90:91], v5 offset:22784
    ds_read_b64_tr_b16 a[92:93], v6 offset:22528
    ds_read_b64_tr_b16 a[94:95], v6 offset:22784
    s_waitcnt lgkmcnt(0)
    s_add_u32 m0, s64, 20480
    s_mov_b32 s73, s67
    buffer_load_dwordx4 v7, s[8:11], s73 offen lds
    s_add_u32 m0, s64, 21504
    s_add_u32 s73, s67, s66
    buffer_load_dwordx4 v7, s[8:11], s73 offen lds
    s_add_u32 m0, s64, 22528
    s_mov_b32 s73, s67
    buffer_load_dwordx4 v7, s[12:15], s73 offen lds
    s_add_u32 m0, s64, 23552
    s_add_u32 s73, s67, s66
    buffer_load_dwordx4 v7, s[12:15], s73 offen lds
    s_add_u32 s67, s67, s66
    s_add_u32 s67, s67, s66
    s_waitcnt vmcnt(20)
    ds_read_b64_tr_b16 a[96:97], v5 offset:0
    ds_read_b64_tr_b16 a[98:99], v5 offset:256
    ds_read_b64_tr_b16 a[100:101], v6 offset:0
    ds_read_b64_tr_b16 a[102:103], v6 offset:256
    ds_read_b64_tr_b16 a[104:105], v5 offset:2048
    ds_read_b64_tr_b16 a[106:107], v5 offset:2304
    ds_read_b64_tr_b16 a[108:109], v6 offset:2048
    ds_read_b64_tr_b16 a[110:111], v6 offset:2304
    s_waitcnt lgkmcnt(0)
    s_add_u32 m0, s64, 0
    s_mov_b32 s73, s67
    buffer_load_dwordx4 v7, s[8:11], s73 offen lds
    s_add_u32 m0, s64, 1024
    s_add_u32 s73, s67, s66
    buffer_load_dwordx4 v7, s[8:11], s73 offen lds
    s_add_u32 m0, s64, 2048
    s_mov_b32 s73, s67
    buffer_load_dwordx4 v7, s[12:15], s73 offen lds
    s_add_u32 m0, s64, 3072
    s_add_u32 s73, s67, s66
    buffer_load_dwordx4 v7, s[12:15], s73 offen lds
    s_add_u32 s67, s67, s66
    s_add_u32 s67, s67, s66
    s_waitcnt vmcnt(20)
    ds_read_b64_tr_b16 a[112:113], v5 offset:4096
    ds_read_b64_tr_b16 a[114:115], v5 offset:4352
    ds_read_b64_tr_b16 a[116:117], v6 offset:4096
    ds_read_b64_tr_b16 a[118:119], v6 offset:4352
    ds_read_b64_tr_b16 a[120:121], v5 offset:6144
    ds_read_b64_tr_b16 a[122:123], v5 offset:6400
    ds_read_b64_tr_b16 a[124:125], v6 offset:6144
    ds_read_b64_tr_b16 a[126:127], v6 offset:6400
    s_waitcnt lgkmcnt(0)
    s_add_u32 m0, s64, 4096
    s_mov_b32 s73, s67
    buffer_load_dwordx4 v7, s[8:11], s73 offen lds
    s_add_u32 m0, s64, 5120
    s_add_u32 s73, s67, s66
    buffer_load_dwordx4 v7, s[8:11], s73 offen lds
    s_add_u32 m0, s64, 6144
    s_mov_b32 s73, s67
    buffer_load_dwordx4 v7, s[12:15], s73 offen lds
    s_add_u32 m0, s64, 7168
    s_add_u32 s73, s67, s66
    buffer_load_dwordx4 v7, s[12:15], s73 offen lds
    s_add_u32 s67, s67, s66
    s_add_u32 s67, s67, s66
    s_waitcnt vmcnt(20)
    ds_read_b64_tr_b16 a[128:129], v5 offset:8192
    ds_read_b64_tr_b16 a[130:131], v5 offset:8448
    ds_read_b64_tr_b16 a[132:133], v6 offset:8192
    ds_read_b64_tr_b16 a[134:135], v6 offset:8448
    ds_read_b64_tr_b16 a[136:137], v5 offset:10240
    ds_read_b64_tr_b16 a[138:139], v5 offset:10496
    ds_read_b64_tr_b16 a[140:141], v6 offset:10240
    ds_read_b64_tr_b16 a[142:143], v6 offset:10496
    s_waitcnt lgkmcnt(0)
    s_add_u32 m0, s64, 8192
    s_mov_b32 s73, s67
    buffer_load_dwordx4 v7, s[8:11], s73 offen lds
    s_add_u32 m0, s64, 9216
    s_add_u32 s73, s67, s66
    buffer_load_dwordx4 v7, s[8:11], s73 offen lds
    s_add_u32 m0, s64, 10240
    s_mov_b32 s73, s67
    buffer_load_dwordx4 v7, s[12:15], s73 offen lds
    s_add_u32 m0, s64, 11264
    s_add_u32 s73, s67, s66
    buffer_load_dwordx4 v7, s[12:15], s73 offen lds
    s_add_u32 s67, s67, s66
    s_add_u32 s67, s67, s66
    s_waitcnt vmcnt(20)
    ds_read_b64_tr_b16 a[144:145], v5 offset:12288
    ds_read_b64_tr_b16 a[146:147], v5 offset:12544
    ds_read_b64_tr_b16 a[148:149], v6 offset:12288
    ds_read_b64_tr_b16 a[150:151], v6 offset:12544
    ds_read_b64_tr_b16 a[152:153], v5 offset:14336
    ds_read_b64_tr_b16 a[154:155], v5 offset:14592
    ds_read_b64_tr_b16 a[156:157], v6 offset:14336
    ds_read_b64_tr_b16 a[158:159], v6 offset:14592
    s_waitcnt lgkmcnt(0)
    s_add_u32 m0, s64, 12288
    s_mov_b32 s73, s67
    buffer_load_dwordx4 v7, s[8:11], s73 offen lds
    s_add_u32 m0, s64, 13312
    s_add_u32 s73, s67, s66
    buffer_load_dwordx4 v7, s[8:11], s73 offen lds
    s_add_u32 m0, s64, 14336
    s_mov_b32 s73, s67
    buffer_load_dwordx4 v7, s[12:15], s73 offen lds
    s_add_u32 m0, s64, 15360
    s_add_u32 s73, s67, s66
    buffer_load_dwordx4 v7, s[12:15], s73 offen lds
    s_add_u32 s67, s67, s66
    s_add_u32 s67, s67, s66
    s_waitcnt vmcnt(20)
    ds_read_b64_tr_b16 a[160:161], v5 offset:16384
    ds_read_b64_tr_b16 a[162:163], v5 offset:16640
    ds_read_b64_tr_b16 a[164:165], v6 offset:16384
    ds_read_b64_tr_b16 a[166:167], v6 offset:16640
    ds_read_b64_tr_b16 a[168:169], v5 offset:18432
    ds_read_b64_tr_b16 a[170:171], v5 offset:18688
    ds_read_b64_tr_b16 a[172:173], v6 offset:18432
    ds_read_b64_tr_b16 a[174:175], v6 offset:18688
    s_waitcnt vmcnt(16)
    ds_read_b64_tr_b16 a[176:177], v5 offset:20480
    ds_read_b64_tr_b16 a[178:179], v5 offset:20736
    ds_read_b64_tr_b16 a[180:181], v6 offset:20480
    ds_read_b64_tr_b16 a[182:183], v6 offset:20736
    ds_read_b64_tr_b16 a[184:185], v5 offset:22528
    ds_read_b64_tr_b16 a[186:187], v5 offset:22784
    ds_read_b64_tr_b16 a[188:189], v6 offset:22528
    ds_read_b64_tr_b16 a[190:191], v6 offset:22784
    s_waitcnt vmcnt(12)
    ds_read_b64_tr_b16 a[192:193], v5 offset:0
    ds_read_b64_tr_b16 a[194:195], v5 offset:256
    ds_read_b64_tr_b16 a[196:197], v6 offset:0
    ds_read_b64_tr_b16 a[198:199], v6 offset:256
    ds_read_b64_tr_b16 a[200:201], v5 offset:2048
    ds_read_b64_tr_b16 a[202:203], v5 offset:2304
    ds_read_b64_tr_b16 a[204:205], v6 offset:2048
    ds_read_b64_tr_b16 a[206:207], v6 offset:2304
    s_waitcnt vmcnt(8)
    ds_read_b64_tr_b16 a[208:209], v5 offset:4096
    ds_read_b64_tr_b16 a[210:211], v5 offset:4352
    ds_read_b64_tr_b16 a[212:213], v6 offset:4096
    ds_read_b64_tr_b16 a[214:215], v6 offset:4352
    ds_read_b64_tr_b16 a[216:217], v5 offset:6144
    ds_read_b64_tr_b16 a[218:219], v5 offset:6400
    ds_read_b64_tr_b16 a[220:221], v6 offset:6144
    ds_read_b64_tr_b16 a[222:223], v6 offset:6400
    s_waitcnt vmcnt(4)
    ds_read_b64_tr_b16 a[224:225], v5 offset:8192
    ds_read_b64_tr_b16 a[226:227], v5 offset:8448
    ds_read_b64_tr_b16 a[228:229], v6 offset:8192
    ds_read_b64_tr_b16 a[230:231], v6 offset:8448
    ds_read_b64_tr_b16 a[232:233], v5 offset:10240
    ds_read_b64_tr_b16 a[234:235], v5 offset:10496
    ds_read_b64_tr_b16 a[236:237], v6 offset:10240
    ds_read_b64_tr_b16 a[238:239], v6 offset:10496
    s_waitcnt vmcnt(0)
    ds_read_b64_tr_b16 a[240:241], v5 offset:12288
    ds_read_b64_tr_b16 a[242:243], v5 offset:12544
    ds_read_b64_tr_b16 a[244:245], v6 offset:12288
    ds_read_b64_tr_b16 a[246:247], v6 offset:12544
    ds_read_b64_tr_b16 a[248:249], v5 offset:14336
    ds_read_b64_tr_b16 a[250:251], v5 offset:14592
    ds_read_b64_tr_b16 a[252:253], v6 offset:14336
    ds_read_b64_tr_b16 a[254:255], v6 offset:14592
    s_waitcnt lgkmcnt(0)
    s_barrier
    s_mov_b32 m0, s26
    s_nop 0
    buffer_load_dwordx4 v2, s[4:7], s24 offen offset:0 lds
    s_add_u32 m0, m0, 3968
    s_nop 0
    buffer_load_dwordx4 v2, s[4:7], s24 offen offset:128 lds
    s_add_u32 m0, m0, 3968
    s_nop 0
    buffer_load_dwordx4 v2, s[4:7], s24 offen offset:256 lds
    s_add_u32 m0, m0, 3968
    s_nop 0
    buffer_load_dwordx4 v2, s[4:7], s24 offen offset:384 lds
    s_add_u32 m0, m0, 3968
    s_nop 0
    buffer_load_dwordx4 v2, s[4:7], s24 offen offset:512 lds
    s_add_u32 m0, m0, 3968
    s_nop 0
    buffer_load_dwordx4 v2, s[4:7], s24 offen offset:640 lds
    s_add_u32 m0, m0, 3968
    s_nop 0
    buffer_load_dwordx4 v2, s[4:7], s24 offen offset:768 lds
    s_add_u32 m0, m0, 3968
    s_nop 0
    buffer_load_dwordx4 v2, s[4:7], s24 offen offset:896 lds
    s_add_u32 s24, s24, 0x8000
    s_add_u32 s26, s26, 0x8000
    s_and_b32 s26, s26, 0x1ffff
    ds_read_b128 v[16:19], v3 offset:0
    ds_read_b128 v[20:23], v4 offset:0
    ds_read_b128 v[24:27], v3 offset:4096
    s_mov_b32 s23, 16
    s_cmp_eq_u32 s21, 0
    s_cbranch_scc1 K1_LOOP_K
    s_cmp_eq_u32 s21, 1
    s_cbranch_scc1 K1_LOOP_V
    s_cmp_eq_u32 s21, 2
    s_cbranch_scc1 K1_LOOP_Q
    s_branch K1_LOOP_G
.p2align 6
K1_LOOP_K:
    s_waitcnt lgkmcnt(2)
    v_mfma_f32_16x16x32_bf16 v[48:51], a[0:3], v[16:19], 0
    ds_read_b128 v[28:31], v4 offset:4096
    v_mfma_f32_16x16x32_bf16 v[52:55], a[4:7], v[16:19], 0
    v_mfma_f32_16x16x32_bf16 v[56:59], a[8:11], v[16:19], 0
    v_mfma_f32_16x16x32_bf16 v[60:63], a[12:15], v[16:19], 0
    v_cvt_pk_bf16_f32 v88, v64, v65
    s_waitcnt lgkmcnt(2)
    v_mfma_f32_16x16x32_bf16 v[48:51], a[16:19], v[20:23], v[48:51]
    ds_read_b128 v[16:19], v3 offset:8192
    v_mfma_f32_16x16x32_bf16 v[52:55], a[20:23], v[20:23], v[52:55]
    v_mfma_f32_16x16x32_bf16 v[56:59], a[24:27], v[20:23], v[56:59]
    v_mfma_f32_16x16x32_bf16 v[60:63], a[28:31], v[20:23], v[60:63]
    s_waitcnt lgkmcnt(2)
    v_mfma_f32_16x16x32_bf16 v[48:51], a[32:35], v[24:27], v[48:51]
    ds_read_b128 v[20:23], v4 offset:8192
    v_cvt_pk_bf16_f32 v89, v66, v67
    v_mfma_f32_16x16x32_bf16 v[52:55], a[36:39], v[24:27], v[52:55]
    v_mfma_f32_16x16x32_bf16 v[56:59], a[40:43], v[24:27], v[56:59]
    v_mfma_f32_16x16x32_bf16 v[60:63], a[44:47], v[24:27], v[60:63]
    s_waitcnt lgkmcnt(2)
    v_mfma_f32_16x16x32_bf16 v[48:51], a[48:51], v[28:31], v[48:51]
    ds_read_b128 v[24:27], v3 offset:12288
    v_mfma_f32_16x16x32_bf16 v[52:55], a[52:55], v[28:31], v[52:55]
    v_mfma_f32_16x16x32_bf16 v[56:59], a[56:59], v[28:31], v[56:59]
    v_cvt_pk_bf16_f32 v90, v68, v69
    v_mfma_f32_16x16x32_bf16 v[60:63], a[60:63], v[28:31], v[60:63]
    s_waitcnt lgkmcnt(2)
    v_mfma_f32_16x16x32_bf16 v[48:51], a[64:67], v[16:19], v[48:51]
    ds_read_b128 v[28:31], v4 offset:12288
    v_mfma_f32_16x16x32_bf16 v[52:55], a[68:71], v[16:19], v[52:55]
    v_mfma_f32_16x16x32_bf16 v[56:59], a[72:75], v[16:19], v[56:59]
    v_mfma_f32_16x16x32_bf16 v[60:63], a[76:79], v[16:19], v[60:63]
    v_cvt_pk_bf16_f32 v91, v70, v71
    s_waitcnt lgkmcnt(2)
    v_mfma_f32_16x16x32_bf16 v[48:51], a[80:83], v[20:23], v[48:51]
    ds_read_b128 v[16:19], v3 offset:16384
    v_mfma_f32_16x16x32_bf16 v[52:55], a[84:87], v[20:23], v[52:55]
    v_mfma_f32_16x16x32_bf16 v[56:59], a[88:91], v[20:23], v[56:59]
    v_mfma_f32_16x16x32_bf16 v[60:63], a[92:95], v[20:23], v[60:63]
    s_waitcnt lgkmcnt(2)
    v_mfma_f32_16x16x32_bf16 v[48:51], a[96:99], v[24:27], v[48:51]
    ds_read_b128 v[20:23], v4 offset:16384
    v_mfma_f32_16x16x32_bf16 v[52:55], a[100:103], v[24:27], v[52:55]
    buffer_store_dwordx4 v[88:91], v8, s[16:19], s27 offen offset:128 sc1
    v_mfma_f32_16x16x32_bf16 v[56:59], a[104:107], v[24:27], v[56:59]
    v_mfma_f32_16x16x32_bf16 v[60:63], a[108:111], v[24:27], v[60:63]
    s_waitcnt lgkmcnt(2)
    v_mfma_f32_16x16x32_bf16 v[48:51], a[112:115], v[28:31], v[48:51]
    ds_read_b128 v[24:27], v3 offset:20480
    v_mfma_f32_16x16x32_bf16 v[52:55], a[116:119], v[28:31], v[52:55]
    v_mfma_f32_16x16x32_bf16 v[56:59], a[120:123], v[28:31], v[56:59]
    v_mfma_f32_16x16x32_bf16 v[60:63], a[124:127], v[28:31], v[60:63]
    v_cvt_pk_bf16_f32 v92, v72, v73
    s_waitcnt lgkmcnt(2)
    v_mfma_f32_16x16x32_bf16 v[48:51], a[128:131], v[16:19], v[48:51]
    ds_read_b128 v[28:31], v4 offset:20480
    v_mfma_f32_16x16x32_bf16 v[52:55], a[132:135], v[16:19], v[52:55]
    v_mfma_f32_16x16x32_bf16 v[56:59], a[136:139], v[16:19], v[56:59]
    v_mfma_f32_16x16x32_bf16 v[60:63], a[140:143], v[16:19], v[60:63]
    s_waitcnt lgkmcnt(2)
    v_mfma_f32_16x16x32_bf16 v[48:51], a[144:147], v[20:23], v[48:51]
    ds_read_b128 v[16:19], v3 offset:24576
    v_cvt_pk_bf16_f32 v93, v74, v75
    v_mfma_f32_16x16x32_bf16 v[52:55], a[148:151], v[20:23], v[52:55]
    v_mfma_f32_16x16x32_bf16 v[56:59], a[152:155], v[20:23], v[56:59]
    v_mfma_f32_16x16x32_bf16 v[60:63], a[156:159], v[20:23], v[60:63]
    s_waitcnt lgkmcnt(2)
    v_mfma_f32_16x16x32_bf16 v[48:51], a[160:163], v[24:27], v[48:51]
    ds_read_b128 v[20:23], v4 offset:24576
    v_mfma_f32_16x16x32_bf16 v[52:55], a[164:167], v[24:27], v[52:55]
    v_mfma_f32_16x16x32_bf16 v[56:59], a[168:171], v[24:27], v[56:59]
    v_cvt_pk_bf16_f32 v94, v76, v77
    v_mfma_f32_16x16x32_bf16 v[60:63], a[172:175], v[24:27], v[60:63]
    s_waitcnt lgkmcnt(2)
    v_mfma_f32_16x16x32_bf16 v[48:51], a[176:179], v[28:31], v[48:51]
    ds_read_b128 v[24:27], v3 offset:28672
    v_mfma_f32_16x16x32_bf16 v[52:55], a[180:183], v[28:31], v[52:55]
    v_mfma_f32_16x16x32_bf16 v[56:59], a[184:187], v[28:31], v[56:59]
    v_mfma_f32_16x16x32_bf16 v[60:63], a[188:191], v[28:31], v[60:63]
    v_cvt_pk_bf16_f32 v95, v78, v79
    s_waitcnt lgkmcnt(2)
    v_mfma_f32_16x16x32_bf16 v[48:51], a[192:195], v[16:19], v[48:51]
    ds_read_b128 v[28:31], v4 offset:28672
    v_mfma_f32_16x16x32_bf16 v[52:55], a[196:199], v[16:19], v[52:55]
    v_mfma_f32_16x16x32_bf16 v[56:59], a[200:203], v[16:19], v[56:59]
    v_mfma_f32_16x16x32_bf16 v[60:63], a[204:207], v[16:19], v[60:63]
    s_waitcnt lgkmcnt(2)
    v_mfma_f32_16x16x32_bf16 v[48:51], a[208:211], v[20:23], v[48:51]
    ds_read_b128 v[16:19], v3 offset:2048
    v_mfma_f32_16x16x32_bf16 v[52:55], a[212:215], v[20:23], v[52:55]
    buffer_store_dwordx4 v[92:95], v8, s[16:19], s27 offen offset:2176 sc1
    v_mfma_f32_16x16x32_bf16 v[56:59], a[216:219], v[20:23], v[56:59]
    v_mfma_f32_16x16x32_bf16 v[60:63], a[220:223], v[20:23], v[60:63]
    s_waitcnt lgkmcnt(2)
    v_mfma_f32_16x16x32_bf16 v[48:51], a[224:227], v[24:27], v[48:51]
    ds_read_b128 v[20:23], v4 offset:2048
    v_mfma_f32_16x16x32_bf16 v[52:55], a[228:231], v[24:27], v[52:55]
    v_mfma_f32_16x16x32_bf16 v[56:59], a[232:235], v[24:27], v[56:59]
    v_mfma_f32_16x16x32_bf16 v[60:63], a[236:239], v[24:27], v[60:63]
    s_waitcnt lgkmcnt(2)
    v_mfma_f32_16x16x32_bf16 v[48:51], a[240:243], v[28:31], v[48:51]
    ds_read_b128 v[24:27], v3 offset:6144
    v_mfma_f32_16x16x32_bf16 v[52:55], a[244:247], v[28:31], v[52:55]
    v_mfma_f32_16x16x32_bf16 v[56:59], a[248:251], v[28:31], v[56:59]
    v_mfma_f32_16x16x32_bf16 v[60:63], a[252:255], v[28:31], v[60:63]
    s_waitcnt vmcnt(14)
    s_barrier
    s_waitcnt lgkmcnt(2)
    v_mfma_f32_16x16x32_bf16 v[64:67], a[0:3], v[16:19], 0
    ds_read_b128 v[28:31], v4 offset:6144
    v_mfma_f32_16x16x32_bf16 v[68:71], a[4:7], v[16:19], 0
    v_mfma_f32_16x16x32_bf16 v[72:75], a[8:11], v[16:19], 0
    v_mfma_f32_16x16x32_bf16 v[76:79], a[12:15], v[16:19], 0
    v_cvt_pk_bf16_f32 v80, v48, v49
    s_waitcnt lgkmcnt(2)
    v_mfma_f32_16x16x32_bf16 v[64:67], a[16:19], v[20:23], v[64:67]
    ds_read_b128 v[16:19], v3 offset:10240
    v_mfma_f32_16x16x32_bf16 v[68:71], a[20:23], v[20:23], v[68:71]
    v_mfma_f32_16x16x32_bf16 v[72:75], a[24:27], v[20:23], v[72:75]
    v_cvt_pk_bf16_f32 v81, v50, v51
    v_mfma_f32_16x16x32_bf16 v[76:79], a[28:31], v[20:23], v[76:79]
    s_waitcnt lgkmcnt(2)
    v_mfma_f32_16x16x32_bf16 v[64:67], a[32:35], v[24:27], v[64:67]
    ds_read_b128 v[20:23], v4 offset:10240
    v_mfma_f32_16x16x32_bf16 v[68:71], a[36:39], v[24:27], v[68:71]
    v_mfma_f32_16x16x32_bf16 v[72:75], a[40:43], v[24:27], v[72:75]
    v_cvt_pk_bf16_f32 v82, v52, v53
    v_mfma_f32_16x16x32_bf16 v[76:79], a[44:47], v[24:27], v[76:79]
    s_waitcnt lgkmcnt(2)
    v_mfma_f32_16x16x32_bf16 v[64:67], a[48:51], v[28:31], v[64:67]
    ds_read_b128 v[24:27], v3 offset:14336
    v_mfma_f32_16x16x32_bf16 v[68:71], a[52:55], v[28:31], v[68:71]
    v_mfma_f32_16x16x32_bf16 v[72:75], a[56:59], v[28:31], v[72:75]
    v_cvt_pk_bf16_f32 v83, v54, v55
    v_mfma_f32_16x16x32_bf16 v[76:79], a[60:63], v[28:31], v[76:79]
    s_waitcnt lgkmcnt(2)
    v_mfma_f32_16x16x32_bf16 v[64:67], a[64:67], v[16:19], v[64:67]
    ds_read_b128 v[28:31], v4 offset:14336
    v_mfma_f32_16x16x32_bf16 v[68:71], a[68:71], v[16:19], v[68:71]
    v_mfma_f32_16x16x32_bf16 v[72:75], a[72:75], v[16:19], v[72:75]
    buffer_store_dwordx4 v[80:83], v8, s[16:19], s25 offen offset:0 sc1
    v_mfma_f32_16x16x32_bf16 v[76:79], a[76:79], v[16:19], v[76:79]
    s_waitcnt lgkmcnt(2)
    v_mfma_f32_16x16x32_bf16 v[64:67], a[80:83], v[20:23], v[64:67]
    ds_read_b128 v[16:19], v3 offset:18432
    v_mfma_f32_16x16x32_bf16 v[68:71], a[84:87], v[20:23], v[68:71]
    v_mfma_f32_16x16x32_bf16 v[72:75], a[88:91], v[20:23], v[72:75]
    v_cvt_pk_bf16_f32 v84, v56, v57
    v_mfma_f32_16x16x32_bf16 v[76:79], a[92:95], v[20:23], v[76:79]
    s_waitcnt lgkmcnt(2)
    v_mfma_f32_16x16x32_bf16 v[64:67], a[96:99], v[24:27], v[64:67]
    ds_read_b128 v[20:23], v4 offset:18432
    v_mfma_f32_16x16x32_bf16 v[68:71], a[100:103], v[24:27], v[68:71]
    v_cvt_pk_bf16_f32 v85, v58, v59
    v_mfma_f32_16x16x32_bf16 v[72:75], a[104:107], v[24:27], v[72:75]
    v_mfma_f32_16x16x32_bf16 v[76:79], a[108:111], v[24:27], v[76:79]
    s_waitcnt lgkmcnt(2)
    v_mfma_f32_16x16x32_bf16 v[64:67], a[112:115], v[28:31], v[64:67]
    ds_read_b128 v[24:27], v3 offset:22528
    v_mfma_f32_16x16x32_bf16 v[68:71], a[116:119], v[28:31], v[68:71]
    v_cvt_pk_bf16_f32 v86, v60, v61
    v_mfma_f32_16x16x32_bf16 v[72:75], a[120:123], v[28:31], v[72:75]
    v_mfma_f32_16x16x32_bf16 v[76:79], a[124:127], v[28:31], v[76:79]
    s_waitcnt lgkmcnt(2)
    v_mfma_f32_16x16x32_bf16 v[64:67], a[128:131], v[16:19], v[64:67]
    ds_read_b128 v[28:31], v4 offset:22528
    v_mfma_f32_16x16x32_bf16 v[68:71], a[132:135], v[16:19], v[68:71]
    v_cvt_pk_bf16_f32 v87, v62, v63
    v_mfma_f32_16x16x32_bf16 v[72:75], a[136:139], v[16:19], v[72:75]
    v_mfma_f32_16x16x32_bf16 v[76:79], a[140:143], v[16:19], v[76:79]
    s_waitcnt lgkmcnt(2)
    v_mfma_f32_16x16x32_bf16 v[64:67], a[144:147], v[20:23], v[64:67]
    ds_read_b128 v[16:19], v3 offset:26624
    v_mfma_f32_16x16x32_bf16 v[68:71], a[148:151], v[20:23], v[68:71]
    buffer_store_dwordx4 v[84:87], v8, s[16:19], s25 offen offset:2048 sc1
    v_mfma_f32_16x16x32_bf16 v[72:75], a[152:155], v[20:23], v[72:75]
    v_mfma_f32_16x16x32_bf16 v[76:79], a[156:159], v[20:23], v[76:79]
    s_waitcnt lgkmcnt(2)
    v_mfma_f32_16x16x32_bf16 v[64:67], a[160:163], v[24:27], v[64:67]
    ds_read_b128 v[20:23], v4 offset:26624
    v_mfma_f32_16x16x32_bf16 v[68:71], a[164:167], v[24:27], v[68:71]
    v_mfma_f32_16x16x32_bf16 v[72:75], a[168:171], v[24:27], v[72:75]
    s_mov_b32 m0, s26
    v_mfma_f32_16x16x32_bf16 v[76:79], a[172:175], v[24:27], v[76:79]
    buffer_load_dwordx4 v2, s[4:7], s24 offen offset:0 lds
    s_waitcnt lgkmcnt(2)
    v_mfma_f32_16x16x32_bf16 v[64:67], a[176:179], v[28:31], v[64:67]
    ds_read_b128 v[24:27], v3 offset:30720
    s_add_u32 m0, m0, 3968
    v_mfma_f32_16x16x32_bf16 v[68:71], a[180:183], v[28:31], v[68:71]
    buffer_load_dwordx4 v2, s[4:7], s24 offen offset:128 lds
    v_mfma_f32_16x16x32_bf16 v[72:75], a[184:187], v[28:31], v[72:75]
    s_add_u32 m0, m0, 3968
    v_mfma_f32_16x16x32_bf16 v[76:79], a[188:191], v[28:31], v[76:79]
    buffer_load_dwordx4 v2, s[4:7], s24 offen offset:256 lds
    s_waitcnt lgkmcnt(2)
    v_mfma_f32_16x16x32_bf16 v[64:67], a[192:195], v[16:19], v[64:67]
    ds_read_b128 v[28:31], v4 offset:30720
    s_add_u32 m0, m0, 3968
    v_mfma_f32_16x16x32_bf16 v[68:71], a[196:199], v[16:19], v[68:71]
    v_add_u32 v3, 0x8000, v3
    buffer_load_dwordx4 v2, s[4:7], s24 offen offset:384 lds
    v_mfma_f32_16x16x32_bf16 v[72:75], a[200:203], v[16:19], v[72:75]
    v_and_b32 v3, 0x1ffff, v3
    s_add_u32 m0, m0, 3968
    v_mfma_f32_16x16x32_bf16 v[76:79], a[204:207], v[16:19], v[76:79]
    v_xor_b32 v4, 64, v3
    buffer_load_dwordx4 v2, s[4:7], s24 offen offset:512 lds
    s_waitcnt lgkmcnt(2)
    v_mfma_f32_16x16x32_bf16 v[64:67], a[208:211], v[20:23], v[64:67]
    ds_read_b128 v[16:19], v3 offset:0
    s_add_u32 m0, m0, 3968
    v_mfma_f32_16x16x32_bf16 v[68:71], a[212:215], v[20:23], v[68:71]
    buffer_load_dwordx4 v2, s[4:7], s24 offen offset:640 lds
    v_mfma_f32_16x16x32_bf16 v[72:75], a[216:219], v[20:23], v[72:75]
    s_add_u32 m0, m0, 3968
    v_mfma_f32_16x16x32_bf16 v[76:79], a[220:223], v[20:23], v[76:79]
    buffer_load_dwordx4 v2, s[4:7], s24 offen offset:768 lds
    s_waitcnt lgkmcnt(2)
    v_mfma_f32_16x16x32_bf16 v[64:67], a[224:227], v[24:27], v[64:67]
    ds_read_b128 v[20:23], v4 offset:0
    s_add_u32 m0, m0, 3968
    v_mfma_f32_16x16x32_bf16 v[68:71], a[228:231], v[24:27], v[68:71]
    buffer_load_dwordx4 v2, s[4:7], s24 offen offset:896 lds
    v_mfma_f32_16x16x32_bf16 v[72:75], a[232:235], v[24:27], v[72:75]
    v_mfma_f32_16x16x32_bf16 v[76:79], a[236:239], v[24:27], v[76:79]
    s_waitcnt lgkmcnt(2)
    v_mfma_f32_16x16x32_bf16 v[64:67], a[240:243], v[28:31], v[64:67]
    ds_read_b128 v[24:27], v3 offset:4096
    s_add_u32 s24, s24, 0x8000
    s_add_u32 s26, s26, 0x8000
    s_and_b32 s26, s26, 0x1ffff
    v_mfma_f32_16x16x32_bf16 v[68:71], a[244:247], v[28:31], v[68:71]
    s_mov_b32 s27, s25
    s_add_u32 s25, s25, 8192
    v_mfma_f32_16x16x32_bf16 v[72:75], a[248:251], v[28:31], v[72:75]
    v_mfma_f32_16x16x32_bf16 v[76:79], a[252:255], v[28:31], v[76:79]
    s_sub_u32 s23, s23, 1
    s_cmp_lg_u32 s23, 0
    s_cbranch_scc1 K1_LOOP_K
    s_nop 7
    v_cvt_pk_bf16_f32 v88, v64, v65
    v_cvt_pk_bf16_f32 v89, v66, v67
    v_cvt_pk_bf16_f32 v90, v68, v69
    v_cvt_pk_bf16_f32 v91, v70, v71
    buffer_store_dwordx4 v[88:91], v8, s[16:19], s27 offen offset:128 sc1
    v_cvt_pk_bf16_f32 v92, v72, v73
    v_cvt_pk_bf16_f32 v93, v74, v75
    v_cvt_pk_bf16_f32 v94, v76, v77
    v_cvt_pk_bf16_f32 v95, v78, v79
    buffer_store_dwordx4 v[92:95], v8, s[16:19], s27 offen offset:2176 sc1
    s_endpgm
.p2align 6
K1_LOOP_V:
    s_waitcnt lgkmcnt(2)
    v_mfma_f32_16x16x32_bf16 v[48:51], v[16:19], a[0:3], 0
    ds_read_b128 v[28:31], v4 offset:4096
    v_mfma_f32_16x16x32_bf16 v[52:55], v[16:19], a[4:7], 0
    v_mfma_f32_16x16x32_bf16 v[56:59], v[16:19], a[8:11], 0
    v_mfma_f32_16x16x32_bf16 v[60:63], v[16:19], a[12:15], 0
    v_cvt_pk_bf16_f32 v82, v64, v65
    s_waitcnt lgkmcnt(2)
    v_mfma_f32_16x16x32_bf16 v[48:51], v[20:23], a[16:19], v[48:51]
    ds_read_b128 v[16:19], v3 offset:8192
    v_mfma_f32_16x16x32_bf16 v[52:55], v[20:23], a[20:23], v[52:55]
    v_mfma_f32_16x16x32_bf16 v[56:59], v[20:23], a[24:27], v[56:59]
    v_mfma_f32_16x16x32_bf16 v[60:63], v[20:23], a[28:31], v[60:63]
    v_cvt_pk_bf16_f32 v83, v66, v67
    s_waitcnt lgkmcnt(2)
    v_mfma_f32_16x16x32_bf16 v[48:51], v[24:27], a[32:35], v[48:51]
    ds_read_b128 v[20:23], v4 offset:8192
    v_mfma_f32_16x16x32_bf16 v[52:55], v[24:27], a[36:39], v[52:55]
    v_mfma_f32_16x16x32_bf16 v[56:59], v[24:27], a[40:43], v[56:59]
    v_mfma_f32_16x16x32_bf16 v[60:63], v[24:27], a[44:47], v[60:63]
    s_waitcnt lgkmcnt(2)
    v_mfma_f32_16x16x32_bf16 v[48:51], v[28:31], a[48:51], v[48:51]
    ds_read_b128 v[24:27], v3 offset:12288
    buffer_store_dwordx4 v[80:83], v8, s[16:19], s27 offen offset:0 sc1
    v_mfma_f32_16x16x32_bf16 v[52:55], v[28:31], a[52:55], v[52:55]
    v_mfma_f32_16x16x32_bf16 v[56:59], v[28:31], a[56:59], v[56:59]
    v_mfma_f32_16x16x32_bf16 v[60:63], v[28:31], a[60:63], v[60:63]
    s_waitcnt lgkmcnt(2)
    v_mfma_f32_16x16x32_bf16 v[48:51], v[16:19], a[64:67], v[48:51]
    ds_read_b128 v[28:31], v4 offset:12288
    v_mfma_f32_16x16x32_bf16 v[52:55], v[16:19], a[68:71], v[52:55]
    v_cvt_pk_bf16_f32 v86, v68, v69
    v_mfma_f32_16x16x32_bf16 v[56:59], v[16:19], a[72:75], v[56:59]
    v_mfma_f32_16x16x32_bf16 v[60:63], v[16:19], a[76:79], v[60:63]
    s_waitcnt lgkmcnt(2)
    v_mfma_f32_16x16x32_bf16 v[48:51], v[20:23], a[80:83], v[48:51]
    ds_read_b128 v[16:19], v3 offset:16384
    v_mfma_f32_16x16x32_bf16 v[52:55], v[20:23], a[84:87], v[52:55]
    v_cvt_pk_bf16_f32 v87, v70, v71
    v_mfma_f32_16x16x32_bf16 v[56:59], v[20:23], a[88:91], v[56:59]
    v_mfma_f32_16x16x32_bf16 v[60:63], v[20:23], a[92:95], v[60:63]
    s_waitcnt lgkmcnt(2)
    v_mfma_f32_16x16x32_bf16 v[48:51], v[24:27], a[96:99], v[48:51]
    ds_read_b128 v[20:23], v4 offset:16384
    v_mfma_f32_16x16x32_bf16 v[52:55], v[24:27], a[100:103], v[52:55]
    v_mfma_f32_16x16x32_bf16 v[56:59], v[24:27], a[104:107], v[56:59]
    buffer_store_dwordx4 v[84:87], v8, s[16:19], s27 offen offset:256 sc1
    v_mfma_f32_16x16x32_bf16 v[60:63], v[24:27], a[108:111], v[60:63]
    s_waitcnt lgkmcnt(2)
    v_mfma_f32_16x16x32_bf16 v[48:51], v[28:31], a[112:115], v[48:51]
    ds_read_b128 v[24:27], v3 offset:20480
    v_mfma_f32_16x16x32_bf16 v[52:55], v[28:31], a[116:119], v[52:55]
    v_mfma_f32_16x16x32_bf16 v[56:59], v[28:31], a[120:123], v[56:59]
    v_mfma_f32_16x16x32_bf16 v[60:63], v[28:31], a[124:127], v[60:63]
    v_cvt_pk_bf16_f32 v90, v72, v73
    s_waitcnt lgkmcnt(2)
    v_mfma_f32_16x16x32_bf16 v[48:51], v[16:19], a[128:131], v[48:51]
    ds_read_b128 v[28:31], v4 offset:20480
    v_mfma_f32_16x16x32_bf16 v[52:55], v[16:19], a[132:135], v[52:55]
    v_mfma_f32_16x16x32_bf16 v[56:59], v[16:19], a[136:139], v[56:59]
    v_mfma_f32_16x16x32_bf16 v[60:63], v[16:19], a[140:143], v[60:63]
    v_cvt_pk_bf16_f32 v91, v74, v75
    s_waitcnt lgkmcnt(2)
    v_mfma_f32_16x16x32_bf16 v[48:51], v[20:23], a[144:147], v[48:51]
    ds_read_b128 v[16:19], v3 offset:24576
    v_mfma_f32_16x16x32_bf16 v[52:55], v[20:23], a[148:151], v[52:55]
    v_mfma_f32_16x16x32_bf16 v[56:59], v[20:23], a[152:155], v[56:59]
    v_mfma_f32_16x16x32_bf16 v[60:63], v[20:23], a[156:159], v[60:63]
    s_waitcnt lgkmcnt(2)
    v_mfma_f32_16x16x32_bf16 v[48:51], v[24:27], a[160:163], v[48:51]
    ds_read_b128 v[20:23], v4 offset:24576
    buffer_store_dwordx4 v[88:91], v8, s[16:19], s27 offen offset:2048 sc1
    v_mfma_f32_16x16x32_bf16 v[52:55], v[24:27], a[164:167], v[52:55]
    v_mfma_f32_16x16x32_bf16 v[56:59], v[24:27], a[168:171], v[56:59]
    v_mfma_f32_16x16x32_bf16 v[60:63], v[24:27], a[172:175], v[60:63]
    s_waitcnt lgkmcnt(2)
    v_mfma_f32_16x16x32_bf16 v[48:51], v[28:31], a[176:179], v[48:51]
    ds_read_b128 v[24:27], v3 offset:28672
    v_mfma_f32_16x16x32_bf16 v[52:55], v[28:31], a[180:183], v[52:55]
    v_cvt_pk_bf16_f32 v94, v76, v77
    v_mfma_f32_16x16x32_bf16 v[56:59], v[28:31], a[184:187], v[56:59]
    v_mfma_f32_16x16x32_bf16 v[60:63], v[28:31], a[188:191], v[60:63]
    s_waitcnt lgkmcnt(2)
    v_mfma_f32_16x16x32_bf16 v[48:51], v[16:19], a[192:195], v[48:51]
    ds_read_b128 v[28:31], v4 offset:28672
    v_mfma_f32_16x16x32_bf16 v[52:55], v[16:19], a[196:199], v[52:55]
    v_cvt_pk_bf16_f32 v95, v78, v79
    v_mfma_f32_16x16x32_bf16 v[56:59], v[16:19], a[200:203], v[56:59]
    v_mfma_f32_16x16x32_bf16 v[60:63], v[16:19], a[204:207], v[60:63]
    s_waitcnt lgkmcnt(2)
    v_mfma_f32_16x16x32_bf16 v[48:51], v[20:23], a[208:211], v[48:51]
    ds_read_b128 v[16:19], v3 offset:2048
    v_mfma_f32_16x16x32_bf16 v[52:55], v[20:23], a[212:215], v[52:55]
    v_mfma_f32_16x16x32_bf16 v[56:59], v[20:23], a[216:219], v[56:59]
    buffer_store_dwordx4 v[92:95], v8, s[16:19], s27 offen offset:2304 sc1
    v_mfma_f32_16x16x32_bf16 v[60:63], v[20:23], a[220:223], v[60:63]
    s_waitcnt lgkmcnt(2)
    v_mfma_f32_16x16x32_bf16 v[48:51], v[24:27], a[224:227], v[48:51]
    ds_read_b128 v[20:23], v4 offset:2048
    v_mfma_f32_16x16x32_bf16 v[52:55], v[24:27], a[228:231], v[52:55]
    v_mfma_f32_16x16x32_bf16 v[56:59], v[24:27], a[232:235], v[56:59]
    v_mfma_f32_16x16x32_bf16 v[60:63], v[24:27], a[236:239], v[60:63]
    s_waitcnt lgkmcnt(2)
    v_mfma_f32_16x16x32_bf16 v[48:51], v[28:31], a[240:243], v[48:51]
    ds_read_b128 v[24:27], v3 offset:6144
    v_mfma_f32_16x16x32_bf16 v[52:55], v[28:31], a[244:247], v[52:55]
    v_mfma_f32_16x16x32_bf16 v[56:59], v[28:31], a[248:251], v[56:59]
    v_mfma_f32_16x16x32_bf16 v[60:63], v[28:31], a[252:255], v[60:63]
    s_waitcnt vmcnt(16)
    s_barrier
    s_waitcnt lgkmcnt(2)
    v_mfma_f32_16x16x32_bf16 v[64:67], v[16:19], a[0:3], 0
    ds_read_b128 v[28:31], v4 offset:6144
    v_mfma_f32_16x16x32_bf16 v[68:71], v[16:19], a[4:7], 0
    v_mfma_f32_16x16x32_bf16 v[72:75], v[16:19], a[8:11], 0
    v_mfma_f32_16x16x32_bf16 v[76:79], v[16:19], a[12:15], 0
    v_cvt_pk_bf16_f32 v80, v48, v49
    s_waitcnt lgkmcnt(2)
    v_mfma_f32_16x16x32_bf16 v[64:67], v[20:23], a[16:19], v[64:67]
    ds_read_b128 v[16:19], v3 offset:10240
    v_mfma_f32_16x16x32_bf16 v[68:71], v[20:23], a[20:23], v[68:71]
    v_mfma_f32_16x16x32_bf16 v[72:75], v[20:23], a[24:27], v[72:75]
    v_mfma_f32_16x16x32_bf16 v[76:79], v[20:23], a[28:31], v[76:79]
    v_cvt_pk_bf16_f32 v81, v50, v51
    s_waitcnt lgkmcnt(2)
    v_mfma_f32_16x16x32_bf16 v[64:67], v[24:27], a[32:35], v[64:67]
    ds_read_b128 v[20:23], v4 offset:10240
    v_mfma_f32_16x16x32_bf16 v[68:71], v[24:27], a[36:39], v[68:71]
    v_mfma_f32_16x16x32_bf16 v[72:75], v[24:27], a[40:43], v[72:75]
    v_mfma_f32_16x16x32_bf16 v[76:79], v[24:27], a[44:47], v[76:79]
    s_waitcnt lgkmcnt(2)
    v_mfma_f32_16x16x32_bf16 v[64:67], v[28:31], a[48:51], v[64:67]
    ds_read_b128 v[24:27], v3 offset:14336
    v_cvt_pk_bf16_f32 v84, v52, v53
    v_mfma_f32_16x16x32_bf16 v[68:71], v[28:31], a[52:55], v[68:71]
    v_mfma_f32_16x16x32_bf16 v[72:75], v[28:31], a[56:59], v[72:75]
    v_mfma_f32_16x16x32_bf16 v[76:79], v[28:31], a[60:63], v[76:79]
    s_waitcnt lgkmcnt(2)
    v_mfma_f32_16x16x32_bf16 v[64:67], v[16:19], a[64:67], v[64:67]
    ds_read_b128 v[28:31], v4 offset:14336
    v_mfma_f32_16x16x32_bf16 v[68:71], v[16:19], a[68:71], v[68:71]
    v_cvt_pk_bf16_f32 v85, v54, v55
    v_mfma_f32_16x16x32_bf16 v[72:75], v[16:19], a[72:75], v[72:75]
    v_mfma_f32_16x16x32_bf16 v[76:79], v[16:19], a[76:79], v[76:79]
    s_waitcnt lgkmcnt(2)
    v_mfma_f32_16x16x32_bf16 v[64:67], v[20:23], a[80:83], v[64:67]
    ds_read_b128 v[16:19], v3 offset:18432
    v_mfma_f32_16x16x32_bf16 v[68:71], v[20:23], a[84:87], v[68:71]
    v_mfma_f32_16x16x32_bf16 v[72:75], v[20:23], a[88:91], v[72:75]
    v_cvt_pk_bf16_f32 v88, v56, v57
    v_mfma_f32_16x16x32_bf16 v[76:79], v[20:23], a[92:95], v[76:79]
    s_waitcnt lgkmcnt(2)
    v_mfma_f32_16x16x32_bf16 v[64:67], v[24:27], a[96:99], v[64:67]
    ds_read_b128 v[20:23], v4 offset:18432
    v_mfma_f32_16x16x32_bf16 v[68:71], v[24:27], a[100:103], v[68:71]
    v_mfma_f32_16x16x32_bf16 v[72:75], v[24:27], a[104:107], v[72:75]
    v_cvt_pk_bf16_f32 v89, v58, v59
    v_mfma_f32_16x16x32_bf16 v[76:79], v[24:27], a[108:111], v[76:79]
    s_waitcnt lgkmcnt(2)
    v_mfma_f32_16x16x32_bf16 v[64:67], v[28:31], a[112:115], v[64:67]
    ds_read_b128 v[24:27], v3 offset:22528
    v_mfma_f32_16x16x32_bf16 v[68:71], v[28:31], a[116:119], v[68:71]
    v_mfma_f32_16x16x32_bf16 v[72:75], v[28:31], a[120:123], v[72:75]
    v_mfma_f32_16x16x32_bf16 v[76:79], v[28:31], a[124:127], v[76:79]
    v_cvt_pk_bf16_f32 v92, v60, v61
    s_waitcnt lgkmcnt(2)
    v_mfma_f32_16x16x32_bf16 v[64:67], v[16:19], a[128:131], v[64:67]
    ds_read_b128 v[28:31], v4 offset:22528
    v_mfma_f32_16x16x32_bf16 v[68:71], v[16:19], a[132:135], v[68:71]
    v_mfma_f32_16x16x32_bf16 v[72:75], v[16:19], a[136:139], v[72:75]
    v_mfma_f32_16x16x32_bf16 v[76:79], v[16:19], a[140:143], v[76:79]
    s_waitcnt lgkmcnt(2)
    v_mfma_f32_16x16x32_bf16 v[64:67], v[20:23], a[144:147], v[64:67]
    ds_read_b128 v[16:19], v3 offset:26624
    v_cvt_pk_bf16_f32 v93, v62, v63
    v_mfma_f32_16x16x32_bf16 v[68:71], v[20:23], a[148:151], v[68:71]
    v_mfma_f32_16x16x32_bf16 v[72:75], v[20:23], a[152:155], v[72:75]
    v_mfma_f32_16x16x32_bf16 v[76:79], v[20:23], a[156:159], v[76:79]
    s_waitcnt lgkmcnt(2)
    v_mfma_f32_16x16x32_bf16 v[64:67], v[24:27], a[160:163], v[64:67]
    ds_read_b128 v[20:23], v4 offset:26624
    v_mfma_f32_16x16x32_bf16 v[68:71], v[24:27], a[164:167], v[68:71]
    v_mfma_f32_16x16x32_bf16 v[72:75], v[24:27], a[168:171], v[72:75]
    s_mov_b32 m0, s26
    v_mfma_f32_16x16x32_bf16 v[76:79], v[24:27], a[172:175], v[76:79]
    buffer_load_dwordx4 v2, s[4:7], s24 offen offset:0 lds
    s_waitcnt lgkmcnt(2)
    v_mfma_f32_16x16x32_bf16 v[64:67], v[28:31], a[176:179], v[64:67]
    ds_read_b128 v[24:27], v3 offset:30720
    s_add_u32 m0, m0, 3968
    v_mfma_f32_16x16x32_bf16 v[68:71], v[28:31], a[180:183], v[68:71]
    buffer_load_dwordx4 v2, s[4:7], s24 offen offset:128 lds
    v_mfma_f32_16x16x32_bf16 v[72:75], v[28:31], a[184:187], v[72:75]
    s_add_u32 m0, m0, 3968
    v_mfma_f32_16x16x32_bf16 v[76:79], v[28:31], a[188:191], v[76:79]
    buffer_load_dwordx4 v2, s[4:7], s24 offen offset:256 lds
    s_waitcnt lgkmcnt(2)
    v_mfma_f32_16x16x32_bf16 v[64:67], v[16:19], a[192:195], v[64:67]
    ds_read_b128 v[28:31], v4 offset:30720
    s_add_u32 m0, m0, 3968
    v_mfma_f32_16x16x32_bf16 v[68:71], v[16:19], a[196:199], v[68:71]
    v_add_u32 v3, 0x8000, v3
    buffer_load_dwordx4 v2, s[4:7], s24 offen offset:384 lds
    v_mfma_f32_16x16x32_bf16 v[72:75], v[16:19], a[200:203], v[72:75]
    v_and_b32 v3, 0x1ffff, v3
    s_add_u32 m0, m0, 3968
    v_mfma_f32_16x16x32_bf16 v[76:79], v[16:19], a[204:207], v[76:79]
    v_xor_b32 v4, 64, v3
    buffer_load_dwordx4 v2, s[4:7], s24 offen offset:512 lds
    s_waitcnt lgkmcnt(2)
    v_mfma_f32_16x16x32_bf16 v[64:67], v[20:23], a[208:211], v[64:67]
    ds_read_b128 v[16:19], v3 offset:0
    s_add_u32 m0, m0, 3968
    v_mfma_f32_16x16x32_bf16 v[68:71], v[20:23], a[212:215], v[68:71]
    buffer_load_dwordx4 v2, s[4:7], s24 offen offset:640 lds
    v_mfma_f32_16x16x32_bf16 v[72:75], v[20:23], a[216:219], v[72:75]
    s_add_u32 m0, m0, 3968
    v_mfma_f32_16x16x32_bf16 v[76:79], v[20:23], a[220:223], v[76:79]
    buffer_load_dwordx4 v2, s[4:7], s24 offen offset:768 lds
    s_waitcnt lgkmcnt(2)
    v_mfma_f32_16x16x32_bf16 v[64:67], v[24:27], a[224:227], v[64:67]
    ds_read_b128 v[20:23], v4 offset:0
    s_add_u32 m0, m0, 3968
    v_mfma_f32_16x16x32_bf16 v[68:71], v[24:27], a[228:231], v[68:71]
    buffer_load_dwordx4 v2, s[4:7], s24 offen offset:896 lds
    v_mfma_f32_16x16x32_bf16 v[72:75], v[24:27], a[232:235], v[72:75]
    v_mfma_f32_16x16x32_bf16 v[76:79], v[24:27], a[236:239], v[76:79]
    s_waitcnt lgkmcnt(2)
    v_mfma_f32_16x16x32_bf16 v[64:67], v[28:31], a[240:243], v[64:67]
    ds_read_b128 v[24:27], v3 offset:4096
    s_add_u32 s24, s24, 0x8000
    s_add_u32 s26, s26, 0x8000
    s_and_b32 s26, s26, 0x1ffff
    v_mfma_f32_16x16x32_bf16 v[68:71], v[28:31], a[244:247], v[68:71]
    s_mov_b32 s27, s25
    s_add_u32 s25, s25, 8192
    v_mfma_f32_16x16x32_bf16 v[72:75], v[28:31], a[248:251], v[72:75]
    v_mfma_f32_16x16x32_bf16 v[76:79], v[28:31], a[252:255], v[76:79]
    s_sub_u32 s23, s23, 1
    s_cmp_lg_u32 s23, 0
    s_cbranch_scc1 K1_LOOP_V
    s_nop 7
    v_cvt_pk_bf16_f32 v82, v64, v65
    v_cvt_pk_bf16_f32 v83, v66, v67
    buffer_store_dwordx4 v[80:83], v8, s[16:19], s27 offen offset:0 sc1
    v_cvt_pk_bf16_f32 v86, v68, v69
    v_cvt_pk_bf16_f32 v87, v70, v71
    buffer_store_dwordx4 v[84:87], v8, s[16:19], s27 offen offset:256 sc1
    v_cvt_pk_bf16_f32 v90, v72, v73
    v_cvt_pk_bf16_f32 v91, v74, v75
    buffer_store_dwordx4 v[88:91], v8, s[16:19], s27 offen offset:2048 sc1
    v_cvt_pk_bf16_f32 v94, v76, v77
    v_cvt_pk_bf16_f32 v95, v78, v79
    buffer_store_dwordx4 v[92:95], v8, s[16:19], s27 offen offset:2304 sc1
    s_endpgm
.p2align 6
K1_LOOP_Q:
    s_waitcnt lgkmcnt(2)
    v_mfma_f32_16x16x32_bf16 v[48:51], a[0:3], v[16:19], 0
    ds_read_b128 v[28:31], v4 offset:4096
    v_mfma_f32_16x16x32_bf16 v[52:55], a[4:7], v[16:19], 0
    v_mfma_f32_16x16x32_bf16 v[56:59], a[8:11], v[16:19], 0
    v_mfma_f32_16x16x32_bf16 v[60:63], a[12:15], v[16:19], 0
    v_mul_f32 v64, s30, v64
    s_waitcnt lgkmcnt(2)
    v_mfma_f32_16x16x32_bf16 v[48:51], a[16:19], v[20:23], v[48:51]
    ds_read_b128 v[16:19], v3 offset:8192
    v_mfma_f32_16x16x32_bf16 v[52:55], a[20:23], v[20:23], v[52:55]
    v_mul_f32 v65, s30, v65
    v_mfma_f32_16x16x32_bf16 v[56:59], a[24:27], v[20:23], v[56:59]
    v_mfma_f32_16x16x32_bf16 v[60:63], a[28:31], v[20:23], v[60:63]
    v_mul_f32 v66, s30, v66
    s_waitcnt lgkmcnt(2)
    v_mfma_f32_16x16x32_bf16 v[48:51], a[32:35], v[24:27], v[48:51]
    ds_read_b128 v[20:23], v4 offset:8192
    v_mfma_f32_16x16x32_bf16 v[52:55], a[36:39], v[24:27], v[52:55]
    v_mul_f32 v67, s30, v67
    v_mfma_f32_16x16x32_bf16 v[56:59], a[40:43], v[24:27], v[56:59]
    v_mfma_f32_16x16x32_bf16 v[60:63], a[44:47], v[24:27], v[60:63]
    v_mul_f32 v68, s30, v68
    s_waitcnt lgkmcnt(2)
    v_mfma_f32_16x16x32_bf16 v[48:51], a[48:51], v[28:31], v[48:51]
    ds_read_b128 v[24:27], v3 offset:12288
    v_mfma_f32_16x16x32_bf16 v[52:55], a[52:55], v[28:31], v[52:55]
    v_mul_f32 v69, s30, v69
    v_mfma_f32_16x16x32_bf16 v[56:59], a[56:59], v[28:31], v[56:59]
    v_mfma_f32_16x16x32_bf16 v[60:63], a[60:63], v[28:31], v[60:63]
    v_mul_f32 v70, s30, v70
    s_waitcnt lgkmcnt(2)
    v_mfma_f32_16x16x32_bf16 v[48:51], a[64:67], v[16:19], v[48:51]
    ds_read_b128 v[28:31], v4 offset:12288
    v_mfma_f32_16x16x32_bf16 v[52:55], a[68:71], v[16:19], v[52:55]
    v_mfma_f32_16x16x32_bf16 v[56:59], a[72:75], v[16:19], v[56:59]
    v_mul_f32 v71, s30, v71
    v_mfma_f32_16x16x32_bf16 v[60:63], a[76:79], v[16:19], v[60:63]
    s_waitcnt lgkmcnt(2)
    v_mfma_f32_16x16x32_bf16 v[48:51], a[80:83], v[20:23], v[48:51]
    ds_read_b128 v[16:19], v3 offset:16384
    v_cvt_pk_bf16_f32 v88, v64, v65
    v_mfma_f32_16x16x32_bf16 v[52:55], a[84:87], v[20:23], v[52:55]
    v_mfma_f32_16x16x32_bf16 v[56:59], a[88:91], v[20:23], v[56:59]
    v_cvt_pk_bf16_f32 v89, v66, v67
    v_mfma_f32_16x16x32_bf16 v[60:63], a[92:95], v[20:23], v[60:63]
    s_waitcnt lgkmcnt(2)
    v_mfma_f32_16x16x32_bf16 v[48:51], a[96:99], v[24:27], v[48:51]
    ds_read_b128 v[20:23], v4 offset:16384
    v_cvt_pk_bf16_f32 v90, v68, v69
    v_mfma_f32_16x16x32_bf16 v[52:55], a[100:103], v[24:27], v[52:55]
    v_mfma_f32_16x16x32_bf16 v[56:59], a[104:107], v[24:27], v[56:59]
    v_cvt_pk_bf16_f32 v91, v70, v71
    v_mfma_f32_16x16x32_bf16 v[60:63], a[108:111], v[24:27], v[60:63]
    s_waitcnt lgkmcnt(2)
    v_mfma_f32_16x16x32_bf16 v[48:51], a[112:115], v[28:31], v[48:51]
    ds_read_b128 v[24:27], v3 offset:20480
    buffer_store_dwordx4 v[88:91], v8, s[16:19], s27 offen offset:256 sc1
    v_mfma_f32_16x16x32_bf16 v[52:55], a[116:119], v[28:31], v[52:55]
    v_mfma_f32_16x16x32_bf16 v[56:59], a[120:123], v[28:31], v[56:59]
    v_mfma_f32_16x16x32_bf16 v[60:63], a[124:127], v[28:31], v[60:63]
    v_mul_f32 v72, s30, v72
    s_waitcnt lgkmcnt(2)
    v_mfma_f32_16x16x32_bf16 v[48:51], a[128:131], v[16:19], v[48:51]
    ds_read_b128 v[28:31], v4 offset:20480
    v_mfma_f32_16x16x32_bf16 v[52:55], a[132:135], v[16:19], v[52:55]
    v_mul_f32 v73, s30, v73
    v_mfma_f32_16x16x32_bf16 v[56:59], a[136:139], v[16:19], v[56:59]
    v_mfma_f32_16x16x32_bf16 v[60:63], a[140:143], v[16:19], v[60:63]
    v_mul_f32 v74, s30, v74
    s_waitcnt lgkmcnt(2)
    v_mfma_f32_16x16x32_bf16 v[48:51], a[144:147], v[20:23], v[48:51]
    ds_read_b128 v[16:19], v3 offset:24576
    v_mfma_f32_16x16x32_bf16 v[52:55], a[148:151], v[20:23], v[52:55]
    v_mul_f32 v75, s30, v75
    v_mfma_f32_16x16x32_bf16 v[56:59], a[152:155], v[20:23], v[56:59]
    v_mfma_f32_16x16x32_bf16 v[60:63], a[156:159], v[20:23], v[60:63]
    v_mul_f32 v76, s30, v76
    s_waitcnt lgkmcnt(2)
    v_mfma_f32_16x16x32_bf16 v[48:51], a[160:163], v[24:27], v[48:51]
    ds_read_b128 v[20:23], v4 offset:24576
    v_mfma_f32_16x16x32_bf16 v[52:55], a[164:167], v[24:27], v[52:55]
    v_mul_f32 v77, s30, v77
    v_mfma_f32_16x16x32_bf16 v[56:59], a[168:171], v[24:27], v[56:59]
    v_mfma_f32_16x16x32_bf16 v[60:63], a[172:175], v[24:27], v[60:63]
    v_mul_f32 v78, s30, v78
    s_waitcnt lgkmcnt(2)
    v_mfma_f32_16x16x32_bf16 v[48:51], a[176:179], v[28:31], v[48:51]
    ds_read_b128 v[24:27], v3 offset:28672
    v_mfma_f32_16x16x32_bf16 v[52:55], a[180:183], v[28:31], v[52:55]
    v_mfma_f32_16x16x32_bf16 v[56:59], a[184:187], v[28:31], v[56:59]
    v_mul_f32 v79, s30, v79
    v_mfma_f32_16x16x32_bf16 v[60:63], a[188:191], v[28:31], v[60:63]
    s_waitcnt lgkmcnt(2)
    v_mfma_f32_16x16x32_bf16 v[48:51], a[192:195], v[16:19], v[48:51]
    ds_read_b128 v[28:31], v4 offset:28672
    v_cvt_pk_bf16_f32 v92, v72, v73
    v_mfma_f32_16x16x32_bf16 v[52:55], a[196:199], v[16:19], v[52:55]
    v_mfma_f32_16x16x32_bf16 v[56:59], a[200:203], v[16:19], v[56:59]
    v_cvt_pk_bf16_f32 v93, v74, v75
    v_mfma_f32_16x16x32_bf16 v[60:63], a[204:207], v[16:19], v[60:63]
    s_waitcnt lgkmcnt(2)
    v_mfma_f32_16x16x32_bf16 v[48:51], a[208:211], v[20:23], v[48:51]
    ds_read_b128 v[16:19], v3 offset:2048
    v_cvt_pk_bf16_f32 v94, v76, v77
    v_mfma_f32_16x16x32_bf16 v[52:55], a[212:215], v[20:23], v[52:55]
    v_mfma_f32_16x16x32_bf16 v[56:59], a[216:219], v[20:23], v[56:59]
    v_cvt_pk_bf16_f32 v95, v78, v79
    v_mfma_f32_16x16x32_bf16 v[60:63], a[220:223], v[20:23], v[60:63]
    s_waitcnt lgkmcnt(2)
    v_mfma_f32_16x16x32_bf16 v[48:51], a[224:227], v[24:27], v[48:51]
    ds_read_b128 v[20:23], v4 offset:2048
    buffer_store_dwordx4 v[92:95], v8, s[16:19], s27 offen offset:2304 sc1
    v_mfma_f32_16x16x32_bf16 v[52:55], a[228:231], v[24:27], v[52:55]
    v_mfma_f32_16x16x32_bf16 v[56:59], a[232:235], v[24:27], v[56:59]
    v_mfma_f32_16x16x32_bf16 v[60:63], a[236:239], v[24:27], v[60:63]
    s_waitcnt lgkmcnt(2)
    v_mfma_f32_16x16x32_bf16 v[48:51], a[240:243], v[28:31], v[48:51]
    ds_read_b128 v[24:27], v3 offset:6144
    v_mfma_f32_16x16x32_bf16 v[52:55], a[244:247], v[28:31], v[52:55]
    v_mfma_f32_16x16x32_bf16 v[56:59], a[248:251], v[28:31], v[56:59]
    v_mfma_f32_16x16x32_bf16 v[60:63], a[252:255], v[28:31], v[60:63]
    s_waitcnt vmcnt(14)
    s_barrier
    s_waitcnt lgkmcnt(2)
    v_mfma_f32_16x16x32_bf16 v[64:67], a[0:3], v[16:19], 0
    ds_read_b128 v[28:31], v4 offset:6144
    v_mfma_f32_16x16x32_bf16 v[68:71], a[4:7], v[16:19], 0
    v_mfma_f32_16x16x32_bf16 v[72:75], a[8:11], v[16:19], 0
    v_mfma_f32_16x16x32_bf16 v[76:79], a[12:15], v[16:19], 0
    v_mul_f32 v48, s30, v48
    s_waitcnt lgkmcnt(2)
    v_mfma_f32_16x16x32_bf16 v[64:67], a[16:19], v[20:23], v[64:67]
    ds_read_b128 v[16:19], v3 offset:10240
    v_mul_f32 v49, s30, v49
    v_mfma_f32_16x16x32_bf16 v[68:71], a[20:23], v[20:23], v[68:71]
    v_mul_f32 v50, s30, v50
    v_mfma_f32_16x16x32_bf16 v[72:75], a[24:27], v[20:23], v[72:75]
    v_mfma_f32_16x16x32_bf16 v[76:79], a[28:31], v[20:23], v[76:79]
    v_mul_f32 v51, s30, v51
    s_waitcnt lgkmcnt(2)
    v_mfma_f32_16x16x32_bf16 v[64:67], a[32:35], v[24:27], v[64:67]
    ds_read_b128 v[20:23], v4 offset:10240
    v_mul_f32 v52, s30, v52
    v_mfma_f32_16x16x32_bf16 v[68:71], a[36:39], v[24:27], v[68:71]
    v_mfma_f32_16x16x32_bf16 v[72:75], a[40:43], v[24:27], v[72:75]
    v_mul_f32 v53, s30, v53
    v_mfma_f32_16x16x32_bf16 v[76:79], a[44:47], v[24:27], v[76:79]
    v_mul_f32 v54, s30, v54
    s_waitcnt lgkmcnt(2)
    v_mfma_f32_16x16x32_bf16 v[64:67], a[48:51], v[28:31], v[64:67]
    ds_read_b128 v[24:27], v3 offset:14336
    v_mfma_f32_16x16x32_bf16 v[68:71], a[52:55], v[28:31], v[68:71]
    v_mul_f32 v55, s30, v55
    v_mfma_f32_16x16x32_bf16 v[72:75], a[56:59], v[28:31], v[72:75]
    v_cvt_pk_bf16_f32 v80, v48, v49
    v_mfma_f32_16x16x32_bf16 v[76:79], a[60:63], v[28:31], v[76:79]
    s_waitcnt lgkmcnt(2)
    v_mfma_f32_16x16x32_bf16 v[64:67], a[64:67], v[16:19], v[64:67]
    ds_read_b128 v[28:31], v4 offset:14336
    v_cvt_pk_bf16_f32 v81, v50, v51
    v_mfma_f32_16x16x32_bf16 v[68:71], a[68:71], v[16:19], v[68:71]
    v_cvt_pk_bf16_f32 v82, v52, v53
    v_mfma_f32_16x16x32_bf16 v[72:75], a[72:75], v[16:19], v[72:75]
    v_mfma_f32_16x16x32_bf16 v[76:79], a[76:79], v[16:19], v[76:79]
    v_cvt_pk_bf16_f32 v83, v54, v55
    s_waitcnt lgkmcnt(2)
    v_mfma_f32_16x16x32_bf16 v[64:67], a[80:83], v[20:23], v[64:67]
    ds_read_b128 v[16:19], v3 offset:18432
    buffer_store_dwordx4 v[80:83], v8, s[16:19], s25 offen offset:0 sc1
    v_mfma_f32_16x16x32_bf16 v[68:71], a[84:87], v[20:23], v[68:71]
    v_mfma_f32_16x16x32_bf16 v[72:75], a[88:91], v[20:23], v[72:75]
    v_mul_f32 v56, s30, v56
    v_mfma_f32_16x16x32_bf16 v[76:79], a[92:95], v[20:23], v[76:79]
    v_mul_f32 v57, s30, v57
    s_waitcnt lgkmcnt(2)
    v_mfma_f32_16x16x32_bf16 v[64:67], a[96:99], v[24:27], v[64:67]
    ds_read_b128 v[20:23], v4 offset:18432
    v_mul_f32 v58, s30, v58
    v_mfma_f32_16x16x32_bf16 v[68:71], a[100:103], v[24:27], v[68:71]
    v_mfma_f32_16x16x32_bf16 v[72:75], a[104:107], v[24:27], v[72:75]
    v_mul_f32 v59, s30, v59
    v_mfma_f32_16x16x32_bf16 v[76:79], a[108:111], v[24:27], v[76:79]
    v_mul_f32 v60, s30, v60
    s_waitcnt lgkmcnt(2)
    v_mfma_f32_16x16x32_bf16 v[64:67], a[112:115], v[28:31], v[64:67]
    ds_read_b128 v[24:27], v3 offset:22528
    v_mfma_f32_16x16x32_bf16 v[68:71], a[116:119], v[28:31], v[68:71]
    v_mul_f32 v61, s30, v61
    v_mfma_f32_16x16x32_bf16 v[72:75], a[120:123], v[28:31], v[72:75]
    v_mul_f32 v62, s30, v62
    v_mfma_f32_16x16x32_bf16 v[76:79], a[124:127], v[28:31], v[76:79]
    s_waitcnt lgkmcnt(2)
    v_mfma_f32_16x16x32_bf16 v[64:67], a[128:131], v[16:19], v[64:67]
    ds_read_b128 v[28:31], v4 offset:22528
    v_mul_f32 v63, s30, v63
    v_mfma_f32_16x16x32_bf16 v[68:71], a[132:135], v[16:19], v[68:71]
    v_cvt_pk_bf16_f32 v84, v56, v57
    v_mfma_f32_16x16x32_bf16 v[72:75], a[136:139], v[16:19], v[72:75]
    v_mfma_f32_16x16x32_bf16 v[76:79], a[140:143], v[16:19], v[76:79]
    v_cvt_pk_bf16_f32 v85, v58, v59
    s_waitcnt lgkmcnt(2)
    v_mfma_f32_16x16x32_bf16 v[64:67], a[144:147], v[20:23], v[64:67]
    ds_read_b128 v[16:19], v3 offset:26624
    v_cvt_pk_bf16_f32 v86, v60, v61
    v_mfma_f32_16x16x32_bf16 v[68:71], a[148:151], v[20:23], v[68:71]
    v_mfma_f32_16x16x32_bf16 v[72:75], a[152:155], v[20:23], v[72:75]
    v_cvt_pk_bf16_f32 v87, v62, v63
    v_mfma_f32_16x16x32_bf16 v[76:79], a[156:159], v[20:23], v[76:79]
    buffer_store_dwordx4 v[84:87], v8, s[16:19], s25 offen offset:2048 sc1
    s_waitcnt lgkmcnt(2)
    v_mfma_f32_16x16x32_bf16 v[64:67], a[160:163], v[24:27], v[64:67]
    ds_read_b128 v[20:23], v4 offset:26624
    v_mfma_f32_16x16x32_bf16 v[68:71], a[164:167], v[24:27], v[68:71]
    v_mfma_f32_16x16x32_bf16 v[72:75], a[168:171], v[24:27], v[72:75]
    s_mov_b32 m0, s26
    v_mfma_f32_16x16x32_bf16 v[76:79], a[172:175], v[24:27], v[76:79]
    buffer_load_dwordx4 v2, s[4:7], s24 offen offset:0 lds
    s_waitcnt lgkmcnt(2)
    v_mfma_f32_16x16x32_bf16 v[64:67], a[176:179], v[28:31], v[64:67]
    ds_read_b128 v[24:27], v3 offset:30720
    s_add_u32 m0, m0, 3968
    v_mfma_f32_16x16x32_bf16 v[68:71], a[180:183], v[28:31], v[68:71]
    buffer_load_dwordx4 v2, s[4:7], s24 offen offset:128 lds
    v_mfma_f32_16x16x32_bf16 v[72:75], a[184:187], v[28:31], v[72:75]
    s_add_u32 m0, m0, 3968
    v_mfma_f32_16x16x32_bf16 v[76:79], a[188:191], v[28:31], v[76:79]
    buffer_load_dwordx4 v2, s[4:7], s24 offen offset:256 lds
    s_waitcnt lgkmcnt(2)
    v_mfma_f32_16x16x32_bf16 v[64:67], a[192:195], v[16:19], v[64:67]
    ds_read_b128 v[28:31], v4 offset:30720
    s_add_u32 m0, m0, 3968
    v_mfma_f32_16x16x32_bf16 v[68:71], a[196:199], v[16:19], v[68:71]
    v_add_u32 v3, 0x8000, v3
    buffer_load_dwordx4 v2, s[4:7], s24 offen offset:384 lds
    v_mfma_f32_16x16x32_bf16 v[72:75], a[200:203], v[16:19], v[72:75]
    v_and_b32 v3, 0x1ffff, v3
    s_add_u32 m0, m0, 3968
    v_mfma_f32_16x16x32_bf16 v[76:79], a[204:207], v[16:19], v[76:79]
    v_xor_b32 v4, 64, v3
    buffer_load_dwordx4 v2, s[4:7], s24 offen offset:512 lds
    s_waitcnt lgkmcnt(2)
    v_mfma_f32_16x16x32_bf16 v[64:67], a[208:211], v[20:23], v[64:67]
    ds_read_b128 v[16:19], v3 offset:0
    s_add_u32 m0, m0, 3968
    v_mfma_f32_16x16x32_bf16 v[68:71], a[212:215], v[20:23], v[68:71]
    buffer_load_dwordx4 v2, s[4:7], s24 offen offset:640 lds
    v_mfma_f32_16x16x32_bf16 v[72:75], a[216:219], v[20:23], v[72:75]
    s_add_u32 m0, m0, 3968
    v_mfma_f32_16x16x32_bf16 v[76:79], a[220:223], v[20:23], v[76:79]
    buffer_load_dwordx4 v2, s[4:7], s24 offen offset:768 lds
    s_waitcnt lgkmcnt(2)
    v_mfma_f32_16x16x32_bf16 v[64:67], a[224:227], v[24:27], v[64:67]
    ds_read_b128 v[20:23], v4 offset:0
    s_add_u32 m0, m0, 3968
    v_mfma_f32_16x16x32_bf16 v[68:71], a[228:231], v[24:27], v[68:71]
    buffer_load_dwordx4 v2, s[4:7], s24 offen offset:896 lds
    v_mfma_f32_16x16x32_bf16 v[72:75], a[232:235], v[24:27], v[72:75]
    v_mfma_f32_16x16x32_bf16 v[76:79], a[236:239], v[24:27], v[76:79]
    s_waitcnt lgkmcnt(2)
    v_mfma_f32_16x16x32_bf16 v[64:67], a[240:243], v[28:31], v[64:67]
    ds_read_b128 v[24:27], v3 offset:4096
    s_add_u32 s24, s24, 0x8000
    s_add_u32 s26, s26, 0x8000
    s_and_b32 s26, s26, 0x1ffff
    v_mfma_f32_16x16x32_bf16 v[68:71], a[244:247], v[28:31], v[68:71]
    s_mov_b32 s27, s25
    s_add_u32 s25, s25, 8192
    v_mfma_f32_16x16x32_bf16 v[72:75], a[248:251], v[28:31], v[72:75]
    v_mfma_f32_16x16x32_bf16 v[76:79], a[252:255], v[28:31], v[76:79]
    s_sub_u32 s23, s23, 1
    s_cmp_lg_u32 s23, 0
    s_cbranch_scc1 K1_LOOP_Q
    s_nop 7
    v_mul_f32 v64, s30, v64
    v_mul_f32 v65, s30, v65
    v_mul_f32 v66, s30, v66
    v_mul_f32 v67, s30, v67
    v_mul_f32 v68, s30, v68
    v_mul_f32 v69, s30, v69
    v_mul_f32 v70, s30, v70
    v_mul_f32 v71, s30, v71
    v_cvt_pk_bf16_f32 v88, v64, v65
    v_cvt_pk_bf16_f32 v89, v66, v67
    v_cvt_pk_bf16_f32 v90, v68, v69
    v_cvt_pk_bf16_f32 v91, v70, v71
    buffer_store_dwordx4 v[88:91], v8, s[16:19], s27 offen offset:256 sc1
    v_mul_f32 v72, s30, v72
    v_mul_f32 v73, s30, v73
    v_mul_f32 v74, s30, v74
    v_mul_f32 v75, s30, v75
    v_mul_f32 v76, s30, v76
    v_mul_f32 v77, s30, v77
    v_mul_f32 v78, s30, v78
    v_mul_f32 v79, s30, v79
    v_cvt_pk_bf16_f32 v92, v72, v73
    v_cvt_pk_bf16_f32 v93, v74, v75
    v_cvt_pk_bf16_f32 v94, v76, v77
    v_cvt_pk_bf16_f32 v95, v78, v79
    buffer_store_dwordx4 v[92:95], v8, s[16:19], s27 offen offset:2304 sc1
    s_endpgm
.p2align 6
K1_LOOP_G:
    s_waitcnt lgkmcnt(2)
    v_mfma_f32_16x16x32_bf16 v[48:51], a[0:3], v[16:19], 0
    ds_read_b128 v[28:31], v4 offset:4096
    v_mfma_f32_16x16x32_bf16 v[52:55], a[4:7], v[16:19], 0
    v_mfma_f32_16x16x32_bf16 v[56:59], a[8:11], v[16:19], 0
    v_mfma_f32_16x16x32_bf16 v[60:63], a[12:15], v[16:19], 0
    v_mul_f32 v96, s31, v64
    s_waitcnt lgkmcnt(2)
    v_mfma_f32_16x16x32_bf16 v[48:51], a[16:19], v[20:23], v[48:51]
    ds_read_b128 v[16:19], v3 offset:8192
    v_mul_f32 v97, s31, v65
    v_mfma_f32_16x16x32_bf16 v[52:55], a[20:23], v[20:23], v[52:55]
    v_mul_f32 v98, s31, v66
    v_mfma_f32_16x16x32_bf16 v[56:59], a[24:27], v[20:23], v[56:59]
    v_mul_f32 v99, s31, v67
    v_mfma_f32_16x16x32_bf16 v[60:63], a[28:31], v[20:23], v[60:63]
    v_exp_f32 v96, v96
    s_waitcnt lgkmcnt(2)
    v_mfma_f32_16x16x32_bf16 v[48:51], a[32:35], v[24:27], v[48:51]
    ds_read_b128 v[20:23], v4 offset:8192
    v_exp_f32 v97, v97
    v_mfma_f32_16x16x32_bf16 v[52:55], a[36:39], v[24:27], v[52:55]
    v_exp_f32 v98, v98
    v_mfma_f32_16x16x32_bf16 v[56:59], a[40:43], v[24:27], v[56:59]
    v_exp_f32 v99, v99
    v_mfma_f32_16x16x32_bf16 v[60:63], a[44:47], v[24:27], v[60:63]
    v_add_f32 v96, 1.0, v96
    s_waitcnt lgkmcnt(2)
    v_mfma_f32_16x16x32_bf16 v[48:51], a[48:51], v[28:31], v[48:51]
    ds_read_b128 v[24:27], v3 offset:12288
    v_add_f32 v97, 1.0, v97
    v_mfma_f32_16x16x32_bf16 v[52:55], a[52:55], v[28:31], v[52:55]
    v_add_f32 v98, 1.0, v98
    v_mfma_f32_16x16x32_bf16 v[56:59], a[56:59], v[28:31], v[56:59]
    v_add_f32 v99, 1.0, v99
    v_mfma_f32_16x16x32_bf16 v[60:63], a[60:63], v[28:31], v[60:63]
    v_rcp_f32 v96, v96
    s_waitcnt lgkmcnt(2)
    v_mfma_f32_16x16x32_bf16 v[48:51], a[64:67], v[16:19], v[48:51]
    ds_read_b128 v[28:31], v4 offset:12288
    v_rcp_f32 v97, v97
    v_mfma_f32_16x16x32_bf16 v[52:55], a[68:71], v[16:19], v[52:55]
    v_rcp_f32 v98, v98
    v_mfma_f32_16x16x32_bf16 v[56:59], a[72:75], v[16:19], v[56:59]
    v_rcp_f32 v99, v99
    v_mfma_f32_16x16x32_bf16 v[60:63], a[76:79], v[16:19], v[60:63]
    v_mul_f32 v64, v64, v72
    s_waitcnt lgkmcnt(2)
    v_mfma_f32_16x16x32_bf16 v[48:51], a[80:83], v[20:23], v[48:51]
    ds_read_b128 v[16:19], v3 offset:16384
    v_mul_f32 v65, v65, v73
    v_mfma_f32_16x16x32_bf16 v[52:55], a[84:87], v[20:23], v[52:55]
    v_mfma_f32_16x16x32_bf16 v[56:59], a[88:91], v[20:23], v[56:59]
    v_mul_f32 v66, v66, v74
    v_mfma_f32_16x16x32_bf16 v[60:63], a[92:95], v[20:23], v[60:63]
    v_mul_f32 v67, v67, v75
    s_waitcnt lgkmcnt(2)
    v_mfma_f32_16x16x32_bf16 v[48:51], a[96:99], v[24:27], v[48:51]
    ds_read_b128 v[20:23], v4 offset:16384
    v_mul_f32 v64, v64, v96
    v_mfma_f32_16x16x32_bf16 v[52:55], a[100:103], v[24:27], v[52:55]
    v_mul_f32 v65, v65, v97
    v_mfma_f32_16x16x32_bf16 v[56:59], a[104:107], v[24:27], v[56:59]
    v_mul_f32 v66, v66, v98
    v_mfma_f32_16x16x32_bf16 v[60:63], a[108:111], v[24:27], v[60:63]
    v_mul_f32 v67, v67, v99
    s_waitcnt lgkmcnt(2)
    v_mfma_f32_16x16x32_bf16 v[48:51], a[112:115], v[28:31], v[48:51]
    ds_read_b128 v[24:27], v3 offset:20480
    v_cvt_pk_bf16_f32 v84, v64, v65
    v_mfma_f32_16x16x32_bf16 v[52:55], a[116:119], v[28:31], v[52:55]
    v_cvt_pk_bf16_f32 v85, v66, v67
    v_mfma_f32_16x16x32_bf16 v[56:59], a[120:123], v[28:31], v[56:59]
    v_mul_f32 v96, s31, v68
    v_mfma_f32_16x16x32_bf16 v[60:63], a[124:127], v[28:31], v[60:63]
    v_mul_f32 v97, s31, v69
    s_waitcnt lgkmcnt(2)
    v_mfma_f32_16x16x32_bf16 v[48:51], a[128:131], v[16:19], v[48:51]
    ds_read_b128 v[28:31], v4 offset:20480
    v_mul_f32 v98, s31, v70
    v_mfma_f32_16x16x32_bf16 v[52:55], a[132:135], v[16:19], v[52:55]
    v_mul_f32 v99, s31, v71
    v_mfma_f32_16x16x32_bf16 v[56:59], a[136:139], v[16:19], v[56:59]
    v_exp_f32 v96, v96
    v_mfma_f32_16x16x32_bf16 v[60:63], a[140:143], v[16:19], v[60:63]
    v_exp_f32 v97, v97
    s_waitcnt lgkmcnt(2)
    v_mfma_f32_16x16x32_bf16 v[48:51], a[144:147], v[20:23], v[48:51]
    ds_read_b128 v[16:19], v3 offset:24576
    v_exp_f32 v98, v98
    v_mfma_f32_16x16x32_bf16 v[52:55], a[148:151], v[20:23], v[52:55]
    v_exp_f32 v99, v99
    v_mfma_f32_16x16x32_bf16 v[56:59], a[152:155], v[20:23], v[56:59]
    v_add_f32 v96, 1.0, v96
    v_mfma_f32_16x16x32_bf16 v[60:63], a[156:159], v[20:23], v[60:63]
    v_add_f32 v97, 1.0, v97
    s_waitcnt lgkmcnt(2)
    v_mfma_f32_16x16x32_bf16 v[48:51], a[160:163], v[24:27], v[48:51]
    ds_read_b128 v[20:23], v4 offset:24576
    v_mfma_f32_16x16x32_bf16 v[52:55], a[164:167], v[24:27], v[52:55]
    v_add_f32 v98, 1.0, v98
    v_mfma_f32_16x16x32_bf16 v[56:59], a[168:171], v[24:27], v[56:59]
    v_add_f32 v99, 1.0, v99
    v_mfma_f32_16x16x32_bf16 v[60:63], a[172:175], v[24:27], v[60:63]
    v_rcp_f32 v96, v96
    s_waitcnt lgkmcnt(2)
    v_mfma_f32_16x16x32_bf16 v[48:51], a[176:179], v[28:31], v[48:51]
    ds_read_b128 v[24:27], v3 offset:28672
    v_rcp_f32 v97, v97
    v_mfma_f32_16x16x32_bf16 v[52:55], a[180:183], v[28:31], v[52:55]
    v_rcp_f32 v98, v98
    v_mfma_f32_16x16x32_bf16 v[56:59], a[184:187], v[28:31], v[56:59]
    v_rcp_f32 v99, v99
    v_mfma_f32_16x16x32_bf16 v[60:63], a[188:191], v[28:31], v[60:63]
    v_mul_f32 v68, v68, v76
    s_waitcnt lgkmcnt(2)
    v_mfma_f32_16x16x32_bf16 v[48:51], a[192:195], v[16:19], v[48:51]
    ds_read_b128 v[28:31], v4 offset:28672
    v_mul_f32 v69, v69, v77
    v_mfma_f32_16x16x32_bf16 v[52:55], a[196:199], v[16:19], v[52:55]
    v_mul_f32 v70, v70, v78
    v_mfma_f32_16x16x32_bf16 v[56:59], a[200:203], v[16:19], v[56:59]
    v_mul_f32 v71, v71, v79
    v_mfma_f32_16x16x32_bf16 v[60:63], a[204:207], v[16:19], v[60:63]
    v_mul_f32 v68, v68, v96
    s_waitcnt lgkmcnt(2)
    v_mfma_f32_16x16x32_bf16 v[48:51], a[208:211], v[20:23], v[48:51]
    ds_read_b128 v[16:19], v3 offset:2048
    v_mul_f32 v69, v69, v97
    v_mfma_f32_16x16x32_bf16 v[52:55], a[212:215], v[20:23], v[52:55]
    v_mul_f32 v70, v70, v98
    v_mfma_f32_16x16x32_bf16 v[56:59], a[216:219], v[20:23], v[56:59]
    v_mul_f32 v71, v71, v99
    v_mfma_f32_16x16x32_bf16 v[60:63], a[220:223], v[20:23], v[60:63]
    v_cvt_pk_bf16_f32 v86, v68, v69
    s_waitcnt lgkmcnt(2)
    v_mfma_f32_16x16x32_bf16 v[48:51], a[224:227], v[24:27], v[48:51]
    ds_read_b128 v[20:23], v4 offset:2048
    v_cvt_pk_bf16_f32 v87, v70, v71
    v_mfma_f32_16x16x32_bf16 v[52:55], a[228:231], v[24:27], v[52:55]
    buffer_store_dwordx4 v[84:87], v8, s[16:19], s29 offen offset:0 sc1
    v_mfma_f32_16x16x32_bf16 v[56:59], a[232:235], v[24:27], v[56:59]
    v_mfma_f32_16x16x32_bf16 v[60:63], a[236:239], v[24:27], v[60:63]
    s_waitcnt lgkmcnt(2)
    v_mfma_f32_16x16x32_bf16 v[48:51], a[240:243], v[28:31], v[48:51]
    ds_read_b128 v[24:27], v3 offset:6144
    v_mfma_f32_16x16x32_bf16 v[52:55], a[244:247], v[28:31], v[52:55]
    v_mfma_f32_16x16x32_bf16 v[56:59], a[248:251], v[28:31], v[56:59]
    v_mfma_f32_16x16x32_bf16 v[60:63], a[252:255], v[28:31], v[60:63]
    s_waitcnt vmcnt(11)
    s_barrier
    s_waitcnt lgkmcnt(2)
    v_mfma_f32_16x16x32_bf16 v[64:67], a[0:3], v[16:19], 0
    ds_read_b128 v[28:31], v4 offset:6144
    v_mfma_f32_16x16x32_bf16 v[68:71], a[4:7], v[16:19], 0
    v_mfma_f32_16x16x32_bf16 v[72:75], a[8:11], v[16:19], 0
    v_mfma_f32_16x16x32_bf16 v[76:79], a[12:15], v[16:19], 0
    v_mul_f32 v96, s31, v48
    v_mul_f32 v97, s31, v49
    s_waitcnt lgkmcnt(2)
    v_mfma_f32_16x16x32_bf16 v[64:67], a[16:19], v[20:23], v[64:67]
    ds_read_b128 v[16:19], v3 offset:10240
    v_mul_f32 v98, s31, v50
    v_mfma_f32_16x16x32_bf16 v[68:71], a[20:23], v[20:23], v[68:71]
    v_mul_f32 v99, s31, v51
    v_exp_f32 v96, v96
    v_mfma_f32_16x16x32_bf16 v[72:75], a[24:27], v[20:23], v[72:75]
    v_exp_f32 v97, v97
    v_mfma_f32_16x16x32_bf16 v[76:79], a[28:31], v[20:23], v[76:79]
    v_exp_f32 v98, v98
    s_waitcnt lgkmcnt(2)
    v_mfma_f32_16x16x32_bf16 v[64:67], a[32:35], v[24:27], v[64:67]
    ds_read_b128 v[20:23], v4 offset:10240
    v_exp_f32 v99, v99
    v_add_f32 v96, 1.0, v96
    v_mfma_f32_16x16x32_bf16 v[68:71], a[36:39], v[24:27], v[68:71]
    v_add_f32 v97, 1.0, v97
    v_mfma_f32_16x16x32_bf16 v[72:75], a[40:43], v[24:27], v[72:75]
    v_add_f32 v98, 1.0, v98
    v_add_f32 v99, 1.0, v99
    v_mfma_f32_16x16x32_bf16 v[76:79], a[44:47], v[24:27], v[76:79]
    v_rcp_f32 v96, v96
    s_waitcnt lgkmcnt(2)
    v_mfma_f32_16x16x32_bf16 v[64:67], a[48:51], v[28:31], v[64:67]
    ds_read_b128 v[24:27], v3 offset:14336
    v_rcp_f32 v97, v97
    v_mfma_f32_16x16x32_bf16 v[68:71], a[52:55], v[28:31], v[68:71]
    v_rcp_f32 v98, v98
    v_rcp_f32 v99, v99
    v_mfma_f32_16x16x32_bf16 v[72:75], a[56:59], v[28:31], v[72:75]
    v_mul_f32 v48, v48, v56
    v_mfma_f32_16x16x32_bf16 v[76:79], a[60:63], v[28:31], v[76:79]
    v_mul_f32 v49, v49, v57
    v_mul_f32 v50, v50, v58
    s_waitcnt lgkmcnt(2)
    v_mfma_f32_16x16x32_bf16 v[64:67], a[64:67], v[16:19], v[64:67]
    ds_read_b128 v[28:31], v4 offset:14336
    v_mul_f32 v51, v51, v59
    v_mfma_f32_16x16x32_bf16 v[68:71], a[68:71], v[16:19], v[68:71]
    v_mul_f32 v48, v48, v96
    v_mfma_f32_16x16x32_bf16 v[72:75], a[72:75], v[16:19], v[72:75]
    v_mul_f32 v49, v49, v97
    v_mul_f32 v50, v50, v98
    v_mfma_f32_16x16x32_bf16 v[76:79], a[76:79], v[16:19], v[76:79]
    v_mul_f32 v51, v51, v99
    s_waitcnt lgkmcnt(2)
    v_mfma_f32_16x16x32_bf16 v[64:67], a[80:83], v[20:23], v[64:67]
    ds_read_b128 v[16:19], v3 offset:18432
    v_cvt_pk_bf16_f32 v80, v48, v49
    v_cvt_pk_bf16_f32 v81, v50, v51
    v_mfma_f32_16x16x32_bf16 v[68:71], a[84:87], v[20:23], v[68:71]
    v_mul_f32 v96, s31, v52
    v_mfma_f32_16x16x32_bf16 v[72:75], a[88:91], v[20:23], v[72:75]
    v_mul_f32 v97, s31, v53
    v_mfma_f32_16x16x32_bf16 v[76:79], a[92:95], v[20:23], v[76:79]
    v_mul_f32 v98, s31, v54
    v_mul_f32 v99, s31, v55
    s_waitcnt lgkmcnt(2)
    v_mfma_f32_16x16x32_bf16 v[64:67], a[96:99], v[24:27], v[64:67]
    ds_read_b128 v[20:23], v4 offset:18432
    v_exp_f32 v96, v96
    v_mfma_f32_16x16x32_bf16 v[68:71], a[100:103], v[24:27], v[68:71]
    v_exp_f32 v97, v97
    v_exp_f32 v98, v98
    v_mfma_f32_16x16x32_bf16 v[72:75], a[104:107], v[24:27], v[72:75]
    v_exp_f32 v99, v99
    v_mfma_f32_16x16x32_bf16 v[76:79], a[108:111], v[24:27], v[76:79]
    v_add_f32 v96, 1.0, v96
    s_waitcnt lgkmcnt(2)
    v_mfma_f32_16x16x32_bf16 v[64:67], a[112:115], v[28:31], v[64:67]
    ds_read_b128 v[24:27], v3 offset:22528
    v_add_f32 v97, 1.0, v97
    v_add_f32 v98, 1.0, v98
    v_mfma_f32_16x16x32_bf16 v[68:71], a[116:119], v[28:31], v[68:71]
    v_add_f32 v99, 1.0, v99
    v_mfma_f32_16x16x32_bf16 v[72:75], a[120:123], v[28:31], v[72:75]
    v_rcp_f32 v96, v96
    v_rcp_f32 v97, v97
    v_mfma_f32_16x16x32_bf16 v[76:79], a[124:127], v[28:31], v[76:79]
    v_rcp_f32 v98, v98
    s_waitcnt lgkmcnt(2)
    v_mfma_f32_16x16x32_bf16 v[64:67], a[128:131], v[16:19], v[64:67]
    ds_read_b128 v[28:31], v4 offset:22528
    v_rcp_f32 v99, v99
    v_mfma_f32_16x16x32_bf16 v[68:71], a[132:135], v[16:19], v[68:71]
    v_mul_f32 v52, v52, v60
    v_mul_f32 v53, v53, v61
    v_mfma_f32_16x16x32_bf16 v[72:75], a[136:139], v[16:19], v[72:75]
    v_mul_f32 v54, v54, v62
    v_mfma_f32_16x16x32_bf16 v[76:79], a[140:143], v[16:19], v[76:79]
    v_mul_f32 v55, v55, v63
    v_mul_f32 v52, v52, v96
    s_waitcnt lgkmcnt(2)
    v_mfma_f32_16x16x32_bf16 v[64:67], a[144:147], v[20:23], v[64:67]
    ds_read_b128 v[16:19], v3 offset:26624
    v_mul_f32 v53, v53, v97
    v_mfma_f32_16x16x32_bf16 v[68:71], a[148:151], v[20:23], v[68:71]
    v_mul_f32 v54, v54, v98
    v_mfma_f32_16x16x32_bf16 v[72:75], a[152:155], v[20:23], v[72:75]
    v_mul_f32 v55, v55, v99
    v_cvt_pk_bf16_f32 v82, v52, v53
    v_mfma_f32_16x16x32_bf16 v[76:79], a[156:159], v[20:23], v[76:79]
    v_cvt_pk_bf16_f32 v83, v54, v55
    s_waitcnt lgkmcnt(2)
    v_mfma_f32_16x16x32_bf16 v[64:67], a[160:163], v[24:27], v[64:67]
    ds_read_b128 v[20:23], v4 offset:26624
    buffer_store_dwordx4 v[80:83], v8, s[16:19], s25 offen offset:0 sc1
    v_mfma_f32_16x16x32_bf16 v[68:71], a[164:167], v[24:27], v[68:71]
    v_mfma_f32_16x16x32_bf16 v[72:75], a[168:171], v[24:27], v[72:75]
    s_mov_b32 m0, s26
    v_mfma_f32_16x16x32_bf16 v[76:79], a[172:175], v[24:27], v[76:79]
    buffer_load_dwordx4 v2, s[4:7], s24 offen offset:0 lds
    s_waitcnt lgkmcnt(2)
    v_mfma_f32_16x16x32_bf16 v[64:67], a[176:179], v[28:31], v[64:67]
    ds_read_b128 v[24:27], v3 offset:30720
    s_add_u32 m0, m0, 3968
    v_mfma_f32_16x16x32_bf16 v[68:71], a[180:183], v[28:31], v[68:71]
    buffer_load_dwordx4 v2, s[4:7], s24 offen offset:128 lds
    v_mfma_f32_16x16x32_bf16 v[72:75], a[184:187], v[28:31], v[72:75]
    s_add_u32 m0, m0, 3968
    v_mfma_f32_16x16x32_bf16 v[76:79], a[188:191], v[28:31], v[76:79]
    buffer_load_dwordx4 v2, s[4:7], s24 offen offset:256 lds
    s_waitcnt lgkmcnt(2)
    v_mfma_f32_16x16x32_bf16 v[64:67], a[192:195], v[16:19], v[64:67]
    ds_read_b128 v[28:31], v4 offset:30720
    s_add_u32 m0, m0, 3968
    v_mfma_f32_16x16x32_bf16 v[68:71], a[196:199], v[16:19], v[68:71]
    v_add_u32 v3, 0x8000, v3
    buffer_load_dwordx4 v2, s[4:7], s24 offen offset:384 lds
    v_mfma_f32_16x16x32_bf16 v[72:75], a[200:203], v[16:19], v[72:75]
    v_and_b32 v3, 0x1ffff, v3
    s_add_u32 m0, m0, 3968
    v_mfma_f32_16x16x32_bf16 v[76:79], a[204:207], v[16:19], v[76:79]
    v_xor_b32 v4, 64, v3
    buffer_load_dwordx4 v2, s[4:7], s24 offen offset:512 lds
    s_waitcnt lgkmcnt(2)
    v_mfma_f32_16x16x32_bf16 v[64:67], a[208:211], v[20:23], v[64:67]
    ds_read_b128 v[16:19], v3 offset:0
    s_add_u32 m0, m0, 3968
    v_mfma_f32_16x16x32_bf16 v[68:71], a[212:215], v[20:23], v[68:71]
    buffer_load_dwordx4 v2, s[4:7], s24 offen offset:640 lds
    v_mfma_f32_16x16x32_bf16 v[72:75], a[216:219], v[20:23], v[72:75]
    s_add_u32 m0, m0, 3968
    v_mfma_f32_16x16x32_bf16 v[76:79], a[220:223], v[20:23], v[76:79]
    buffer_load_dwordx4 v2, s[4:7], s24 offen offset:768 lds
    s_waitcnt lgkmcnt(2)
    v_mfma_f32_16x16x32_bf16 v[64:67], a[224:227], v[24:27], v[64:67]
    ds_read_b128 v[20:23], v4 offset:0
    s_add_u32 m0, m0, 3968
    v_mfma_f32_16x16x32_bf16 v[68:71], a[228:231], v[24:27], v[68:71]
    buffer_load_dwordx4 v2, s[4:7], s24 offen offset:896 lds
    v_mfma_f32_16x16x32_bf16 v[72:75], a[232:235], v[24:27], v[72:75]
    v_mfma_f32_16x16x32_bf16 v[76:79], a[236:239], v[24:27], v[76:79]
    s_waitcnt lgkmcnt(2)
    v_mfma_f32_16x16x32_bf16 v[64:67], a[240:243], v[28:31], v[64:67]
    ds_read_b128 v[24:27], v3 offset:4096
    s_add_u32 s24, s24, 0x8000
    s_add_u32 s26, s26, 0x8000
    s_and_b32 s26, s26, 0x1ffff
    v_mfma_f32_16x16x32_bf16 v[68:71], a[244:247], v[28:31], v[68:71]
    s_add_u32 s29, s25, 44032
    s_add_u32 s25, s25, 88064
    v_mfma_f32_16x16x32_bf16 v[72:75], a[248:251], v[28:31], v[72:75]
    v_mfma_f32_16x16x32_bf16 v[76:79], a[252:255], v[28:31], v[76:79]
    s_sub_u32 s23, s23, 1
    s_cmp_lg_u32 s23, 0
    s_cbranch_scc1 K1_LOOP_G
    s_nop 7
    v_mul_f32 v96, s31, v64
    v_mul_f32 v97, s31, v65
    v_mul_f32 v98, s31, v66
    v_mul_f32 v99, s31, v67
    v_exp_f32 v96, v96
    v_exp_f32 v97, v97
    v_exp_f32 v98, v98
    v_exp_f32 v99, v99
    v_add_f32 v96, 1.0, v96
    v_add_f32 v97, 1.0, v97
    v_add_f32 v98, 1.0, v98
    v_add_f32 v99, 1.0, v99
    v_rcp_f32 v96, v96
    v_rcp_f32 v97, v97
    v_rcp_f32 v98, v98
    v_rcp_f32 v99, v99
    v_mul_f32 v64, v64, v72
    v_mul_f32 v65, v65, v73
    v_mul_f32 v66, v66, v74
    v_mul_f32 v67, v67, v75
    v_mul_f32 v64, v64, v96
    v_mul_f32 v65, v65, v97
    v_mul_f32 v66, v66, v98
    v_mul_f32 v67, v67, v99
    v_cvt_pk_bf16_f32 v84, v64, v65
    v_cvt_pk_bf16_f32 v85, v66, v67
    v_mul_f32 v96, s31, v68
    v_mul_f32 v97, s31, v69
    v_mul_f32 v98, s31, v70
    v_mul_f32 v99, s31, v71
    v_exp_f32 v96, v96
    v_exp_f32 v97, v97
    v_exp_f32 v98, v98
    v_exp_f32 v99, v99
    v_add_f32 v96, 1.0, v96
    v_add_f32 v97, 1.0, v97
    v_add_f32 v98, 1.0, v98
    v_add_f32 v99, 1.0, v99
    v_rcp_f32 v96, v96
    v_rcp_f32 v97, v97
    v_rcp_f32 v98, v98
    v_rcp_f32 v99, v99
    v_mul_f32 v68, v68, v76
    v_mul_f32 v69, v69, v77
    v_mul_f32 v70, v70, v78
    v_mul_f32 v71, v71, v79
    v_mul_f32 v68, v68, v96
    v_mul_f32 v69, v69, v97
    v_mul_f32 v70, v70, v98
    v_mul_f32 v71, v71, v99
    v_cvt_pk_bf16_f32 v86, v68, v69
    v_cvt_pk_bf16_f32 v87, v70, v71
    buffer_store_dwordx4 v[84:87], v8, s[16:19], s29 offen offset:0 sc1
    s_endpgm
K1_AUX:
    s_load_dwordx2 s[40:41], s[0:1], 40
    s_load_dwordx2 s[42:43], s[0:1], 72
    s_sub_u32 s57, s54, 4
    s_lshl_b32 s57, s57, 2
    s_cmp_eq_u32 s55, 7
    s_cselect_b32 s57, s57, 16
    s_add_u32 s57, s57, s56
    s_lshl_b32 s57, s57, 2
    s_add_u32 s57, s57, s20
    s_mul_i32 s58, s20, 40960
    s_waitcnt lgkmcnt(0)
    s_mov_b32 s4, s40
    s_and_b32 s5, s41, 0xffff
    s_mov_b32 s6, 4194304
    s_mov_b32 s7, 0x20000
    s_mov_b32 s8, s42
    s_and_b32 s9, s43, 0xffff
    s_mov_b32 s10, 1409024
    s_mov_b32 s11, 0x20000
    s_add_u32 s16, s52, 100663296
    s_addc_u32 s17, s53, 0
    s_and_b32 s17, s17, 0xffff
    s_mov_b32 s18, 5636096
    s_mov_b32 s19, 0x20000
    v_lshrrev_b32 v9, 1, v1
    v_and_b32 v18, 1, v1
    v_lshlrev_b32 v18, 4, v18
    v_xor_b32 v10, 0, v9
    v_lshl_add_u32 v10, v10, 5, v18
    v_xor_b32 v11, 1, v9
    v_lshl_add_u32 v11, v11, 5, v18
    v_xor_b32 v12, 2, v9
    v_lshl_add_u32 v12, v12, 5, v18
    v_xor_b32 v13, 3, v9
    v_lshl_add_u32 v13, v13, 5, v18
    v_xor_b32 v14, 4, v9
    v_lshl_add_u32 v14, v14, 5, v18
    v_xor_b32 v15, 5, v9
    v_lshl_add_u32 v15, v15, 5, v18
    v_xor_b32 v16, 6, v9
    v_lshl_add_u32 v16, v16, 5, v18
    v_xor_b32 v17, 7, v9
    v_lshl_add_u32 v17, v17, 5, v18
    v_and_b32 v2, 15, v1
    v_lshrrev_b32 v3, 4, v1
    v_lshrrev_b32 v4, 2, v2
    v_lshl_add_u32 v5, v3, 2, v4
    v_and_b32 v6, 7, v5
    v_lshlrev_b32 v5, 10, v5
    v_and_b32 v7, 3, v2
    v_lshl_add_u32 v5, v7, 3, v5
    v_add_u32 v5, s58, v5
    v_xor_b32 v7, 0, v6
    v_lshl_add_u32 v20, v7, 5, v5
    v_xor_b32 v7, 1, v6
    v_lshl_add_u32 v21, v7, 5, v5
    v_xor_b32 v7, 2, v6
    v_lshl_add_u32 v22, v7, 5, v5
    v_xor_b32 v7, 3, v6
    v_lshl_add_u32 v23, v7, 5, v5
    v_xor_b32 v7, 4, v6
    v_lshl_add_u32 v24, v7, 5, v5
    v_xor_b32 v7, 5, v6
    v_lshl_add_u32 v25, v7, 5, v5
    v_xor_b32 v7, 6, v6
    v_lshl_add_u32 v26, v7, 5, v5
    v_xor_b32 v7, 7, v6
    v_lshl_add_u32 v27, v7, 5, v5
    v_lshlrev_b32 v8, 4, v1
K1_AUXL:
    s_cmp_ge_u32 s57, 171
    s_cbranch_scc1 K1_AUXE
    s_cmp_lt_u32 s57, 128
    s_cselect_b32 s12, s4, s8
    s_cselect_b32 s13, s5, s9
    s_cselect_b32 s14, s6, s10
    s_cselect_b32 s15, s7, s11
    s_mov_b32 s15, 0x20000
    s_and_b32 s59, s57, 127
    s_lshl_b32 s59, s59, 15
    s_mov_b32 m0, s58
    s_nop 0
    buffer_load_dwordx4 v10, s[12:15], s59 offen lds
    s_add_u32 m0, m0, 1024
    s_add_u32 s59, s59, 1024
    buffer_load_dwordx4 v11, s[12:15], s59 offen lds
    s_add_u32 m0, m0, 1024
    s_add_u32 s59, s59, 1024
    buffer_load_dwordx4 v12, s[12:15], s59 offen lds
    s_add_u32 m0, m0, 1024
    s_add_u32 s59, s59, 1024
    buffer_load_dwordx4 v13, s[12:15], s59 offen lds
    s_add_u32 m0, m0, 1024
    s_add_u32 s59, s59, 1024
    buffer_load_dwordx4 v14, s[12:15], s59 offen lds
    s_add_u32 m0, m0, 1024
    s_add_u32 s59, s59, 1024
    buffer_load_dwordx4 v15, s[12:15], s59 offen lds
    s_add_u32 m0, m0, 1024
    s_add_u32 s59, s59, 1024
    buffer_load_dwordx4 v16, s[12:15], s59 offen lds
    s_add_u32 m0, m0, 1024
    s_add_u32 s59, s59, 1024
    buffer_load_dwordx4 v17, s[12:15], s59 offen lds
    s_add_u32 m0, m0, 1024
    s_add_u32 s59, s59, 1024
    buffer_load_dwordx4 v10, s[12:15], s59 offen lds
    s_add_u32 m0, m0, 1024
    s_add_u32 s59, s59, 1024
    buffer_load_dwordx4 v11, s[12:15], s59 offen lds
    s_add_u32 m0, m0, 1024
    s_add_u32 s59, s59, 1024
    buffer_load_dwordx4 v12, s[12:15], s59 offen lds
    s_add_u32 m0, m0, 1024
    s_add_u32 s59, s59, 1024
    buffer_load_dwordx4 v13, s[12:15], s59 offen lds
    s_add_u32 m0, m0, 1024
    s_add_u32 s59, s59, 1024
    buffer_load_dwordx4 v14, s[12:15], s59 offen lds
    s_add_u32 m0, m0, 1024
    s_add_u32 s59, s59, 1024
    buffer_load_dwordx4 v15, s[12:15], s59 offen lds
    s_add_u32 m0, m0, 1024
    s_add_u32 s59, s59, 1024
    buffer_load_dwordx4 v16, s[12:15], s59 offen lds
    s_add_u32 m0, m0, 1024
    s_add_u32 s59, s59, 1024
    buffer_load_dwordx4 v17, s[12:15], s59 offen lds
    s_add_u32 m0, m0, 1024
    s_add_u32 s59, s59, 1024
    buffer_load_dwordx4 v10, s[12:15], s59 offen lds
    s_add_u32 m0, m0, 1024
    s_add_u32 s59, s59, 1024
    buffer_load_dwordx4 v11, s[12:15], s59 offen lds
    s_add_u32 m0, m0, 1024
    s_add_u32 s59, s59, 1024
    buffer_load_dwordx4 v12, s[12:15], s59 offen lds
    s_add_u32 m0, m0, 1024
    s_add_u32 s59, s59, 1024
    buffer_load_dwordx4 v13, s[12:15], s59 offen lds
    s_add_u32 m0, m0, 1024
    s_add_u32 s59, s59, 1024
    buffer_load_dwordx4 v14, s[12:15], s59 offen lds
    s_add_u32 m0, m0, 1024
    s_add_u32 s59, s59, 1024
    buffer_load_dwordx4 v15, s[12:15], s59 offen lds
    s_add_u32 m0, m0, 1024
    s_add_u32 s59, s59, 1024
    buffer_load_dwordx4 v16, s[12:15], s59 offen lds
    s_add_u32 m0, m0, 1024
    s_add_u32 s59, s59, 1024
    buffer_load_dwordx4 v17, s[12:15], s59 offen lds
    s_add_u32 m0, m0, 1024
    s_add_u32 s59, s59, 1024
    buffer_load_dwordx4 v10, s[12:15], s59 offen lds
    s_add_u32 m0, m0, 1024
    s_add_u32 s59, s59, 1024
    buffer_load_dwordx4 v11, s[12:15], s59 offen lds
    s_add_u32 m0, m0, 1024
    s_add_u32 s59, s59, 1024
    buffer_load_dwordx4 v12, s[12:15], s59 offen lds
    s_add_u32 m0, m0, 1024
    s_add_u32 s59, s59, 1024
    buffer_load_dwordx4 v13, s[12:15], s59 offen lds
    s_add_u32 m0, m0, 1024
    s_add_u32 s59, s59, 1024
    buffer_load_dwordx4 v14, s[12:15], s59 offen lds
    s_add_u32 m0, m0, 1024
    s_add_u32 s59, s59, 1024
    buffer_load_dwordx4 v15, s[12:15], s59 offen lds
    s_add_u32 m0, m0, 1024
    s_add_u32 s59, s59, 1024
    buffer_load_dwordx4 v16, s[12:15], s59 offen lds
    s_add_u32 m0, m0, 1024
    s_add_u32 s59, s59, 1024
    buffer_load_dwordx4 v17, s[12:15], s59 offen lds
    s_add_u32 m0, m0, 1024
    s_add_u32 s59, s59, 1024
    s_lshl_b32 s60, s57, 12
    s_waitcnt vmcnt(0)
    ds_read_b64_tr_b16 v[64:65], v20 offset:0
    ds_read_b64_tr_b16 v[66:67], v20 offset:16384
    ds_read_b64_tr_b16 v[68:69], v21 offset:0
    ds_read_b64_tr_b16 v[70:71], v21 offset:16384
    ds_read_b64_tr_b16 v[72:73], v22 offset:0
    ds_read_b64_tr_b16 v[74:75], v22 offset:16384
    ds_read_b64_tr_b16 v[76:77], v23 offset:0
    ds_read_b64_tr_b16 v[78:79], v23 offset:16384
    s_waitcnt lgkmcnt(0)
    buffer_store_dwordx4 v[64:67], v8, s[16:19], s60 offen offset:0 sc1
    buffer_store_dwordx4 v[68:71], v8, s[16:19], s60 offen offset:1024 sc1
    buffer_store_dwordx4 v[72:75], v8, s[16:19], s60 offen offset:2048 sc1
    buffer_store_dwordx4 v[76:79], v8, s[16:19], s60 offen offset:3072 sc1
    s_add_u32 s60, s60, 704512
    ds_read_b64_tr_b16 v[80:81], v24 offset:0
    ds_read_b64_tr_b16 v[82:83], v24 offset:16384
    ds_read_b64_tr_b16 v[84:85], v25 offset:0
    ds_read_b64_tr_b16 v[86:87], v25 offset:16384
    ds_read_b64_tr_b16 v[88:89], v26 offset:0
    ds_read_b64_tr_b16 v[90:91], v26 offset:16384
    ds_read_b64_tr_b16 v[92:93], v27 offset:0
    ds_read_b64_tr_b16 v[94:95], v27 offset:16384
    s_waitcnt lgkmcnt(0)
    buffer_store_dwordx4 v[80:83], v8, s[16:19], s60 offen offset:0 sc1
    buffer_store_dwordx4 v[84:87], v8, s[16:19], s60 offen offset:1024 sc1
    buffer_store_dwordx4 v[88:91], v8, s[16:19], s60 offen offset:2048 sc1
    buffer_store_dwordx4 v[92:95], v8, s[16:19], s60 offen offset:3072 sc1
    s_add_u32 s60, s60, 704512
    ds_read_b64_tr_b16 v[96:97], v20 offset:256
    ds_read_b64_tr_b16 v[98:99], v20 offset:16640
    ds_read_b64_tr_b16 v[100:101], v21 offset:256
    ds_read_b64_tr_b16 v[102:103], v21 offset:16640
    ds_read_b64_tr_b16 v[104:105], v22 offset:256
    ds_read_b64_tr_b16 v[106:107], v22 offset:16640
    ds_read_b64_tr_b16 v[108:109], v23 offset:256
    ds_read_b64_tr_b16 v[110:111], v23 offset:16640
    s_waitcnt lgkmcnt(0)
    buffer_store_dwordx4 v[96:99], v8, s[16:19], s60 offen offset:0 sc1
    buffer_store_dwordx4 v[100:103], v8, s[16:19], s60 offen offset:1024 sc1
    buffer_store_dwordx4 v[104:107], v8, s[16:19], s60 offen offset:2048 sc1
    buffer_store_dwordx4 v[108:111], v8, s[16:19], s60 offen offset:3072 sc1
    s_add_u32 s60, s60, 704512
    ds_read_b64_tr_b16 v[112:113], v24 offset:256
    ds_read_b64_tr_b16 v[114:115], v24 offset:16640
    ds_read_b64_tr_b16 v[116:117], v25 offset:256
    ds_read_b64_tr_b16 v[118:119], v25 offset:16640
    ds_read_b64_tr_b16 v[120:121], v26 offset:256
    ds_read_b64_tr_b16 v[122:123], v26 offset:16640
    ds_read_b64_tr_b16 v[124:125], v27 offset:256
    ds_read_b64_tr_b16 v[126:127], v27 offset:16640
    s_waitcnt lgkmcnt(0)
    buffer_store_dwordx4 v[112:115], v8, s[16:19], s60 offen offset:0 sc1
    buffer_store_dwordx4 v[116:119], v8, s[16:19], s60 offen offset:1024 sc1
    buffer_store_dwordx4 v[120:123], v8, s[16:19], s60 offen offset:2048 sc1
    buffer_store_dwordx4 v[124:127], v8, s[16:19], s60 offen offset:3072 sc1
    s_add_u32 s60, s60, 704512
    ds_read_b64_tr_b16 v[64:65], v20 offset:512
    ds_read_b64_tr_b16 v[66:67], v20 offset:16896
    ds_read_b64_tr_b16 v[68:69], v21 offset:512
    ds_read_b64_tr_b16 v[70:71], v21 offset:16896
    ds_read_b64_tr_b16 v[72:73], v22 offset:512
    ds_read_b64_tr_b16 v[74:75], v22 offset:16896
    ds_read_b64_tr_b16 v[76:77], v23 offset:512
    ds_read_b64_tr_b16 v[78:79], v23 offset:16896
    s_waitcnt lgkmcnt(0)
    buffer_store_dwordx4 v[64:67], v8, s[16:19], s60 offen offset:0 sc1
    buffer_store_dwordx4 v[68:71], v8, s[16:19], s60 offen offset:1024 sc1
    buffer_store_dwordx4 v[72:75], v8, s[16:19], s60 offen offset:2048 sc1
    buffer_store_dwordx4 v[76:79], v8, s[16:19], s60 offen offset:3072 sc1
    s_add_u32 s60, s60, 704512
    ds_read_b64_tr_b16 v[80:81], v24 offset:512
    ds_read_b64_tr_b16 v[82:83], v24 offset:16896
    ds_read_b64_tr_b16 v[84:85], v25 offset:512
    ds_read_b64_tr_b16 v[86:87], v25 offset:16896
    ds_read_b64_tr_b16 v[88:89], v26 offset:512
    ds_read_b64_tr_b16 v[90:91], v26 offset:16896
    ds_read_b64_tr_b16 v[92:93], v27 offset:512
    ds_read_b64_tr_b16 v[94:95], v27 offset:16896
    s_waitcnt lgkmcnt(0)
    buffer_store_dwordx4 v[80:83], v8, s[16:19], s60 offen offset:0 sc1
    buffer_store_dwordx4 v[84:87], v8, s[16:19], s60 offen offset:1024 sc1
    buffer_store_dwordx4 v[88:91], v8, s[16:19], s60 offen offset:2048 sc1
    buffer_store_dwordx4 v[92:95], v8, s[16:19], s60 offen offset:3072 sc1
    s_add_u32 s60, s60, 704512
    ds_read_b64_tr_b16 v[96:97], v20 offset:768
    ds_read_b64_tr_b16 v[98:99], v20 offset:17152
    ds_read_b64_tr_b16 v[100:101], v21 offset:768
    ds_read_b64_tr_b16 v[102:103], v21 offset:17152
    ds_read_b64_tr_b16 v[104:105], v22 offset:768
    ds_read_b64_tr_b16 v[106:107], v22 offset:17152
    ds_read_b64_tr_b16 v[108:109], v23 offset:768
    ds_read_b64_tr_b16 v[110:111], v23 offset:17152
    s_waitcnt lgkmcnt(0)
    buffer_store_dwordx4 v[96:99], v8, s[16:19], s60 offen offset:0 sc1
    buffer_store_dwordx4 v[100:103], v8, s[16:19], s60 offen offset:1024 sc1
    buffer_store_dwordx4 v[104:107], v8, s[16:19], s60 offen offset:2048 sc1
    buffer_store_dwordx4 v[108:111], v8, s[16:19], s60 offen offset:3072 sc1
    s_add_u32 s60, s60, 704512
    ds_read_b64_tr_b16 v[112:113], v24 offset:768
    ds_read_b64_tr_b16 v[114:115], v24 offset:17152
    ds_read_b64_tr_b16 v[116:117], v25 offset:768
    ds_read_b64_tr_b16 v[118:119], v25 offset:17152
    ds_read_b64_tr_b16 v[120:121], v26 offset:768
    ds_read_b64_tr_b16 v[122:123], v26 offset:17152
    ds_read_b64_tr_b16 v[124:125], v27 offset:768
    ds_read_b64_tr_b16 v[126:127], v27 offset:17152
    s_waitcnt lgkmcnt(0)
    buffer_store_dwordx4 v[112:115], v8, s[16:19], s60 offen offset:0 sc1
    buffer_store_dwordx4 v[116:119], v8, s[16:19], s60 offen offset:1024 sc1
    buffer_store_dwordx4 v[120:123], v8, s[16:19], s60 offen offset:2048 sc1
    buffer_store_dwordx4 v[124:127], v8, s[16:19], s60 offen offset:3072 sc1
    s_add_u32 s60, s60, 704512
    s_waitcnt vmcnt(0)
    s_add_u32 s57, s57, 80
    s_branch K1_AUXL
K1_AUXE:
    s_endpgm
K1_END:
    s_endpgm
.globl attn_kernel
.p2align 8
.type attn_kernel,@function
attn_kernel:
    s_cmp_ge_u32 s2, 256
    s_cbranch_scc1 K2_END
    s_load_dwordx2 s[36:37], s[0:1], 96
    v_lshrrev_b32 v1, 6, v0
    s_nop 0
    v_readfirstlane_b32 s20, v1
    v_and_b32 v1, 63, v0
    s_and_b32 s38, s2, 7
    s_lshr_b32 s39, s2, 3
    s_and_b32 s21, s39, 7
    s_lshr_b32 s39, s39, 3
    s_lshl_b32 s38, s38, 2
    s_add_u32 s38, s38, s39
    s_lshl_b32 s22, s21, 2
    s_add_u32 s22, s22, 4
    s_lshl_b32 s23, s21, 2
    s_sub_u32 s23, 64, s23
    s_lshl_b32 s39, s38, 19
    v_lshlrev_b32 v4, 4, v1
    s_waitcnt lgkmcnt(0)
    s_add_u32 s40, s39, 33554432
    s_add_u32 s4, s36, s40
    s_addc_u32 s5, s37, 0
    s_and_b32 s5, s5, 0xffff
    s_lshl_b32 s6, s23, 13
    s_mov_b32 s7, 0x20000
    s_add_u32 s40, s39, 50331648
    s_add_u32 s8, s36, s40
    s_addc_u32 s9, s37, 0
    s_and_b32 s9, s9, 0xffff
    s_lshl_b32 s10, s23, 13
    s_mov_b32 s11, 0x20000
    s_add_u32 s40, s39, 16777216
    s_add_u32 s12, s36, s40
    s_addc_u32 s13, s37, 0
    s_and_b32 s13, s13, 0xffff
    s_mov_b32 s14, 0x80000
    s_mov_b32 s15, 0x20000
    s_add_u32 s16, s36, 67108864
    s_addc_u32 s17, s37, 0
    s_and_b32 s17, s17, 0xffff
    s_mov_b32 s18, 0x1000000
    s_mov_b32 s19, 0x20000
    s_sub_u32 s40, 15, s21
    s_lshl_b32 s40, s40, 2
    s_add_u32 s40, s40, s20
    s_lshl_b32 s41, s21, 2
    s_add_u32 s41, s41, s20
    s_lshl_b32 s42, s40, 13
    s_lshl_b32 s43, s41, 13
    s_add_u32 s44, s42, 0x1000
    s_add_u32 s45, s43, 0x1000
    s_xor_b32 s61, s40, 1
    s_lshl_b32 s62, s61, 13
    s_add_u32 s63, s62, 0x1000
    s_lshl_b32 s27, s20, 11
    s_or_b32 s28, s27, 0x10000
    s_mov_b32 s25, s27
    s_mov_b32 s26, s27
    s_mov_b32 s31, 0xffff
    s_mov_b32 s34, 0x2000
    s_mov_b32 s35, 0x2000
    s_mov_b32 s60, s20
    s_and_b32 s64, s20, 1
    s_lshl_b32 s64, s64, 13
    s_mov_b32 m0, s27
    s_add_u32 s27, s27, 0x2000
    buffer_load_dwordx4 v4, s[4:7], s25 offen lds
    buffer_load_dwordx4 v4, s[4:7], s25 offen offset:1024 lds
    s_and_b32 s27, s27, 0xffff
    s_add_u32 s25, s25, 0x2000
    buffer_load_dwordx4 a[0:3], v4, s[12:15], s42 offen offset:0
    buffer_load_dwordx4 a[4:7], v4, s[12:15], s42 offen offset:1024
    buffer_load_dwordx4 a[8:11], v4, s[12:15], s42 offen offset:2048
    buffer_load_dwordx4 a[12:15], v4, s[12:15], s42 offen offset:3072
    buffer_load_dwordx4 a[16:19], v4, s[12:15], s44 offen offset:0
    buffer_load_dwordx4 a[20:23], v4, s[12:15], s44 offen offset:1024
    buffer_load_dwordx4 a[24:27], v4, s[12:15], s44 offen offset:2048
    buffer_load_dwordx4 a[28:31], v4, s[12:15], s44 offen offset:3072
    buffer_load_dwordx4 a[32:35], v4, s[12:15], s43 offen offset:0
    buffer_load_dwordx4 a[36:39], v4, s[12:15], s43 offen offset:1024
    buffer_load_dwordx4 a[40:43], v4, s[12:15], s43 offen offset:2048
    buffer_load_dwordx4 a[44:47], v4, s[12:15], s43 offen offset:3072
    buffer_load_dwordx4 a[48:51], v4, s[12:15], s45 offen offset:0
    buffer_load_dwordx4 a[52:55], v4, s[12:15], s45 offen offset:1024
    buffer_load_dwordx4 a[56:59], v4, s[12:15], s45 offen offset:2048
    buffer_load_dwordx4 a[60:63], v4, s[12:15], s45 offen offset:3072
    v_mov_b32 v2, v4
    v_or_b32 v3, 0x10000, v4
    v_mov_b32 v128, 0
    v_mov_b32 v129, 0
    v_mov_b32 v130, 0
    v_mov_b32 v131, 0
    v_mov_b32 v132, 0
    v_mov_b32 v133, 0
    v_mov_b32 v134, 0
    v_mov_b32 v135, 0
    v_mov_b32 v136, 0
    v_mov_b32 v137, 0
    v_mov_b32 v138, 0
    v_mov_b32 v139, 0
    v_mov_b32 v140, 0
    v_mov_b32 v141, 0
    v_mov_b32 v142, 0
    v_mov_b32 v143, 0
    v_mov_b32 v144, 0
    v_mov_b32 v145, 0
    v_mov_b32 v146, 0
    v_mov_b32 v147, 0
    v_mov_b32 v148, 0
    v_mov_b32 v149, 0
    v_mov_b32 v150, 0
    v_mov_b32 v151, 0
    v_mov_b32 v152, 0
    v_mov_b32 v153, 0
    v_mov_b32 v154, 0
    v_mov_b32 v155, 0
    v_mov_b32 v156, 0
    v_mov_b32 v157, 0
    v_mov_b32 v158, 0
    v_mov_b32 v159, 0
    v_mov_b32 v160, 0
    v_mov_b32 v161, 0
    v_mov_b32 v162, 0
    v_mov_b32 v163, 0
    v_mov_b32 v164, 0
    v_mov_b32 v165, 0
    v_mov_b32 v166, 0
    v_mov_b32 v167, 0
    v_mov_b32 v168, 0
    v_mov_b32 v169, 0
    v_mov_b32 v170, 0
    v_mov_b32 v171, 0
    v_mov_b32 v172, 0
    v_mov_b32 v173, 0
    v_mov_b32 v174, 0
    v_mov_b32 v175, 0
    v_mov_b32 v176, 0
    v_mov_b32 v177, 0
    v_mov_b32 v178, 0
    v_mov_b32 v179, 0
    v_mov_b32 v180, 0
    v_mov_b32 v181, 0
    v_mov_b32 v182, 0
    v_mov_b32 v183, 0
    v_mov_b32 v184, 0
    v_mov_b32 v185, 0
    v_mov_b32 v186, 0
    v_mov_b32 v187, 0
    v_mov_b32 v188, 0
    v_mov_b32 v189, 0
    v_mov_b32 v190, 0
    v_mov_b32 v191, 0
    v_mov_b32 v192, 0
    v_mov_b32 v193, 0
    v_mov_b32 v194, 0
    v_mov_b32 v195, 0
    v_mov_b32 v196, 0
    v_mov_b32 v197, 0
    v_mov_b32 v198, 0
    v_mov_b32 v199, 0
    v_mov_b32 v200, 0
    v_mov_b32 v201, 0
    v_mov_b32 v202, 0
    v_mov_b32 v203, 0
    v_mov_b32 v204, 0
    v_mov_b32 v205, 0
    v_mov_b32 v206, 0
    v_mov_b32 v207, 0
    v_mov_b32 v208, 0
    v_mov_b32 v209, 0
    v_mov_b32 v210, 0
    v_mov_b32 v211, 0
    v_mov_b32 v212, 0
    v_mov_b32 v213, 0
    v_mov_b32 v214, 0
    v_mov_b32 v215, 0
    v_mov_b32 v216, 0
    v_mov_b32 v217, 0
    v_mov_b32 v218, 0
    v_mov_b32 v219, 0
    v_mov_b32 v220, 0
    v_mov_b32 v221, 0
    v_mov_b32 v222, 0
    v_mov_b32 v223, 0
    v_mov_b32 v224, 0
    v_mov_b32 v225, 0
    v_mov_b32 v226, 0
    v_mov_b32 v227, 0
    v_mov_b32 v228, 0
    v_mov_b32 v229, 0
    v_mov_b32 v230, 0
    v_mov_b32 v231, 0
    v_mov_b32 v232, 0
    v_mov_b32 v233, 0
    v_mov_b32 v234, 0
    v_mov_b32 v235, 0
    v_mov_b32 v236, 0
    v_mov_b32 v237, 0
    v_mov_b32 v238, 0
    v_mov_b32 v239, 0
    v_mov_b32 v240, 0
    v_mov_b32 v241, 0
    v_mov_b32 v242, 0
    v_mov_b32 v243, 0
    v_mov_b32 v244, 0
    v_mov_b32 v245, 0
    v_mov_b32 v246, 0
    v_mov_b32 v247, 0
    v_mov_b32 v248, 0
    v_mov_b32 v249, 0
    v_mov_b32 v250, 0
    v_mov_b32 v251, 0
    v_mov_b32 v252, 0
    v_mov_b32 v253, 0
    v_mov_b32 v254, 0
    v_mov_b32 v255, 0
    v_mov_b32 v112, 0
    v_mov_b32 v113, 0
    v_mov_b32 v114, 0
    v_mov_b32 v115, 0
    v_mov_b32 v116, 0
    v_mov_b32 v117, 0
    v_accvgpr_write_b32 a96, 0
    v_accvgpr_write_b32 a97, 0
    v_accvgpr_write_b32 a98, 0
    v_accvgpr_write_b32 a99, 0
    v_accvgpr_write_b32 a100, 0
    v_accvgpr_write_b32 a101, 0
    v_accvgpr_write_b32 a102, 0
    v_accvgpr_write_b32 a103, 0
    v_accvgpr_write_b32 a104, 0
    v_accvgpr_write_b32 a105, 0
    v_accvgpr_write_b32 a106, 0
    v_accvgpr_write_b32 a107, 0
    v_accvgpr_write_b32 a108, 0
    v_accvgpr_write_b32 a109, 0
    v_accvgpr_write_b32 a110, 0
    v_accvgpr_write_b32 a111, 0
    v_accvgpr_write_b32 a112, 0
    v_accvgpr_write_b32 a113, 0
    v_accvgpr_write_b32 a114, 0
    v_accvgpr_write_b32 a115, 0
    v_accvgpr_write_b32 a116, 0
    v_accvgpr_write_b32 a117, 0
    v_accvgpr_write_b32 a118, 0
    v_accvgpr_write_b32 a119, 0
    v_accvgpr_write_b32 a120, 0
    v_accvgpr_write_b32 a121, 0
    v_accvgpr_write_b32 a122, 0
    v_accvgpr_write_b32 a123, 0
    v_accvgpr_write_b32 a124, 0
    v_accvgpr_write_b32 a125, 0
    v_accvgpr_write_b32 a126, 0
    v_accvgpr_write_b32 a127, 0
    v_accvgpr_write_b32 a160, 0
    v_accvgpr_write_b32 a161, 0
    v_accvgpr_write_b32 a162, 0
    v_accvgpr_write_b32 a163, 0
    v_accvgpr_write_b32 a164, 0
    v_accvgpr_write_b32 a165, 0
    v_accvgpr_write_b32 a166, 0
    v_accvgpr_write_b32 a167, 0
    v_accvgpr_write_b32 a168, 0
    v_accvgpr_write_b32 a169, 0
    v_accvgpr_write_b32 a170, 0
    v_accvgpr_write_b32 a171, 0
    v_accvgpr_write_b32 a172, 0
    v_accvgpr_write_b32 a173, 0
    v_accvgpr_write_b32 a174, 0
    v_accvgpr_write_b32 a175, 0
    v_accvgpr_write_b32 a176, 0
    v_accvgpr_write_b32 a177, 0
    v_accvgpr_write_b32 a178, 0
    v_accvgpr_write_b32 a179, 0
    v_accvgpr_write_b32 a180, 0
    v_accvgpr_write_b32 a181, 0
    v_accvgpr_write_b32 a182, 0
    v_accvgpr_write_b32 a183, 0
    v_accvgpr_write_b32 a184, 0
    v_accvgpr_write_b32 a185, 0
    v_accvgpr_write_b32 a186, 0
    v_accvgpr_write_b32 a187, 0
    v_accvgpr_write_b32 a188, 0
    v_accvgpr_write_b32 a189, 0
    v_accvgpr_write_b32 a190, 0
    v_accvgpr_write_b32 a191, 0
    v_and_b32 v6, 31, v1
    v_lshrrev_b32 v7, 5, v1
    v_lshlrev_b32 v7, 2, v7
    v_sub_u32 v6, v6, v7
    v_mov_b32 v7, 0xf149f2ca
    v_cmp_le_i32 vcc, 0, v6
    s_nop 1
    v_cndmask_b32 v80, v7, v112, vcc
    v_cmp_le_i32 vcc, 1, v6
    s_nop 1
    v_cndmask_b32 v81, v7, v112, vcc
    v_cmp_le_i32 vcc, 2, v6
    s_nop 1
    v_cndmask_b32 v82, v7, v112, vcc
    v_cmp_le_i32 vcc, 3, v6
    s_nop 1
    v_cndmask_b32 v83, v7, v112, vcc
    v_cmp_le_i32 vcc, 16, v6
    s_nop 1
    v_cndmask_b32 v84, v7, v112, vcc
    v_cmp_le_i32 vcc, 17, v6
    s_nop 1
    v_cndmask_b32 v85, v7, v112, vcc
    v_cmp_le_i32 vcc, 18, v6
    s_nop 1
    v_cndmask_b32 v86, v7, v112, vcc
    v_cmp_le_i32 vcc, 19, v6
    s_nop 1
    v_cndmask_b32 v87, v7, v112, vcc
    v_cmp_le_i32 vcc, 8, v6
    s_nop 1
    v_cndmask_b32 v88, v7, v112, vcc
    v_cmp_le_i32 vcc, 9, v6
    s_nop 1
    v_cndmask_b32 v89, v7, v112, vcc
    v_cmp_le_i32 vcc, 10, v6
    s_nop 1
    v_cndmask_b32 v90, v7, v112, vcc
    v_cmp_le_i32 vcc, 11, v6
    s_nop 1
    v_cndmask_b32 v91, v7, v112, vcc
    v_cmp_le_i32 vcc, 24, v6
    s_nop 1
    v_cndmask_b32 v92, v7, v112, vcc
    v_cmp_le_i32 vcc, 25, v6
    s_nop 1
    v_cndmask_b32 v93, v7, v112, vcc
    v_cmp_le_i32 vcc, 26, v6
    s_nop 1
    v_cndmask_b32 v94, v7, v112, vcc
    v_cmp_le_i32 vcc, 27, v6
    s_nop 1
    v_cndmask_b32 v95, v7, v112, vcc
    v_mov_b32 v96, v7
    v_mov_b32 v97, v7
    v_mov_b32 v98, v7
    v_mov_b32 v99, v7
    v_mov_b32 v100, v7
    v_mov_b32 v101, v7
    v_mov_b32 v102, v7
    v_mov_b32 v103, v7
    v_mov_b32 v104, v7
    v_mov_b32 v105, v7
    v_mov_b32 v106, v7
    v_mov_b32 v107, v7
    v_mov_b32 v108, v7
    v_mov_b32 v109, v7
    v_mov_b32 v110, v7
    v_mov_b32 v111, v7
    s_mov_b32 s66, 0
    s_mov_b32 s69, 0x207
    s_sub_u32 s29, 4, s23
    s_sub_u32 s30, 4, s22
    s_mov_b32 s33, 1
    s_waitcnt vmcnt(8)
    s_barrier
    ds_read_b128 a[64:67], v2 offset:0
    ds_read_b128 a[68:71], v2 offset:1024
    ds_read_b128 a[72:75], v2 offset:2048
    ds_read_b128 a[76:79], v2 offset:3072
    ds_read_b128 a[80:83], v2 offset:4096
    ds_read_b128 a[84:87], v2 offset:5120
    ds_read_b128 a[88:91], v2 offset:6144
    ds_read_b128 a[92:95], v2 offset:7168
    v_add_u32 v2, s35, v2
    v_and_b32 v2, 0xffff, v2
    s_waitcnt lgkmcnt(0)
    s_cmp_lt_i32 s29, s20
    s_cbranch_scc0 K2T_1
    v_mfma_f32_32x32x16_bf16 v[32:47], a[64:67], a[0:3], 0
    s_branch K2J_3
K2T_1:
    s_cmp_eq_i32 s29, s20
    s_cbranch_scc1 K2N_2
    v_mfma_f32_32x32x16_bf16 v[32:47], a[64:67], a[0:3], v[96:111]
    s_branch K2J_3
K2N_2:
    v_mfma_f32_32x32x16_bf16 v[32:47], a[64:67], a[0:3], v[80:95]
K2J_3:
    s_mov_b32 m0, s27
    s_add_u32 s27, s27, 0x2000
    buffer_load_dwordx4 v4, s[4:7], s25 offen lds
    buffer_load_dwordx4 v4, s[4:7], s25 offen offset:1024 lds
    s_and_b32 s27, s27, 0xffff
    s_add_u32 s25, s25, 0x2000
    v_mfma_f32_32x32x16_bf16 v[32:47], a[68:71], a[4:7], v[32:47]
    s_mov_b32 m0, s27
    s_add_u32 s27, s27, 0x2000
    buffer_load_dwordx4 v4, s[4:7], s25 offen lds
    buffer_load_dwordx4 v4, s[4:7], s25 offen offset:1024 lds
    s_and_b32 s27, s27, 0xffff
    s_add_u32 s25, s25, 0x2000
    v_mfma_f32_32x32x16_bf16 v[32:47], a[72:75], a[8:11], v[32:47]
    s_mov_b32 m0, s27
    s_add_u32 s27, s27, 0x2000
    buffer_load_dwordx4 v4, s[4:7], s25 offen lds
    buffer_load_dwordx4 v4, s[4:7], s25 offen offset:1024 lds
    s_and_b32 s27, s27, 0xffff
    s_add_u32 s25, s25, 0x2000
    v_mfma_f32_32x32x16_bf16 v[32:47], a[76:79], a[12:15], v[32:47]
    s_mov_b32 m0, s28
    s_add_u32 s28, s28, 0x2000
    buffer_load_dwordx4 v4, s[8:11], s26 offen lds
    buffer_load_dwordx4 v4, s[8:11], s26 offen offset:1024 lds
    s_and_b32 s28, s28, 0xffff
    s_or_b32 s28, s28, 0x10000
    s_add_u32 s26, s26, 0x2000
    v_mfma_f32_32x32x16_bf16 v[32:47], a[80:83], a[16:19], v[32:47]
    s_mov_b32 m0, s27
    s_add_u32 s27, s27, 0x2000
    buffer_load_dwordx4 v4, s[4:7], s25 offen lds
    buffer_load_dwordx4 v4, s[4:7], s25 offen offset:1024 lds
    s_and_b32 s27, s27, 0xffff
    s_add_u32 s25, s25, 0x2000
    v_mfma_f32_32x32x16_bf16 v[32:47], a[84:87], a[20:23], v[32:47]
    s_mov_b32 m0, s28
    s_add_u32 s28, s28, 0x2000
    buffer_load_dwordx4 v4, s[8:11], s26 offen lds
    buffer_load_dwordx4 v4, s[8:11], s26 offen offset:1024 lds
    s_and_b32 s28, s28, 0xffff
    s_or_b32 s28, s28, 0x10000
    s_add_u32 s26, s26, 0x2000
    v_mfma_f32_32x32x16_bf16 v[32:47], a[88:91], a[24:27], v[32:47]
    s_mov_b32 m0, s27
    s_add_u32 s27, s27, 0x2000
    buffer_load_dwordx4 v4, s[4:7], s25 offen lds
    buffer_load_dwordx4 v4, s[4:7], s25 offen offset:1024 lds
    s_and_b32 s27, s27, 0xffff
    s_add_u32 s25, s25, 0x2000
    v_mfma_f32_32x32x16_bf16 v[32:47], a[92:95], a[28:31], v[32:47]
    s_mov_b32 m0, s28
    s_add_u32 s28, s28, 0x2000
    buffer_load_dwordx4 v4, s[8:11], s26 offen lds
    buffer_load_dwordx4 v4, s[8:11], s26 offen offset:1024 lds
    s_and_b32 s28, s28, 0xffff
    s_or_b32 s28, s28, 0x10000
    s_add_u32 s26, s26, 0x2000
    s_waitcnt vmcnt(16)
    s_cmp_lt_i32 s30, s60
    s_cbranch_scc0 K2T_4
    v_mfma_f32_32x32x16_bf16 v[48:63], a[64:67], a[32:35], 0
    s_branch K2J_6
K2T_4:
    s_cmp_eq_i32 s30, s60
    s_cbranch_scc1 K2N_5
    v_mfma_f32_32x32x16_bf16 v[48:63], a[64:67], a[32:35], v[96:111]
    s_branch K2J_6
K2N_5:
    v_mfma_f32_32x32x16_bf16 v[48:63], a[64:67], a[32:35], v[80:95]
K2J_6:
    s_mov_b32 m0, s27
    s_add_u32 s27, s27, 0x2000
    buffer_load_dwordx4 v4, s[4:7], s25 offen lds
    buffer_load_dwordx4 v4, s[4:7], s25 offen offset:1024 lds
    s_and_b32 s27, s27, 0xffff
    s_add_u32 s25, s25, 0x2000
    v_mfma_f32_32x32x16_bf16 v[48:63], a[68:71], a[36:39], v[48:63]
    s_mov_b32 m0, s28
    s_add_u32 s28, s28, 0x2000
    buffer_load_dwordx4 v4, s[8:11], s26 offen lds
    buffer_load_dwordx4 v4, s[8:11], s26 offen offset:1024 lds
    s_and_b32 s28, s28, 0xffff
    s_or_b32 s28, s28, 0x10000
    s_add_u32 s26, s26, 0x2000
    v_mfma_f32_32x32x16_bf16 v[48:63], a[72:75], a[40:43], v[48:63]
    s_mov_b32 m0, s27
    s_add_u32 s27, s27, 0x2000
    buffer_load_dwordx4 v4, s[4:7], s25 offen lds
    buffer_load_dwordx4 v4, s[4:7], s25 offen offset:1024 lds
    s_and_b32 s27, s27, 0xffff
    s_add_u32 s25, s25, 0x2000
    v_exp_f32 v32, v32
    v_exp_f32 v33, v33
    v_add_f32 v112, v112, v32
    v_mfma_f32_32x32x16_bf16 v[48:63], a[76:79], a[44:47], v[48:63]
    s_mov_b32 m0, s28
    s_add_u32 s28, s28, 0x2000
    buffer_load_dwordx4 v4, s[8:11], s26 offen lds
    buffer_load_dwordx4 v4, s[8:11], s26 offen offset:1024 lds
    s_and_b32 s28, s28, 0xffff
    s_or_b32 s28, s28, 0x10000
    s_add_u32 s26, s26, 0x2000
    v_add_f32 v113, v113, v33
    v_exp_f32 v34, v34
    v_exp_f32 v35, v35
    v_mfma_f32_32x32x16_bf16 v[48:63], a[80:83], a[48:51], v[48:63]
    buffer_load_dwordx4 a[192:195], v4, s[12:15], s62 offen offset:0
    buffer_load_dwordx4 a[196:199], v4, s[12:15], s62 offen offset:1024
    v_add_f32 v112, v112, v34
    v_add_f32 v113, v113, v35
    v_exp_f32 v36, v36
    v_mfma_f32_32x32x16_bf16 v[48:63], a[84:87], a[52:55], v[48:63]
    buffer_load_dwordx4 a[200:203], v4, s[12:15], s62 offen offset:2048
    buffer_load_dwordx4 a[204:207], v4, s[12:15], s62 offen offset:3072
    v_add_f32 v112, v112, v36
    v_exp_f32 v37, v37
    v_exp_f32 v38, v38
    v_mfma_f32_32x32x16_bf16 v[48:63], a[88:91], a[56:59], v[48:63]
    buffer_load_dwordx4 a[208:211], v4, s[12:15], s63 offen offset:0
    buffer_load_dwordx4 a[212:215], v4, s[12:15], s63 offen offset:1024
    v_add_f32 v113, v113, v37
    v_add_f32 v112, v112, v38
    v_exp_f32 v39, v39
    v_mfma_f32_32x32x16_bf16 v[48:63], a[92:95], a[60:63], v[48:63]
    buffer_load_dwordx4 a[216:219], v4, s[12:15], s63 offen offset:2048
    buffer_load_dwordx4 a[220:223], v4, s[12:15], s63 offen offset:3072
    v_add_f32 v113, v113, v39
    v_exp_f32 v40, v40
    v_exp_f32 v41, v41
    s_waitcnt vmcnt(30)
    s_barrier
    ds_read_b128 a[64:67], v2 offset:0
    v_add_f32 v112, v112, v40
    v_add_f32 v113, v113, v41
    v_exp_f32 v42, v42
    ds_read_b128 a[68:71], v2 offset:1024
    s_mov_b32 m0, s27
    s_add_u32 s27, s27, 0x2000
    buffer_load_dwordx4 v4, s[4:7], s25 offen lds
    v_add_f32 v112, v112, v42
    v_exp_f32 v43, v43
    ds_read_b128 a[72:75], v2 offset:2048
    buffer_load_dwordx4 v4, s[4:7], s25 offen offset:1024 lds
    s_and_b32 s27, s27, 0xffff
    s_add_u32 s25, s25, 0x2000
    v_add_f32 v113, v113, v43
    v_exp_f32 v44, v44
    ds_read_b128 a[76:79], v2 offset:3072
    s_mov_b32 m0, s28
    s_add_u32 s28, s28, 0x2000
    v_cvt_pk_bf16_f32 v64, v32, v33
    v_cvt_pk_bf16_f32 v65, v34, v35
    v_cvt_pk_bf16_f32 v66, v36, v37
    v_cvt_pk_bf16_f32 v67, v38, v39
    ds_read_b128 a[80:83], v2 offset:4096
    buffer_load_dwordx4 v4, s[8:11], s26 offen lds
    buffer_load_dwordx4 v4, s[8:11], s26 offen offset:1024 lds
    s_and_b32 s28, s28, 0xffff
    v_add_f32 v112, v112, v44
    v_exp_f32 v45, v45
    ds_read_b128 a[84:87], v2 offset:5120
    s_or_b32 s28, s28, 0x10000
    s_add_u32 s26, s26, 0x2000
    v_add_f32 v113, v113, v45
    v_exp_f32 v46, v46
    ds_read_b128 a[88:91], v2 offset:6144
    v_add_f32 v112, v112, v46
    v_exp_f32 v47, v47
    ds_read_b128 a[92:95], v2 offset:7168
    v_add_u32 v2, s35, v2
    v_cvt_pk_bf16_f32 v68, v40, v41
    v_cvt_pk_bf16_f32 v69, v42, v43
    v_cvt_pk_bf16_f32 v70, v44, v45
    v_cvt_pk_bf16_f32 v71, v46, v47
    v_and_b32 v2, 0xffff, v2
    v_add_f32 v113, v113, v47
    v_exp_f32 v48, v48
    v_exp_f32 v49, v49
    v_add_f32 v114, v114, v48
    v_add_f32 v115, v115, v49
    v_exp_f32 v50, v50
    s_nop 0
    v_add_f32 v114, v114, v50
    v_exp_f32 v51, v51
    v_exp_f32 v52, v52
    v_cvt_pk_bf16_f32 v72, v48, v49
    v_cvt_pk_bf16_f32 v73, v50, v51
    v_add_f32 v115, v115, v51
    v_add_f32 v114, v114, v52
    v_exp_f32 v53, v53
    v_exp_f32 v54, v54
    v_cvt_pk_bf16_f32 v74, v52, v53
    s_add_u32 s29, s29, s33
    s_add_u32 s30, s30, s33
    v_add_f32 v115, v115, v53
    v_add_f32 v114, v114, v54
    v_exp_f32 v55, v55
    s_nop 0
    v_cvt_pk_bf16_f32 v75, v54, v55
    v_add_f32 v115, v115, v55
    v_exp_f32 v56, v56
    v_exp_f32 v57, v57
    s_sub_u32 s24, s22, 5
    s_cmp_gt_i32 s24, 0
    s_cbranch_scc0 K2_P1M_PRE
    s_add_u32 s29, s29, s24
    s_add_u32 s30, s30, s24
.p2align 6
K2_P1U:
    s_waitcnt vmcnt(20) lgkmcnt(0)
    s_barrier
    v_mfma_f32_32x32x16_bf16 v[32:47], a[64:67], a[0:3], 0
    ds_read_b128 a[128:131], v3 offset:0
    v_cvt_pk_bf16_f32 v76, v56, v57
    v_add_f32 v114, v114, v56
    v_add_f32 v115, v115, v57
    v_mfma_f32_32x32x16_bf16 v[32:47], a[68:71], a[4:7], v[32:47]
    ds_read_b128 a[136:139], v3 offset:2048
    v_exp_f32 v58, v58
    v_exp_f32 v59, v59
    v_mfma_f32_32x32x16_bf16 v[32:47], a[72:75], a[8:11], v[32:47]
    v_cvt_pk_bf16_f32 v77, v58, v59
    v_add_f32 v114, v114, v58
    v_add_f32 v115, v115, v59
    v_exp_f32 v60, v60
    v_mfma_f32_32x32x16_bf16 v[32:47], a[76:79], a[12:15], v[32:47]
    ds_read_b128 a[144:147], v3 offset:4096
    v_add_f32 v114, v114, v60
    v_exp_f32 v61, v61
    v_mfma_f32_32x32x16_bf16 v[32:47], a[80:83], a[16:19], v[32:47]
    ds_read_b128 a[152:155], v3 offset:6144
    v_cvt_pk_bf16_f32 v78, v60, v61
    v_add_f32 v115, v115, v61
    v_exp_f32 v62, v62
    v_mfma_f32_32x32x16_bf16 v[32:47], a[84:87], a[20:23], v[32:47]
    v_add_f32 v114, v114, v62
    v_exp_f32 v63, v63
    v_mfma_f32_32x32x16_bf16 v[32:47], a[88:91], a[24:27], v[32:47]
    ds_read_b128 a[132:135], v3 offset:1024
    v_cvt_pk_bf16_f32 v79, v62, v63
    v_add_f32 v115, v115, v63
    v_mfma_f32_32x32x16_bf16 v[32:47], a[92:95], a[28:31], v[32:47]
    ds_read_b128 a[140:143], v3 offset:3072
    s_mov_b32 m0, s27
    s_add_u32 s27, s27, 0x2000
    buffer_load_dwordx4 v4, s[4:7], s25 offen lds
    buffer_load_dwordx4 v4, s[4:7], s25 offen offset:1024 lds
    s_and_b32 s27, s27, 0xffff
    v_mfma_f32_32x32x16_bf16 v[48:63], a[64:67], a[32:35], 0
    s_add_u32 s25, s25, 0x2000
    s_mov_b32 m0, s28
    s_add_u32 s28, s28, 0x2000
    buffer_load_dwordx4 v4, s[8:11], s26 offen lds
    v_mfma_f32_32x32x16_bf16 v[48:63], a[68:71], a[36:39], v[48:63]
    ds_read_b128 a[148:151], v3 offset:5120
    buffer_load_dwordx4 v4, s[8:11], s26 offen offset:1024 lds
    s_and_b32 s28, s28, 0xffff
    s_or_b32 s28, s28, 0x10000
    s_add_u32 s26, s26, 0x2000
    v_mfma_f32_32x32x16_bf16 v[48:63], a[72:75], a[40:43], v[48:63]
    ds_read_b128 a[156:159], v3 offset:7168
    v_exp_f32 v32, v32
    v_exp_f32 v33, v33
    v_mfma_f32_32x32x16_bf16 v[48:63], a[76:79], a[44:47], v[48:63]
    v_add_u32 v5, s34, v3
    v_add_f32 v112, v112, v32
    v_add_f32 v113, v113, v33
    v_exp_f32 v34, v34
    v_mfma_f32_32x32x16_bf16 v[48:63], a[80:83], a[48:51], v[48:63]
    v_bfi_b32 v3, s31, v5, v3
    v_add_f32 v112, v112, v34
    v_exp_f32 v35, v35
    v_mfma_f32_32x32x16_bf16 v[48:63], a[84:87], a[52:55], v[48:63]
    v_add_f32 v113, v113, v35
    v_exp_f32 v36, v36
    v_exp_f32 v37, v37
    v_mfma_f32_32x32x16_bf16 v[48:63], a[88:91], a[56:59], v[48:63]
    v_add_f32 v112, v112, v36
    v_add_f32 v113, v113, v37
    v_exp_f32 v38, v38
    v_mfma_f32_32x32x16_bf16 v[48:63], a[92:95], a[60:63], v[48:63]
    v_add_f32 v112, v112, v38
    v_exp_f32 v39, v39
    v_exp_f32 v40, v40
    s_waitcnt lgkmcnt(0)
    v_mfma_f32_32x32x16_bf16 v[128:143], a[128:131], v[64:67], v[128:143]
    ds_read_b128 a[64:67], v2 offset:0
    v_add_f32 v113, v113, v39
    v_add_f32 v112, v112, v40
    v_exp_f32 v41, v41
    v_mfma_f32_32x32x16_bf16 v[144:159], a[136:139], v[64:67], v[144:159]
    ds_read_b128 a[68:71], v2 offset:1024
    v_add_f32 v113, v113, v41
    v_exp_f32 v42, v42
    v_mfma_f32_32x32x16_bf16 v[160:175], a[144:147], v[64:67], v[160:175]
    v_add_f32 v112, v112, v42
    v_exp_f32 v43, v43
    v_exp_f32 v44, v44
    v_mfma_f32_32x32x16_bf16 v[176:191], a[152:155], v[64:67], v[176:191]
    ds_read_b128 a[72:75], v2 offset:2048
    v_cvt_pk_bf16_f32 v64, v32, v33
    v_cvt_pk_bf16_f32 v65, v34, v35
    v_cvt_pk_bf16_f32 v66, v36, v37
    v_cvt_pk_bf16_f32 v67, v38, v39
    v_mfma_f32_32x32x16_bf16 v[128:143], a[132:135], v[68:71], v[128:143]
    ds_read_b128 a[76:79], v2 offset:3072
    v_add_f32 v113, v113, v43
    v_add_f32 v112, v112, v44
    v_exp_f32 v45, v45
    v_mfma_f32_32x32x16_bf16 v[144:159], a[140:143], v[68:71], v[144:159]
    v_add_f32 v113, v113, v45
    v_exp_f32 v46, v46
    v_exp_f32 v47, v47
    v_mfma_f32_32x32x16_bf16 v[160:175], a[148:151], v[68:71], v[160:175]
    ds_read_b128 a[80:83], v2 offset:4096
    v_add_f32 v112, v112, v46
    v_add_f32 v113, v113, v47
    v_exp_f32 v48, v48
    v_mfma_f32_32x32x16_bf16 v[176:191], a[156:159], v[68:71], v[176:191]
    ds_read_b128 a[84:87], v2 offset:5120
    v_cvt_pk_bf16_f32 v68, v40, v41
    v_cvt_pk_bf16_f32 v69, v42, v43
    v_cvt_pk_bf16_f32 v70, v44, v45
    v_cvt_pk_bf16_f32 v71, v46, v47
    v_mfma_f32_32x32x16_bf16 v[192:207], a[128:131], v[72:75], v[192:207]
    v_add_f32 v114, v114, v48
    v_exp_f32 v49, v49
    v_exp_f32 v50, v50
    v_mfma_f32_32x32x16_bf16 v[208:223], a[136:139], v[72:75], v[208:223]
    ds_read_b128 a[88:91], v2 offset:6144
    v_add_f32 v115, v115, v49
    v_add_f32 v114, v114, v50
    v_exp_f32 v51, v51
    v_mfma_f32_32x32x16_bf16 v[224:239], a[144:147], v[72:75], v[224:239]
    ds_read_b128 a[92:95], v2 offset:7168
    v_add_f32 v115, v115, v51
    v_exp_f32 v52, v52
    v_mfma_f32_32x32x16_bf16 v[240:255], a[152:155], v[72:75], v[240:255]
    v_add_u32 v2, s35, v2
    v_cvt_pk_bf16_f32 v72, v48, v49
    v_cvt_pk_bf16_f32 v73, v50, v51
    v_add_f32 v114, v114, v52
    v_mfma_f32_32x32x16_bf16 v[192:207], a[132:135], v[76:79], v[192:207]
    v_and_b32 v2, 0xffff, v2
    v_exp_f32 v53, v53
    v_exp_f32 v54, v54
    v_mfma_f32_32x32x16_bf16 v[208:223], a[140:143], v[76:79], v[208:223]
    v_cvt_pk_bf16_f32 v74, v52, v53
    v_add_f32 v115, v115, v53
    v_add_f32 v114, v114, v54
    v_exp_f32 v55, v55
    v_mfma_f32_32x32x16_bf16 v[224:239], a[148:151], v[76:79], v[224:239]
    v_cvt_pk_bf16_f32 v75, v54, v55
    v_add_f32 v115, v115, v55
    v_exp_f32 v56, v56
    v_mfma_f32_32x32x16_bf16 v[240:255], a[156:159], v[76:79], v[240:255]
    v_exp_f32 v57, v57
    s_sub_u32 s24, s24, 1
    s_cmp_lg_u32 s24, 0
    s_cbranch_scc1 K2_P1U
K2_P1M_PRE:
    s_sub_u32 s24, s22, 1
    s_min_u32 s24, s24, 4
.p2align 6
K2_P1M:
    s_add_u32 s65, s64, 0x2000
    s_cmp_eq_u32 s24, 2
    s_cselect_b32 s35, s65, 0x2000
    s_cmp_eq_u32 s24, 1
    s_cselect_b32 s35, 0x4000, s35
    s_waitcnt vmcnt(20) lgkmcnt(0)
    s_barrier
    s_cmp_lt_i32 s29, s20
    s_cbranch_scc0 K2T_7
    v_mfma_f32_32x32x16_bf16 v[32:47], a[64:67], a[0:3], 0
    s_branch K2J_9
K2T_7:
    s_cmp_eq_i32 s29, s20
    s_cbranch_scc1 K2N_8
    v_mfma_f32_32x32x16_bf16 v[32:47], a[64:67], a[0:3], v[96:111]
    s_branch K2J_9
K2N_8:
    v_mfma_f32_32x32x16_bf16 v[32:47], a[64:67], a[0:3], v[80:95]
K2J_9:
    ds_read_b128 a[128:131], v3 offset:0
    v_cvt_pk_bf16_f32 v76, v56, v57
    v_add_f32 v114, v114, v56
    v_add_f32 v115, v115, v57
    v_mfma_f32_32x32x16_bf16 v[32:47], a[68:71], a[4:7], v[32:47]
    ds_read_b128 a[136:139], v3 offset:2048
    v_exp_f32 v58, v58
    v_exp_f32 v59, v59
    v_mfma_f32_32x32x16_bf16 v[32:47], a[72:75], a[8:11], v[32:47]
    v_cvt_pk_bf16_f32 v77, v58, v59
    v_add_f32 v114, v114, v58
    v_add_f32 v115, v115, v59
    v_exp_f32 v60, v60
    v_mfma_f32_32x32x16_bf16 v[32:47], a[76:79], a[12:15], v[32:47]
    ds_read_b128 a[144:147], v3 offset:4096
    v_add_f32 v114, v114, v60
    v_exp_f32 v61, v61
    v_mfma_f32_32x32x16_bf16 v[32:47], a[80:83], a[16:19], v[32:47]
    ds_read_b128 a[152:155], v3 offset:6144
    v_cvt_pk_bf16_f32 v78, v60, v61
    v_add_f32 v115, v115, v61
    v_exp_f32 v62, v62
    v_mfma_f32_32x32x16_bf16 v[32:47], a[84:87], a[20:23], v[32:47]
    v_add_f32 v114, v114, v62
    v_exp_f32 v63, v63
    v_mfma_f32_32x32x16_bf16 v[32:47], a[88:91], a[24:27], v[32:47]
    ds_read_b128 a[132:135], v3 offset:1024
    v_cvt_pk_bf16_f32 v79, v62, v63
    v_add_f32 v115, v115, v63
    v_mfma_f32_32x32x16_bf16 v[32:47], a[92:95], a[28:31], v[32:47]
    ds_read_b128 a[140:143], v3 offset:3072
    s_mov_b32 m0, s27
    s_add_u32 s27, s27, 0x2000
    buffer_load_dwordx4 v4, s[4:7], s25 offen lds
    buffer_load_dwordx4 v4, s[4:7], s25 offen offset:1024 lds
    s_and_b32 s27, s27, 0xffff
    s_cmp_lt_i32 s30, s60
    s_cbranch_scc0 K2T_10
    v_mfma_f32_32x32x16_bf16 v[48:63], a[64:67], a[32:35], 0
    s_branch K2J_12
K2T_10:
    s_cmp_eq_i32 s30, s60
    s_cbranch_scc1 K2N_11
    v_mfma_f32_32x32x16_bf16 v[48:63], a[64:67], a[32:35], v[96:111]
    s_branch K2J_12
K2N_11:
    v_mfma_f32_32x32x16_bf16 v[48:63], a[64:67], a[32:35], v[80:95]
K2J_12:
    s_add_u32 s25, s25, 0x2000
    s_mov_b32 m0, s28
    s_add_u32 s28, s28, 0x2000
    buffer_load_dwordx4 v4, s[8:11], s26 offen lds
    v_mfma_f32_32x32x16_bf16 v[48:63], a[68:71], a[36:39], v[48:63]
    ds_read_b128 a[148:151], v3 offset:5120
    buffer_load_dwordx4 v4, s[8:11], s26 offen offset:1024 lds
    s_and_b32 s28, s28, 0xffff
    s_or_b32 s28, s28, 0x10000
    s_add_u32 s26, s26, 0x2000
    v_mfma_f32_32x32x16_bf16 v[48:63], a[72:75], a[40:43], v[48:63]
    ds_read_b128 a[156:159], v3 offset:7168
    v_exp_f32 v32, v32
    v_exp_f32 v33, v33
    v_mfma_f32_32x32x16_bf16 v[48:63], a[76:79], a[44:47], v[48:63]
    v_add_u32 v5, s34, v3
    v_add_f32 v112, v112, v32
    v_add_f32 v113, v113, v33
    v_exp_f32 v34, v34
    v_mfma_f32_32x32x16_bf16 v[48:63], a[80:83], a[48:51], v[48:63]
    v_bfi_b32 v3, s31, v5, v3
    v_add_f32 v112, v112, v34
    v_exp_f32 v35, v35
    v_mfma_f32_32x32x16_bf16 v[48:63], a[84:87], a[52:55], v[48:63]
    v_add_f32 v113, v113, v35
    v_exp_f32 v36, v36
    v_exp_f32 v37, v37
    v_mfma_f32_32x32x16_bf16 v[48:63], a[88:91], a[56:59], v[48:63]
    v_add_f32 v112, v112, v36
    v_add_f32 v113, v113, v37
    v_exp_f32 v38, v38
    v_mfma_f32_32x32x16_bf16 v[48:63], a[92:95], a[60:63], v[48:63]
    v_add_f32 v112, v112, v38
    v_exp_f32 v39, v39
    v_exp_f32 v40, v40
    s_waitcnt lgkmcnt(0)
    v_mfma_f32_32x32x16_bf16 v[128:143], a[128:131], v[64:67], v[128:143]
    ds_read_b128 a[64:67], v2 offset:0
    v_add_f32 v113, v113, v39
    v_add_f32 v112, v112, v40
    v_exp_f32 v41, v41
    v_mfma_f32_32x32x16_bf16 v[144:159], a[136:139], v[64:67], v[144:159]
    ds_read_b128 a[68:71], v2 offset:1024
    v_add_f32 v113, v113, v41
    v_exp_f32 v42, v42
    v_mfma_f32_32x32x16_bf16 v[160:175], a[144:147], v[64:67], v[160:175]
    v_add_f32 v112, v112, v42
    v_exp_f32 v43, v43
    v_exp_f32 v44, v44
    v_mfma_f32_32x32x16_bf16 v[176:191], a[152:155], v[64:67], v[176:191]
    ds_read_b128 a[72:75], v2 offset:2048
    v_cvt_pk_bf16_f32 v64, v32, v33
    v_cvt_pk_bf16_f32 v65, v34, v35
    v_cvt_pk_bf16_f32 v66, v36, v37
    v_cvt_pk_bf16_f32 v67, v38, v39
    v_mfma_f32_32x32x16_bf16 v[128:143], a[132:135], v[68:71], v[128:143]
    ds_read_b128 a[76:79], v2 offset:3072
    v_add_f32 v113, v113, v43
    v_add_f32 v112, v112, v44
    v_exp_f32 v45, v45
    v_mfma_f32_32x32x16_bf16 v[144:159], a[140:143], v[68:71], v[144:159]
    v_add_f32 v113, v113, v45
    v_exp_f32 v46, v46
    v_exp_f32 v47, v47
    v_mfma_f32_32x32x16_bf16 v[160:175], a[148:151], v[68:71], v[160:175]
    ds_read_b128 a[80:83], v2 offset:4096
    v_add_f32 v112, v112, v46
    v_add_f32 v113, v113, v47
    v_exp_f32 v48, v48
    v_mfma_f32_32x32x16_bf16 v[176:191], a[156:159], v[68:71], v[176:191]
    ds_read_b128 a[84:87], v2 offset:5120
    v_cvt_pk_bf16_f32 v68, v40, v41
    v_cvt_pk_bf16_f32 v69, v42, v43
    v_cvt_pk_bf16_f32 v70, v44, v45
    v_cvt_pk_bf16_f32 v71, v46, v47
    v_mfma_f32_32x32x16_bf16 v[192:207], a[128:131], v[72:75], v[192:207]
    v_add_f32 v114, v114, v48
    v_exp_f32 v49, v49
    v_exp_f32 v50, v50
    v_mfma_f32_32x32x16_bf16 v[208:223], a[136:139], v[72:75], v[208:223]
    ds_read_b128 a[88:91], v2 offset:6144
    v_add_f32 v115, v115, v49
    v_add_f32 v114, v114, v50
    v_exp_f32 v51, v51
    v_mfma_f32_32x32x16_bf16 v[224:239], a[144:147], v[72:75], v[224:239]
    ds_read_b128 a[92:95], v2 offset:7168
    v_add_f32 v115, v115, v51
    v_exp_f32 v52, v52
    v_mfma_f32_32x32x16_bf16 v[240:255], a[152:155], v[72:75], v[240:255]
    v_add_u32 v2, s35, v2
    v_cvt_pk_bf16_f32 v72, v48, v49
    v_cvt_pk_bf16_f32 v73, v50, v51
    v_add_f32 v114, v114, v52
    v_mfma_f32_32x32x16_bf16 v[192:207], a[132:135], v[76:79], v[192:207]
    v_and_b32 v2, 0xffff, v2
    v_exp_f32 v53, v53
    v_exp_f32 v54, v54
    s_add_u32 s29, s29, s33
    s_add_u32 s30, s30, s33
    v_mfma_f32_32x32x16_bf16 v[208:223], a[140:143], v[76:79], v[208:223]
    v_cvt_pk_bf16_f32 v74, v52, v53
    v_add_f32 v115, v115, v53
    v_add_f32 v114, v114, v54
    v_exp_f32 v55, v55
    v_mfma_f32_32x32x16_bf16 v[224:239], a[148:151], v[76:79], v[224:239]
    v_cvt_pk_bf16_f32 v75, v54, v55
    v_add_f32 v115, v115, v55
    v_exp_f32 v56, v56
    v_mfma_f32_32x32x16_bf16 v[240:255], a[156:159], v[76:79], v[240:255]
    v_exp_f32 v57, v57
    s_sub_u32 s24, s24, 1
    s_cmp_lg_u32 s24, 0
    s_cbranch_scc1 K2_P1M
    s_and_b32 s65, s20, 1
    s_add_u32 s29, s29, s65
    s_mov_b32 s30, s29
    s_xor_b32 s60, s20, 1
    s_mov_b32 s33, 2
    s_add_u32 s34, s64, 0x2000
    s_waitcnt vmcnt(16) lgkmcnt(0)
    s_barrier
    s_cmp_lt_i32 s29, s20
    s_cbranch_scc0 K2T_13
    v_mfma_f32_32x32x16_bf16 v[32:47], a[64:67], a[0:3], 0
    s_branch K2J_15
K2T_13:
    s_cmp_eq_i32 s29, s20
    s_cbranch_scc1 K2N_14
    v_mfma_f32_32x32x16_bf16 v[32:47], a[64:67], a[0:3], v[96:111]
    s_branch K2J_15
K2N_14:
    v_mfma_f32_32x32x16_bf16 v[32:47], a[64:67], a[0:3], v[80:95]
K2J_15:
    ds_read_b128 a[128:131], v3 offset:0
    v_cvt_pk_bf16_f32 v76, v56, v57
    v_add_f32 v114, v114, v56
    v_add_f32 v115, v115, v57
    v_mfma_f32_32x32x16_bf16 v[32:47], a[68:71], a[4:7], v[32:47]
    ds_read_b128 a[136:139], v3 offset:2048
    v_exp_f32 v58, v58
    v_exp_f32 v59, v59
    v_mfma_f32_32x32x16_bf16 v[32:47], a[72:75], a[8:11], v[32:47]
    v_cvt_pk_bf16_f32 v77, v58, v59
    v_add_f32 v114, v114, v58
    v_add_f32 v115, v115, v59
    v_exp_f32 v60, v60
    v_mfma_f32_32x32x16_bf16 v[32:47], a[76:79], a[12:15], v[32:47]
    ds_read_b128 a[144:147], v3 offset:4096
    v_add_f32 v114, v114, v60
    v_exp_f32 v61, v61
    v_mfma_f32_32x32x16_bf16 v[32:47], a[80:83], a[16:19], v[32:47]
    ds_read_b128 a[152:155], v3 offset:6144
    v_cvt_pk_bf16_f32 v78, v60, v61
    v_add_f32 v115, v115, v61
    v_exp_f32 v62, v62
    v_mfma_f32_32x32x16_bf16 v[32:47], a[84:87], a[20:23], v[32:47]
    v_add_f32 v114, v114, v62
    v_exp_f32 v63, v63
    v_mfma_f32_32x32x16_bf16 v[32:47], a[88:91], a[24:27], v[32:47]
    ds_read_b128 a[132:135], v3 offset:1024
    v_cvt_pk_bf16_f32 v79, v62, v63
    v_add_f32 v115, v115, v63
    v_mfma_f32_32x32x16_bf16 v[32:47], a[92:95], a[28:31], v[32:47]
    ds_read_b128 a[140:143], v3 offset:3072
    s_mov_b32 m0, s27
    s_add_u32 s27, s27, 0x2000
    buffer_load_dwordx4 v4, s[4:7], s25 offen lds
    buffer_load_dwordx4 v4, s[4:7], s25 offen offset:1024 lds
    s_and_b32 s27, s27, 0xffff
    s_cmp_lt_i32 s30, s60
    s_cbranch_scc0 K2T_16
    v_mfma_f32_32x32x16_bf16 v[48:63], a[64:67], a[192:195], 0
    s_branch K2J_18
K2T_16:
    s_cmp_eq_i32 s30, s60
    s_cbranch_scc1 K2N_17
    v_mfma_f32_32x32x16_bf16 v[48:63], a[64:67], a[192:195], v[96:111]
    s_branch K2J_18
K2N_17:
    v_mfma_f32_32x32x16_bf16 v[48:63], a[64:67], a[192:195], v[80:95]
K2J_18:
    s_add_u32 s25, s25, 0x2000
    s_mov_b32 m0, s28
    s_add_u32 s28, s28, 0x2000
    buffer_load_dwordx4 v4, s[8:11], s26 offen lds
    v_mfma_f32_32x32x16_bf16 v[48:63], a[68:71], a[196:199], v[48:63]
    ds_read_b128 a[148:151], v3 offset:5120
    buffer_load_dwordx4 v4, s[8:11], s26 offen offset:1024 lds
    s_and_b32 s28, s28, 0xffff
    s_or_b32 s28, s28, 0x10000
    s_add_u32 s26, s26, 0x2000
    v_mfma_f32_32x32x16_bf16 v[48:63], a[72:75], a[200:203], v[48:63]
    ds_read_b128 a[156:159], v3 offset:7168
    v_exp_f32 v32, v32
    v_exp_f32 v33, v33
    v_mfma_f32_32x32x16_bf16 v[48:63], a[76:79], a[204:207], v[48:63]
    v_add_u32 v5, s34, v3
    v_add_f32 v112, v112, v32
    v_add_f32 v113, v113, v33
    v_exp_f32 v34, v34
    v_mfma_f32_32x32x16_bf16 v[48:63], a[80:83], a[208:211], v[48:63]
    v_bfi_b32 v3, s31, v5, v3
    v_add_f32 v112, v112, v34
    v_exp_f32 v35, v35
    v_mfma_f32_32x32x16_bf16 v[48:63], a[84:87], a[212:215], v[48:63]
    v_add_f32 v113, v113, v35
    v_exp_f32 v36, v36
    v_exp_f32 v37, v37
    v_mfma_f32_32x32x16_bf16 v[48:63], a[88:91], a[216:219], v[48:63]
    v_add_f32 v112, v112, v36
    v_add_f32 v113, v113, v37
    v_exp_f32 v38, v38
    v_mfma_f32_32x32x16_bf16 v[48:63], a[92:95], a[220:223], v[48:63]
    v_add_f32 v112, v112, v38
    v_exp_f32 v39, v39
    v_exp_f32 v40, v40
    s_waitcnt lgkmcnt(0)
    v_mfma_f32_32x32x16_bf16 v[128:143], a[128:131], v[64:67], v[128:143]
    ds_read_b128 a[64:67], v2 offset:0
    v_add_f32 v113, v113, v39
    v_add_f32 v112, v112, v40
    v_exp_f32 v41, v41
    v_mfma_f32_32x32x16_bf16 v[144:159], a[136:139], v[64:67], v[144:159]
    ds_read_b128 a[68:71], v2 offset:1024
    v_add_f32 v113, v113, v41
    v_exp_f32 v42, v42
    v_mfma_f32_32x32x16_bf16 v[160:175], a[144:147], v[64:67], v[160:175]
    v_add_f32 v112, v112, v42
    v_exp_f32 v43, v43
    v_exp_f32 v44, v44
    v_mfma_f32_32x32x16_bf16 v[176:191], a[152:155], v[64:67], v[176:191]
    ds_read_b128 a[72:75], v2 offset:2048
    v_cvt_pk_bf16_f32 v64, v32, v33
    v_cvt_pk_bf16_f32 v65, v34, v35
    v_cvt_pk_bf16_f32 v66, v36, v37
    v_cvt_pk_bf16_f32 v67, v38, v39
    v_mfma_f32_32x32x16_bf16 v[128:143], a[132:135], v[68:71], v[128:143]
    ds_read_b128 a[76:79], v2 offset:3072
    v_add_f32 v113, v113, v43
    v_add_f32 v112, v112, v44
    v_exp_f32 v45, v45
    v_mfma_f32_32x32x16_bf16 v[144:159], a[140:143], v[68:71], v[144:159]
    v_add_f32 v113, v113, v45
    v_exp_f32 v46, v46
    v_exp_f32 v47, v47
    v_mfma_f32_32x32x16_bf16 v[160:175], a[148:151], v[68:71], v[160:175]
    ds_read_b128 a[80:83], v2 offset:4096
    v_add_f32 v112, v112, v46
    v_add_f32 v113, v113, v47
    v_exp_f32 v48, v48
    v_mfma_f32_32x32x16_bf16 v[176:191], a[156:159], v[68:71], v[176:191]
    ds_read_b128 a[84:87], v2 offset:5120
    v_cvt_pk_bf16_f32 v68, v40, v41
    v_cvt_pk_bf16_f32 v69, v42, v43
    v_cvt_pk_bf16_f32 v70, v44, v45
    v_cvt_pk_bf16_f32 v71, v46, v47
    v_mfma_f32_32x32x16_bf16 v[192:207], a[128:131], v[72:75], v[192:207]
    v_add_f32 v116, v116, v48
    v_exp_f32 v49, v49
    v_exp_f32 v50, v50
    v_mfma_f32_32x32x16_bf16 v[208:223], a[136:139], v[72:75], v[208:223]
    ds_read_b128 a[88:91], v2 offset:6144
    v_add_f32 v117, v117, v49
    v_add_f32 v116, v116, v50
    v_exp_f32 v51, v51
    v_mfma_f32_32x32x16_bf16 v[224:239], a[144:147], v[72:75], v[224:239]
    ds_read_b128 a[92:95], v2 offset:7168
    v_add_f32 v117, v117, v51
    v_exp_f32 v52, v52
    v_mfma_f32_32x32x16_bf16 v[240:255], a[152:155], v[72:75], v[240:255]
    v_add_u32 v2, s35, v2
    v_cvt_pk_bf16_f32 v72, v48, v49
    v_cvt_pk_bf16_f32 v73, v50, v51
    v_add_f32 v116, v116, v52
    v_mfma_f32_32x32x16_bf16 v[192:207], a[132:135], v[76:79], v[192:207]
    v_and_b32 v2, 0xffff, v2
    v_exp_f32 v53, v53
    v_exp_f32 v54, v54
    s_add_u32 s29, s29, s33
    s_add_u32 s30, s30, s33
    v_mfma_f32_32x32x16_bf16 v[208:223], a[140:143], v[76:79], v[208:223]
    v_cvt_pk_bf16_f32 v74, v52, v53
    v_add_f32 v117, v117, v53
    v_add_f32 v116, v116, v54
    v_exp_f32 v55, v55
    v_mfma_f32_32x32x16_bf16 v[224:239], a[148:151], v[76:79], v[224:239]
    v_cvt_pk_bf16_f32 v75, v54, v55
    v_add_f32 v117, v117, v55
    v_exp_f32 v56, v56
    v_mfma_f32_32x32x16_bf16 v[240:255], a[156:159], v[76:79], v[240:255]
    v_exp_f32 v57, v57
    s_mov_b32 s34, 0x4000
    v_and_b32 v12, 31, v1
    v_lshrrev_b32 v13, 5, v1
    v_lshrrev_b32 v8, 4, v12
    v_lshlrev_b32 v8, 17, v8
    v_lshl_add_u32 v8, v13, 8, v8
    v_and_b32 v9, 15, v12
    v_lshl_add_u32 v8, v9, 4, v8
    s_lshl_b32 s44, s38, 12
    s_lshl_b32 s45, s41, 18
    s_add_u32 s45, s45, s44
    v_add_f32 v114, v114, v115
    v_mov_b32 v10, v114
    s_nop 1
    v_permlane32_swap_b32 v114, v10
    s_nop 1
    v_add_f32 v114, v114, v10
    v_pk_add_f32 v[14:15], v[192:193], v[194:195]
    v_pk_add_f32 v[14:15], v[14:15], v[196:197]
    v_pk_add_f32 v[14:15], v[14:15], v[198:199]
    v_pk_add_f32 v[14:15], v[14:15], v[200:201]
    v_pk_add_f32 v[14:15], v[14:15], v[202:203]
    v_pk_add_f32 v[14:15], v[14:15], v[204:205]
    v_pk_add_f32 v[14:15], v[14:15], v[206:207]
    v_pk_add_f32 v[14:15], v[14:15], v[208:209]
    v_pk_add_f32 v[14:15], v[14:15], v[210:211]
    v_pk_add_f32 v[14:15], v[14:15], v[212:213]
    v_pk_add_f32 v[14:15], v[14:15], v[214:215]
    v_pk_add_f32 v[14:15], v[14:15], v[216:217]
    v_pk_add_f32 v[14:15], v[14:15], v[218:219]
    v_pk_add_f32 v[14:15], v[14:15], v[220:221]
    v_pk_add_f32 v[14:15], v[14:15], v[222:223]
    v_pk_add_f32 v[14:15], v[14:15], v[224:225]
    v_pk_add_f32 v[14:15], v[14:15], v[226:227]
    v_pk_add_f32 v[14:15], v[14:15], v[228:229]
    v_pk_add_f32 v[14:15], v[14:15], v[230:231]
    v_pk_add_f32 v[14:15], v[14:15], v[232:233]
    v_pk_add_f32 v[14:15], v[14:15], v[234:235]
    v_pk_add_f32 v[14:15], v[14:15], v[236:237]
    v_pk_add_f32 v[14:15], v[14:15], v[238:239]
    v_pk_add_f32 v[14:15], v[14:15], v[240:241]
    v_pk_add_f32 v[14:15], v[14:15], v[242:243]
    v_pk_add_f32 v[14:15], v[14:15], v[244:245]
    v_pk_add_f32 v[14:15], v[14:15], v[246:247]
    v_pk_add_f32 v[14:15], v[14:15], v[248:249]
    v_pk_add_f32 v[14:15], v[14:15], v[250:251]
    v_pk_add_f32 v[14:15], v[14:15], v[252:253]
    v_pk_add_f32 v[14:15], v[14:15], v[254:255]
    v_add_f32 v14, v14, v15
    s_mov_b32 s67, 0x21800000
    s_mov_b32 s68, 0x5d800000
    v_cmp_nle_f32 s[70:71], s67, v114
    v_cmp_nge_f32 s[72:73], s68, v114
    v_cmp_class_f32 vcc, v14, s69
    s_nop 1
    s_or_b64 s[70:71], s[70:71], s[72:73]
    s_or_b64 s[70:71], s[70:71], vcc
    s_cmp_eq_u64 s[70:71], 0
    s_cbranch_scc1 K2_OK_19
    s_or_b32 s66, s66, 1
    s_branch K2_DONE_20
K2_OK_19:
    v_rcp_f32 v10, v114
    s_nop 0
    v_mov_b32 v11, v10
    v_pk_mul_f32 v[192:193], v[192:193], v[10:11]
    v_pk_mul_f32 v[194:195], v[194:195], v[10:11]
    v_cvt_pk_bf16_f32 v16, v192, v193
    v_cvt_pk_bf16_f32 v17, v194, v195
    v_pk_mul_f32 v[200:201], v[200:201], v[10:11]
    v_pk_mul_f32 v[202:203], v[202:203], v[10:11]
    v_cvt_pk_bf16_f32 v18, v200, v201
    v_cvt_pk_bf16_f32 v19, v202, v203
    buffer_store_dwordx4 v[16:19], v8, s[16:19], s45 offen offset:0 sc1
    v_pk_mul_f32 v[196:197], v[196:197], v[10:11]
    v_pk_mul_f32 v[198:199], v[198:199], v[10:11]
    v_cvt_pk_bf16_f32 v20, v196, v197
    v_cvt_pk_bf16_f32 v21, v198, v199
    v_pk_mul_f32 v[204:205], v[204:205], v[10:11]
    v_pk_mul_f32 v[206:207], v[206:207], v[10:11]
    v_cvt_pk_bf16_f32 v22, v204, v205
    v_cvt_pk_bf16_f32 v23, v206, v207
    buffer_store_dwordx4 v[20:23], v8, s[16:19], s45 offen offset:512 sc1
    v_pk_mul_f32 v[208:209], v[208:209], v[10:11]
    v_pk_mul_f32 v[210:211], v[210:211], v[10:11]
    v_cvt_pk_bf16_f32 v24, v208, v209
    v_cvt_pk_bf16_f32 v25, v210, v211
    v_pk_mul_f32 v[216:217], v[216:217], v[10:11]
    v_pk_mul_f32 v[218:219], v[218:219], v[10:11]
    v_cvt_pk_bf16_f32 v26, v216, v217
    v_cvt_pk_bf16_f32 v27, v218, v219
    buffer_store_dwordx4 v[24:27], v8, s[16:19], s45 offen offset:1024 sc1
    v_pk_mul_f32 v[212:213], v[212:213], v[10:11]
    v_pk_mul_f32 v[214:215], v[214:215], v[10:11]
    v_cvt_pk_bf16_f32 v28, v212, v213
    v_cvt_pk_bf16_f32 v29, v214, v215
    v_pk_mul_f32 v[220:221], v[220:221], v[10:11]
    v_pk_mul_f32 v[222:223], v[222:223], v[10:11]
    v_cvt_pk_bf16_f32 v30, v220, v221
    v_cvt_pk_bf16_f32 v31, v222, v223
    buffer_store_dwordx4 v[28:31], v8, s[16:19], s45 offen offset:1536 sc1
    v_pk_mul_f32 v[224:225], v[224:225], v[10:11]
    v_pk_mul_f32 v[226:227], v[226:227], v[10:11]
    v_cvt_pk_bf16_f32 v16, v224, v225
    v_cvt_pk_bf16_f32 v17, v226, v227
    v_pk_mul_f32 v[232:233], v[232:233], v[10:11]
    v_pk_mul_f32 v[234:235], v[234:235], v[10:11]
    v_cvt_pk_bf16_f32 v18, v232, v233
    v_cvt_pk_bf16_f32 v19, v234, v235
    buffer_store_dwordx4 v[16:19], v8, s[16:19], s45 offen offset:2048 sc1
    v_pk_mul_f32 v[228:229], v[228:229], v[10:11]
    v_pk_mul_f32 v[230:231], v[230:231], v[10:11]
    v_cvt_pk_bf16_f32 v20, v228, v229
    v_cvt_pk_bf16_f32 v21, v230, v231
    v_pk_mul_f32 v[236:237], v[236:237], v[10:11]
    v_pk_mul_f32 v[238:239], v[238:239], v[10:11]
    v_cvt_pk_bf16_f32 v22, v236, v237
    v_cvt_pk_bf16_f32 v23, v238, v239
    buffer_store_dwordx4 v[20:23], v8, s[16:19], s45 offen offset:2560 sc1
    v_pk_mul_f32 v[240:241], v[240:241], v[10:11]
    v_pk_mul_f32 v[242:243], v[242:243], v[10:11]
    v_cvt_pk_bf16_f32 v24, v240, v241
    v_cvt_pk_bf16_f32 v25, v242, v243
    v_pk_mul_f32 v[248:249], v[248:249], v[10:11]
    v_pk_mul_f32 v[250:251], v[250:251], v[10:11]
    v_cvt_pk_bf16_f32 v26, v248, v249
    v_cvt_pk_bf16_f32 v27, v250, v251
    buffer_store_dwordx4 v[24:27], v8, s[16:19], s45 offen offset:3072 sc1
    v_pk_mul_f32 v[244:245], v[244:245], v[10:11]
    v_pk_mul_f32 v[246:247], v[246:247], v[10:11]
    v_cvt_pk_bf16_f32 v28, v244, v245
    v_cvt_pk_bf16_f32 v29, v246, v247
    v_pk_mul_f32 v[252:253], v[252:253], v[10:11]
    v_pk_mul_f32 v[254:255], v[254:255], v[10:11]
    v_cvt_pk_bf16_f32 v30, v252, v253
    v_cvt_pk_bf16_f32 v31, v254, v255
    buffer_store_dwordx4 v[28:31], v8, s[16:19], s45 offen offset:3584 sc1
K2_DONE_20:
    s_sub_u32 s24, s23, s22
    s_lshr_b32 s24, s24, 1
    s_sub_u32 s24, s24, 3
    s_cmp_gt_i32 s24, 0
    s_cbranch_scc0 K2_P2M_PRE
    s_lshl_b32 s65, s24, 1
    s_add_u32 s29, s29, s65
    s_add_u32 s30, s30, s65
.p2align 6
K2_P2U:
    s_waitcnt vmcnt(14) lgkmcnt(0)
    s_barrier
    v_mfma_f32_32x32x16_bf16 v[32:47], a[64:67], a[0:3], 0
    ds_read_b128 a[128:131], v3 offset:0
    v_cvt_pk_bf16_f32 v76, v56, v57
    v_add_f32 v116, v116, v56
    v_add_f32 v117, v117, v57
    v_mfma_f32_32x32x16_bf16 v[32:47], a[68:71], a[4:7], v[32:47]
    ds_read_b128 a[136:139], v3 offset:2048
    v_exp_f32 v58, v58
    v_exp_f32 v59, v59
    v_mfma_f32_32x32x16_bf16 v[32:47], a[72:75], a[8:11], v[32:47]
    v_cvt_pk_bf16_f32 v77, v58, v59
    v_add_f32 v116, v116, v58
    v_add_f32 v117, v117, v59
    v_exp_f32 v60, v60
    v_mfma_f32_32x32x16_bf16 v[32:47], a[76:79], a[12:15], v[32:47]
    ds_read_b128 a[144:147], v3 offset:4096
    v_add_f32 v116, v116, v60
    v_exp_f32 v61, v61
    v_mfma_f32_32x32x16_bf16 v[32:47], a[80:83], a[16:19], v[32:47]
    ds_read_b128 a[152:155], v3 offset:6144
    v_cvt_pk_bf16_f32 v78, v60, v61
    v_add_f32 v117, v117, v61
    v_exp_f32 v62, v62
    v_mfma_f32_32x32x16_bf16 v[32:47], a[84:87], a[20:23], v[32:47]
    v_add_f32 v116, v116, v62
    v_exp_f32 v63, v63
    v_mfma_f32_32x32x16_bf16 v[32:47], a[88:91], a[24:27], v[32:47]
    ds_read_b128 a[132:135], v3 offset:1024
    v_cvt_pk_bf16_f32 v79, v62, v63
    v_add_f32 v117, v117, v63
    v_mfma_f32_32x32x16_bf16 v[32:47], a[92:95], a[28:31], v[32:47]
    ds_read_b128 a[140:143], v3 offset:3072
    s_mov_b32 m0, s27
    s_add_u32 s27, s27, 0x2000
    buffer_load_dwordx4 v4, s[4:7], s25 offen lds
    buffer_load_dwordx4 v4, s[4:7], s25 offen offset:1024 lds
    s_and_b32 s27, s27, 0xffff
    v_mfma_f32_32x32x16_bf16 v[48:63], a[64:67], a[192:195], 0
    s_add_u32 s25, s25, 0x2000
    s_mov_b32 m0, s28
    s_add_u32 s28, s28, 0x2000
    buffer_load_dwordx4 v4, s[8:11], s26 offen lds
    v_mfma_f32_32x32x16_bf16 v[48:63], a[68:71], a[196:199], v[48:63]
    ds_read_b128 a[148:151], v3 offset:5120
    buffer_load_dwordx4 v4, s[8:11], s26 offen offset:1024 lds
    s_and_b32 s28, s28, 0xffff
    s_or_b32 s28, s28, 0x10000
    s_add_u32 s26, s26, 0x2000
    v_mfma_f32_32x32x16_bf16 v[48:63], a[72:75], a[200:203], v[48:63]
    ds_read_b128 a[156:159], v3 offset:7168
    v_exp_f32 v32, v32
    v_exp_f32 v33, v33
    v_add_f32 v112, v112, v32
    v_mfma_f32_32x32x16_bf16 v[48:63], a[76:79], a[204:207], v[48:63]
    v_add_u32 v5, s34, v3
    v_add_f32 v113, v113, v33
    v_exp_f32 v34, v34
    v_mfma_f32_32x32x16_bf16 v[48:63], a[80:83], a[208:211], v[48:63]
    v_bfi_b32 v3, s31, v5, v3
    v_add_f32 v112, v112, v34
    v_exp_f32 v35, v35
    v_exp_f32 v36, v36
    v_mfma_f32_32x32x16_bf16 v[48:63], a[84:87], a[212:215], v[48:63]
    v_add_f32 v113, v113, v35
    v_add_f32 v112, v112, v36
    v_exp_f32 v37, v37
    v_mfma_f32_32x32x16_bf16 v[48:63], a[88:91], a[216:219], v[48:63]
    v_add_f32 v113, v113, v37
    v_exp_f32 v38, v38
    v_exp_f32 v39, v39
    v_add_f32 v112, v112, v38
    v_mfma_f32_32x32x16_bf16 v[48:63], a[92:95], a[220:223], v[48:63]
    v_add_f32 v113, v113, v39
    v_exp_f32 v40, v40
    v_exp_f32 v41, v41
    s_waitcnt lgkmcnt(0)
    v_mfma_f32_32x32x16_bf16 v[128:143], a[128:131], v[64:67], v[128:143]
    ds_read_b128 a[64:67], v2 offset:0
    v_add_f32 v112, v112, v40
    v_add_f32 v113, v113, v41
    v_exp_f32 v42, v42
    v_mfma_f32_32x32x16_bf16 v[144:159], a[136:139], v[64:67], v[144:159]
    ds_read_b128 a[68:71], v2 offset:1024
    v_add_f32 v112, v112, v42
    v_exp_f32 v43, v43
    v_mfma_f32_32x32x16_bf16 v[160:175], a[144:147], v[64:67], v[160:175]
    v_add_f32 v113, v113, v43
    v_exp_f32 v44, v44
    v_exp_f32 v45, v45
    v_add_f32 v112, v112, v44
    v_mfma_f32_32x32x16_bf16 v[176:191], a[152:155], v[64:67], v[176:191]
    ds_read_b128 a[72:75], v2 offset:2048
    v_cvt_pk_bf16_f32 v64, v32, v33
    v_cvt_pk_bf16_f32 v65, v34, v35
    v_cvt_pk_bf16_f32 v66, v36, v37
    v_cvt_pk_bf16_f32 v67, v38, v39
    v_mfma_f32_32x32x16_bf16 v[128:143], a[132:135], v[68:71], v[128:143]
    ds_read_b128 a[76:79], v2 offset:3072
    v_add_f32 v113, v113, v45
    v_exp_f32 v46, v46
    v_exp_f32 v47, v47
    v_mfma_f32_32x32x16_bf16 v[144:159], a[140:143], v[68:71], v[144:159]
    v_add_f32 v112, v112, v46
    v_add_f32 v113, v113, v47
    v_exp_f32 v48, v48
    v_mfma_f32_32x32x16_bf16 v[160:175], a[148:151], v[68:71], v[160:175]
    ds_read_b128 a[80:83], v2 offset:4096
    v_add_f32 v116, v116, v48
    v_exp_f32 v49, v49
    v_exp_f32 v50, v50
    v_mfma_f32_32x32x16_bf16 v[176:191], a[156:159], v[68:71], v[176:191]
    ds_read_b128 a[84:87], v2 offset:5120
    v_cvt_pk_bf16_f32 v68, v40, v41
    v_cvt_pk_bf16_f32 v69, v42, v43
    v_cvt_pk_bf16_f32 v70, v44, v45
    v_cvt_pk_bf16_f32 v71, v46, v47
    v_mfma_f32_32x32x16_bf16 a[96:111], a[128:131], v[72:75], a[96:111]
    v_add_f32 v117, v117, v49
    v_add_f32 v116, v116, v50
    v_exp_f32 v51, v51
    v_exp_f32 v52, v52
    v_mfma_f32_32x32x16_bf16 a[112:127], a[136:139], v[72:75], a[112:127]
    ds_read_b128 a[88:91], v2 offset:6144
    v_add_f32 v117, v117, v51
    v_add_f32 v116, v116, v52
    v_exp_f32 v53, v53
    v_mfma_f32_32x32x16_bf16 a[160:175], a[144:147], v[72:75], a[160:175]
    ds_read_b128 a[92:95], v2 offset:7168
    v_add_f32 v117, v117, v53
    v_exp_f32 v54, v54
    v_exp_f32 v55, v55
    v_mfma_f32_32x32x16_bf16 a[176:191], a[152:155], v[72:75], a[176:191]
    v_add_u32 v2, s35, v2
    s_mov_b32 m0, s27
    s_add_u32 s27, s27, 0x2000
    buffer_load_dwordx4 v4, s[4:7], s25 offen lds
    v_cvt_pk_bf16_f32 v72, v48, v49
    v_mfma_f32_32x32x16_bf16 a[96:111], a[132:135], v[76:79], a[96:111]
    v_and_b32 v2, 0xffff, v2
    buffer_load_dwordx4 v4, s[4:7], s25 offen offset:1024 lds
    s_and_b32 s27, s27, 0xffff
    s_add_u32 s25, s25, 0x2000
    v_cvt_pk_bf16_f32 v73, v50, v51
    v_cvt_pk_bf16_f32 v74, v52, v53
    v_mfma_f32_32x32x16_bf16 a[112:127], a[140:143], v[76:79], a[112:127]
    s_mov_b32 m0, s28
    s_add_u32 s28, s28, 0x2000
    v_cvt_pk_bf16_f32 v75, v54, v55
    v_add_f32 v116, v116, v54
    v_add_f32 v117, v117, v55
    v_mfma_f32_32x32x16_bf16 a[160:175], a[148:151], v[76:79], a[160:175]
    buffer_load_dwordx4 v4, s[8:11], s26 offen lds
    buffer_load_dwordx4 v4, s[8:11], s26 offen offset:1024 lds
    s_and_b32 s28, s28, 0xffff
    v_exp_f32 v56, v56
    v_mfma_f32_32x32x16_bf16 a[176:191], a[156:159], v[76:79], a[176:191]
    s_or_b32 s28, s28, 0x10000
    s_add_u32 s26, s26, 0x2000
    v_exp_f32 v57, v57
    s_sub_u32 s24, s24, 1
    s_cmp_lg_u32 s24, 0
    s_cbranch_scc1 K2_P2U
K2_P2M_PRE:
    s_sub_u32 s24, s23, s22
    s_lshr_b32 s24, s24, 1
    s_sub_u32 s24, s24, 1
    s_min_u32 s24, s24, 2
.p2align 6
K2_P2M:
    s_cmp_eq_u32 s24, 1
    s_cselect_b32 s65, 1, 0
    s_cmp_lg_u32 s21, 7
    s_cselect_b32 s65, s65, 0
    s_cmp_eq_u32 s65, 0
    s_cbranch_scc1 K2_W_21
    s_waitcnt vmcnt(6)
K2_W_21:
    s_waitcnt vmcnt(14) lgkmcnt(0)
    s_barrier
    s_cmp_lt_i32 s29, s20
    s_cbranch_scc0 K2T_22
    v_mfma_f32_32x32x16_bf16 v[32:47], a[64:67], a[0:3], 0
    s_branch K2J_24
K2T_22:
    s_cmp_eq_i32 s29, s20
    s_cbranch_scc1 K2N_23
    v_mfma_f32_32x32x16_bf16 v[32:47], a[64:67], a[0:3], v[96:111]
    s_branch K2J_24
K2N_23:
    v_mfma_f32_32x32x16_bf16 v[32:47], a[64:67], a[0:3], v[80:95]
K2J_24:
    ds_read_b128 a[128:131], v3 offset:0
    v_cvt_pk_bf16_f32 v76, v56, v57
    v_add_f32 v116, v116, v56
    v_add_f32 v117, v117, v57
    v_mfma_f32_32x32x16_bf16 v[32:47], a[68:71], a[4:7], v[32:47]
    ds_read_b128 a[136:139], v3 offset:2048
    v_exp_f32 v58, v58
    v_exp_f32 v59, v59
    v_mfma_f32_32x32x16_bf16 v[32:47], a[72:75], a[8:11], v[32:47]
    v_cvt_pk_bf16_f32 v77, v58, v59
    v_add_f32 v116, v116, v58
    v_add_f32 v117, v117, v59
    v_exp_f32 v60, v60
    v_mfma_f32_32x32x16_bf16 v[32:47], a[76:79], a[12:15], v[32:47]
    ds_read_b128 a[144:147], v3 offset:4096
    v_add_f32 v116, v116, v60
    v_exp_f32 v61, v61
    v_mfma_f32_32x32x16_bf16 v[32:47], a[80:83], a[16:19], v[32:47]
    ds_read_b128 a[152:155], v3 offset:6144
    v_cvt_pk_bf16_f32 v78, v60, v61
    v_add_f32 v117, v117, v61
    v_exp_f32 v62, v62
    v_mfma_f32_32x32x16_bf16 v[32:47], a[84:87], a[20:23], v[32:47]
    v_add_f32 v116, v116, v62
    v_exp_f32 v63, v63
    v_mfma_f32_32x32x16_bf16 v[32:47], a[88:91], a[24:27], v[32:47]
    ds_read_b128 a[132:135], v3 offset:1024
    v_cvt_pk_bf16_f32 v79, v62, v63
    v_add_f32 v117, v117, v63
    v_mfma_f32_32x32x16_bf16 v[32:47], a[92:95], a[28:31], v[32:47]
    ds_read_b128 a[140:143], v3 offset:3072
    s_cmp_lt_i32 s30, s60
    s_cbranch_scc0 K2T_25
    v_mfma_f32_32x32x16_bf16 v[48:63], a[64:67], a[192:195], 0
    s_branch K2J_27
K2T_25:
    s_cmp_eq_i32 s30, s60
    s_cbranch_scc1 K2N_26
    v_mfma_f32_32x32x16_bf16 v[48:63], a[64:67], a[192:195], v[96:111]
    s_branch K2J_27
K2N_26:
    v_mfma_f32_32x32x16_bf16 v[48:63], a[64:67], a[192:195], v[80:95]
K2J_27:
    s_nop 5
    v_mfma_f32_32x32x16_bf16 v[48:63], a[68:71], a[196:199], v[48:63]
    ds_read_b128 a[148:151], v3 offset:5120
    v_mfma_f32_32x32x16_bf16 v[48:63], a[72:75], a[200:203], v[48:63]
    ds_read_b128 a[156:159], v3 offset:7168
    v_exp_f32 v32, v32
    v_exp_f32 v33, v33
    v_add_f32 v112, v112, v32
    v_mfma_f32_32x32x16_bf16 v[48:63], a[76:79], a[204:207], v[48:63]
    v_add_u32 v5, s34, v3
    v_add_f32 v113, v113, v33
    v_exp_f32 v34, v34
    v_mfma_f32_32x32x16_bf16 v[48:63], a[80:83], a[208:211], v[48:63]
    v_bfi_b32 v3, s31, v5, v3
    v_add_f32 v112, v112, v34
    v_exp_f32 v35, v35
    v_exp_f32 v36, v36
    v_mfma_f32_32x32x16_bf16 v[48:63], a[84:87], a[212:215], v[48:63]
    v_add_f32 v113, v113, v35
    v_add_f32 v112, v112, v36
    v_exp_f32 v37, v37
    v_mfma_f32_32x32x16_bf16 v[48:63], a[88:91], a[216:219], v[48:63]
    v_add_f32 v113, v113, v37
    v_exp_f32 v38, v38
    v_exp_f32 v39, v39
    v_add_f32 v112, v112, v38
    v_mfma_f32_32x32x16_bf16 v[48:63], a[92:95], a[220:223], v[48:63]
    v_add_f32 v113, v113, v39
    v_exp_f32 v40, v40
    v_exp_f32 v41, v41
    s_waitcnt lgkmcnt(0)
    v_mfma_f32_32x32x16_bf16 v[128:143], a[128:131], v[64:67], v[128:143]
    ds_read_b128 a[64:67], v2 offset:0
    v_add_f32 v112, v112, v40
    v_add_f32 v113, v113, v41
    v_exp_f32 v42, v42
    v_mfma_f32_32x32x16_bf16 v[144:159], a[136:139], v[64:67], v[144:159]
    ds_read_b128 a[68:71], v2 offset:1024
    v_add_f32 v112, v112, v42
    v_exp_f32 v43, v43
    v_mfma_f32_32x32x16_bf16 v[160:175], a[144:147], v[64:67], v[160:175]
    v_add_f32 v113, v113, v43
    v_exp_f32 v44, v44
    v_exp_f32 v45, v45
    v_add_f32 v112, v112, v44
    v_mfma_f32_32x32x16_bf16 v[176:191], a[152:155], v[64:67], v[176:191]
    ds_read_b128 a[72:75], v2 offset:2048
    v_cvt_pk_bf16_f32 v64, v32, v33
    v_cvt_pk_bf16_f32 v65, v34, v35
    v_cvt_pk_bf16_f32 v66, v36, v37
    v_cvt_pk_bf16_f32 v67, v38, v39
    v_mfma_f32_32x32x16_bf16 v[128:143], a[132:135], v[68:71], v[128:143]
    ds_read_b128 a[76:79], v2 offset:3072
    v_add_f32 v113, v113, v45
    v_exp_f32 v46, v46
    v_exp_f32 v47, v47
    v_mfma_f32_32x32x16_bf16 v[144:159], a[140:143], v[68:71], v[144:159]
    v_add_f32 v112, v112, v46
    v_add_f32 v113, v113, v47
    v_exp_f32 v48, v48
    v_mfma_f32_32x32x16_bf16 v[160:175], a[148:151], v[68:71], v[160:175]
    ds_read_b128 a[80:83], v2 offset:4096
    v_add_f32 v116, v116, v48
    v_exp_f32 v49, v49
    v_exp_f32 v50, v50
    v_mfma_f32_32x32x16_bf16 v[176:191], a[156:159], v[68:71], v[176:191]
    ds_read_b128 a[84:87], v2 offset:5120
    v_cvt_pk_bf16_f32 v68, v40, v41
    v_cvt_pk_bf16_f32 v69, v42, v43
    v_cvt_pk_bf16_f32 v70, v44, v45
    v_cvt_pk_bf16_f32 v71, v46, v47
    v_mfma_f32_32x32x16_bf16 a[96:111], a[128:131], v[72:75], a[96:111]
    v_add_f32 v117, v117, v49
    v_add_f32 v116, v116, v50
    v_exp_f32 v51, v51
    v_exp_f32 v52, v52
    v_mfma_f32_32x32x16_bf16 a[112:127], a[136:139], v[72:75], a[112:127]
    ds_read_b128 a[88:91], v2 offset:6144
    v_add_f32 v117, v117, v51
    v_add_f32 v116, v116, v52
    v_exp_f32 v53, v53
    v_mfma_f32_32x32x16_bf16 a[160:175], a[144:147], v[72:75], a[160:175]
    ds_read_b128 a[92:95], v2 offset:7168
    v_add_f32 v117, v117, v53
    v_exp_f32 v54, v54
    v_exp_f32 v55, v55
    v_mfma_f32_32x32x16_bf16 a[176:191], a[152:155], v[72:75], a[176:191]
    v_add_u32 v2, s35, v2
    v_cvt_pk_bf16_f32 v72, v48, v49
    v_mfma_f32_32x32x16_bf16 a[96:111], a[132:135], v[76:79], a[96:111]
    v_and_b32 v2, 0xffff, v2
    v_cvt_pk_bf16_f32 v73, v50, v51
    v_cvt_pk_bf16_f32 v74, v52, v53
    s_add_u32 s29, s29, s33
    s_add_u32 s30, s30, s33
    v_mfma_f32_32x32x16_bf16 a[112:127], a[140:143], v[76:79], a[112:127]
    v_cvt_pk_bf16_f32 v75, v54, v55
    v_add_f32 v116, v116, v54
    v_add_f32 v117, v117, v55
    v_mfma_f32_32x32x16_bf16 a[160:175], a[148:151], v[76:79], a[160:175]
    v_exp_f32 v56, v56
    v_mfma_f32_32x32x16_bf16 a[176:191], a[156:159], v[76:79], a[176:191]
    v_exp_f32 v57, v57
    s_sub_u32 s24, s24, 1
    s_cmp_lg_u32 s24, 0
    s_cbranch_scc1 K2_P2M
    s_cmp_eq_u32 s21, 7
    s_cselect_b32 s65, 1, 0
    s_andn2_b32 s65, s65, s66
    s_cmp_eq_u32 s65, 1
    s_cbranch_scc1 K2_W_28
    s_waitcnt vmcnt(0)
K2_W_28:
    s_waitcnt vmcnt(6) lgkmcnt(0)
    s_barrier
    ds_read_b128 a[128:131], v3 offset:0
    ds_read_b128 a[136:139], v3 offset:2048
    ds_read_b128 a[144:147], v3 offset:4096
    ds_read_b128 a[152:155], v3 offset:6144
    ds_read_b128 a[132:135], v3 offset:1024
    ds_read_b128 a[140:143], v3 offset:3072
    ds_read_b128 a[148:151], v3 offset:5120
    ds_read_b128 a[156:159], v3 offset:7168
    s_lshl_b32 s65, s20, 14
    v_add_u32 v6, s65, v4
    s_lshl_b32 s65, s20, 8
    s_add_u32 s65, s65, 0x20000
    v_lshlrev_b32 v7, 2, v1
    v_add_u32 v7, s65, v7
    v_cvt_pk_bf16_f32 v76, v56, v57
    v_add_f32 v116, v116, v56
    v_add_f32 v117, v117, v57
    v_exp_f32 v58, v58
    v_exp_f32 v59, v59
    s_nop 0
    v_cvt_pk_bf16_f32 v77, v58, v59
    v_add_f32 v116, v116, v58
    v_add_f32 v117, v117, v59
    v_exp_f32 v60, v60
    v_exp_f32 v61, v61
    s_nop 0
    v_cvt_pk_bf16_f32 v78, v60, v61
    v_add_f32 v116, v116, v60
    v_add_f32 v117, v117, v61
    v_exp_f32 v62, v62
    v_exp_f32 v63, v63
    s_nop 0
    v_cvt_pk_bf16_f32 v79, v62, v63
    v_add_f32 v116, v116, v62
    v_add_f32 v117, v117, v63
    s_waitcnt lgkmcnt(0)
    v_mfma_f32_32x32x16_bf16 a[96:111], a[128:131], v[72:75], a[96:111]
    v_mfma_f32_32x32x16_bf16 a[112:127], a[136:139], v[72:75], a[112:127]
    v_mfma_f32_32x32x16_bf16 a[160:175], a[144:147], v[72:75], a[160:175]
    v_mfma_f32_32x32x16_bf16 a[176:191], a[152:155], v[72:75], a[176:191]
    v_mfma_f32_32x32x16_bf16 a[96:111], a[132:135], v[76:79], a[96:111]
    v_mfma_f32_32x32x16_bf16 a[112:127], a[140:143], v[76:79], a[112:127]
    v_mfma_f32_32x32x16_bf16 a[160:175], a[148:151], v[76:79], a[160:175]
    v_mfma_f32_32x32x16_bf16 a[176:191], a[156:159], v[76:79], a[176:191]
    v_mfma_f32_32x32x16_bf16 v[128:143], a[128:131], v[64:67], v[128:143]
    v_mfma_f32_32x32x16_bf16 v[144:159], a[136:139], v[64:67], v[144:159]
    v_mfma_f32_32x32x16_bf16 v[160:175], a[144:147], v[64:67], v[160:175]
    v_mfma_f32_32x32x16_bf16 v[176:191], a[152:155], v[64:67], v[176:191]
    v_add_f32 v116, v116, v117
    ds_write_b32 v7, v116
    v_mfma_f32_32x32x16_bf16 v[128:143], a[132:135], v[68:71], v[128:143]
    s_nop 1
    ds_write_b128 v6, a[96:99] offset:0
    ds_write_b128 v6, a[100:103] offset:1024
    ds_write_b128 v6, a[104:107] offset:2048
    ds_write_b128 v6, a[108:111] offset:3072
    v_mfma_f32_32x32x16_bf16 v[144:159], a[140:143], v[68:71], v[144:159]
    ds_write_b128 v6, a[112:115] offset:4096
    ds_write_b128 v6, a[116:119] offset:5120
    ds_write_b128 v6, a[120:123] offset:6144
    ds_write_b128 v6, a[124:127] offset:7168
    v_mfma_f32_32x32x16_bf16 v[160:175], a[148:151], v[68:71], v[160:175]
    ds_write_b128 v6, a[160:163] offset:8192
    ds_write_b128 v6, a[164:167] offset:9216
    ds_write_b128 v6, a[168:171] offset:10240
    ds_write_b128 v6, a[172:175] offset:11264
    v_mfma_f32_32x32x16_bf16 v[176:191], a[156:159], v[68:71], v[176:191]
    s_nop 7
    ds_write_b128 v6, a[176:179] offset:12288
    ds_write_b128 v6, a[180:183] offset:13312
    ds_write_b128 v6, a[184:187] offset:14336
    ds_write_b128 v6, a[188:191] offset:15360
    s_xor_b32 s65, s20, 1
    s_lshl_b32 s64, s65, 14
    v_add_u32 v6, s64, v4
    s_lshl_b32 s65, s65, 8
    s_add_u32 s65, s65, 0x20000
    v_lshlrev_b32 v7, 2, v1
    v_add_u32 v7, s65, v7
    s_waitcnt lgkmcnt(0)
    s_barrier
    ds_read_b128 v[32:35], v6 offset:0
    ds_read_b128 v[36:39], v6 offset:1024
    ds_read_b128 v[40:43], v6 offset:2048
    ds_read_b128 v[44:47], v6 offset:3072
    ds_read_b128 v[48:51], v6 offset:4096
    ds_read_b128 v[52:55], v6 offset:5120
    ds_read_b128 v[56:59], v6 offset:6144
    ds_read_b128 v[60:63], v6 offset:7168
    ds_read_b128 v[64:67], v6 offset:8192
    ds_read_b128 v[68:71], v6 offset:9216
    ds_read_b128 v[72:75], v6 offset:10240
    ds_read_b128 v[76:79], v6 offset:11264
    ds_read_b128 v[80:83], v6 offset:12288
    ds_read_b128 v[84:87], v6 offset:13312
    ds_read_b128 v[88:91], v6 offset:14336
    ds_read_b128 v[92:95], v6 offset:15360
    ds_read_b32 v116, v7
    s_lshl_b32 s45, s40, 18
    s_add_u32 s45, s45, s44
    v_add_f32 v112, v112, v113
    s_waitcnt lgkmcnt(0)
    v_add_f32 v112, v112, v116
    v_mov_b32 v10, v112
    s_nop 1
    v_permlane32_swap_b32 v112, v10
    s_nop 1
    v_add_f32 v112, v112, v10
    v_pk_add_f32 v[128:129], v[128:129], v[32:33]
    v_pk_add_f32 v[130:131], v[130:131], v[34:35]
    v_pk_add_f32 v[132:133], v[132:133], v[36:37]
    v_pk_add_f32 v[134:135], v[134:135], v[38:39]
    v_pk_add_f32 v[136:137], v[136:137], v[40:41]
    v_pk_add_f32 v[138:139], v[138:139], v[42:43]
    v_pk_add_f32 v[140:141], v[140:141], v[44:45]
    v_pk_add_f32 v[142:143], v[142:143], v[46:47]
    v_pk_add_f32 v[144:145], v[144:145], v[48:49]
    v_pk_add_f32 v[146:147], v[146:147], v[50:51]
    v_pk_add_f32 v[148:149], v[148:149], v[52:53]
    v_pk_add_f32 v[150:151], v[150:151], v[54:55]
    v_pk_add_f32 v[152:153], v[152:153], v[56:57]
    v_pk_add_f32 v[154:155], v[154:155], v[58:59]
    v_pk_add_f32 v[156:157], v[156:157], v[60:61]
    v_pk_add_f32 v[158:159], v[158:159], v[62:63]
    v_pk_add_f32 v[160:161], v[160:161], v[64:65]
    v_pk_add_f32 v[162:163], v[162:163], v[66:67]
    v_pk_add_f32 v[164:165], v[164:165], v[68:69]
    v_pk_add_f32 v[166:167], v[166:167], v[70:71]
    v_pk_add_f32 v[168:169], v[168:169], v[72:73]
    v_pk_add_f32 v[170:171], v[170:171], v[74:75]
    v_pk_add_f32 v[172:173], v[172:173], v[76:77]
    v_pk_add_f32 v[174:175], v[174:175], v[78:79]
    v_pk_add_f32 v[176:177], v[176:177], v[80:81]
    v_pk_add_f32 v[178:179], v[178:179], v[82:83]
    v_pk_add_f32 v[180:181], v[180:181], v[84:85]
    v_pk_add_f32 v[182:183], v[182:183], v[86:87]
    v_pk_add_f32 v[184:185], v[184:185], v[88:89]
    v_pk_add_f32 v[186:187], v[186:187], v[90:91]
    v_pk_add_f32 v[188:189], v[188:189], v[92:93]
    v_pk_add_f32 v[190:191], v[190:191], v[94:95]
    v_pk_add_f32 v[14:15], v[128:129], v[130:131]
    v_pk_add_f32 v[14:15], v[14:15], v[132:133]
    v_pk_add_f32 v[14:15], v[14:15], v[134:135]
    v_pk_add_f32 v[14:15], v[14:15], v[136:137]
    v_pk_add_f32 v[14:15], v[14:15], v[138:139]
    v_pk_add_f32 v[14:15], v[14:15], v[140:141]
    v_pk_add_f32 v[14:15], v[14:15], v[142:143]
    v_pk_add_f32 v[14:15], v[14:15], v[144:145]
    v_pk_add_f32 v[14:15], v[14:15], v[146:147]
    v_pk_add_f32 v[14:15], v[14:15], v[148:149]
    v_pk_add_f32 v[14:15], v[14:15], v[150:151]
    v_pk_add_f32 v[14:15], v[14:15], v[152:153]
    v_pk_add_f32 v[14:15], v[14:15], v[154:155]
    v_pk_add_f32 v[14:15], v[14:15], v[156:157]
    v_pk_add_f32 v[14:15], v[14:15], v[158:159]
    v_pk_add_f32 v[14:15], v[14:15], v[160:161]
    v_pk_add_f32 v[14:15], v[14:15], v[162:163]
    v_pk_add_f32 v[14:15], v[14:15], v[164:165]
    v_pk_add_f32 v[14:15], v[14:15], v[166:167]
    v_pk_add_f32 v[14:15], v[14:15], v[168:169]
    v_pk_add_f32 v[14:15], v[14:15], v[170:171]
    v_pk_add_f32 v[14:15], v[14:15], v[172:173]
    v_pk_add_f32 v[14:15], v[14:15], v[174:175]
    v_pk_add_f32 v[14:15], v[14:15], v[176:177]
    v_pk_add_f32 v[14:15], v[14:15], v[178:179]
    v_pk_add_f32 v[14:15], v[14:15], v[180:181]
    v_pk_add_f32 v[14:15], v[14:15], v[182:183]
    v_pk_add_f32 v[14:15], v[14:15], v[184:185]
    v_pk_add_f32 v[14:15], v[14:15], v[186:187]
    v_pk_add_f32 v[14:15], v[14:15], v[188:189]
    v_pk_add_f32 v[14:15], v[14:15], v[190:191]
    v_add_f32 v14, v14, v15
    s_mov_b32 s67, 0x21800000
    s_mov_b32 s68, 0x5d800000
    v_cmp_nle_f32 s[70:71], s67, v112
    v_cmp_nge_f32 s[72:73], s68, v112
    v_cmp_class_f32 vcc, v14, s69
    s_nop 1
    s_or_b64 s[70:71], s[70:71], s[72:73]
    s_or_b64 s[70:71], s[70:71], vcc
    s_cmp_eq_u64 s[70:71], 0
    s_cbranch_scc1 K2_OK_29
    s_or_b32 s66, s66, 2
    s_branch K2_DONE_30
K2_OK_29:
    v_rcp_f32 v10, v112
    s_nop 0
    v_mov_b32 v11, v10
    v_pk_mul_f32 v[128:129], v[128:129], v[10:11]
    v_pk_mul_f32 v[130:131], v[130:131], v[10:11]
    v_cvt_pk_bf16_f32 v16, v128, v129
    v_cvt_pk_bf16_f32 v17, v130, v131
    v_pk_mul_f32 v[136:137], v[136:137], v[10:11]
    v_pk_mul_f32 v[138:139], v[138:139], v[10:11]
    v_cvt_pk_bf16_f32 v18, v136, v137
    v_cvt_pk_bf16_f32 v19, v138, v139
    buffer_store_dwordx4 v[16:19], v8, s[16:19], s45 offen offset:0 sc1
    v_pk_mul_f32 v[132:133], v[132:133], v[10:11]
    v_pk_mul_f32 v[134:135], v[134:135], v[10:11]
    v_cvt_pk_bf16_f32 v20, v132, v133
    v_cvt_pk_bf16_f32 v21, v134, v135
    v_pk_mul_f32 v[140:141], v[140:141], v[10:11]
    v_pk_mul_f32 v[142:143], v[142:143], v[10:11]
    v_cvt_pk_bf16_f32 v22, v140, v141
    v_cvt_pk_bf16_f32 v23, v142, v143
    buffer_store_dwordx4 v[20:23], v8, s[16:19], s45 offen offset:512 sc1
    v_pk_mul_f32 v[144:145], v[144:145], v[10:11]
    v_pk_mul_f32 v[146:147], v[146:147], v[10:11]
    v_cvt_pk_bf16_f32 v24, v144, v145
    v_cvt_pk_bf16_f32 v25, v146, v147
    v_pk_mul_f32 v[152:153], v[152:153], v[10:11]
    v_pk_mul_f32 v[154:155], v[154:155], v[10:11]
    v_cvt_pk_bf16_f32 v26, v152, v153
    v_cvt_pk_bf16_f32 v27, v154, v155
    buffer_store_dwordx4 v[24:27], v8, s[16:19], s45 offen offset:1024 sc1
    v_pk_mul_f32 v[148:149], v[148:149], v[10:11]
    v_pk_mul_f32 v[150:151], v[150:151], v[10:11]
    v_cvt_pk_bf16_f32 v28, v148, v149
    v_cvt_pk_bf16_f32 v29, v150, v151
    v_pk_mul_f32 v[156:157], v[156:157], v[10:11]
    v_pk_mul_f32 v[158:159], v[158:159], v[10:11]
    v_cvt_pk_bf16_f32 v30, v156, v157
    v_cvt_pk_bf16_f32 v31, v158, v159
    buffer_store_dwordx4 v[28:31], v8, s[16:19], s45 offen offset:1536 sc1
    v_pk_mul_f32 v[160:161], v[160:161], v[10:11]
    v_pk_mul_f32 v[162:163], v[162:163], v[10:11]
    v_cvt_pk_bf16_f32 v16, v160, v161
    v_cvt_pk_bf16_f32 v17, v162, v163
    v_pk_mul_f32 v[168:169], v[168:169], v[10:11]
    v_pk_mul_f32 v[170:171], v[170:171], v[10:11]
    v_cvt_pk_bf16_f32 v18, v168, v169
    v_cvt_pk_bf16_f32 v19, v170, v171
    buffer_store_dwordx4 v[16:19], v8, s[16:19], s45 offen offset:2048 sc1
    v_pk_mul_f32 v[164:165], v[164:165], v[10:11]
    v_pk_mul_f32 v[166:167], v[166:167], v[10:11]
    v_cvt_pk_bf16_f32 v20, v164, v165
    v_cvt_pk_bf16_f32 v21, v166, v167
    v_pk_mul_f32 v[172:173], v[172:173], v[10:11]
    v_pk_mul_f32 v[174:175], v[174:175], v[10:11]
    v_cvt_pk_bf16_f32 v22, v172, v173
    v_cvt_pk_bf16_f32 v23, v174, v175
    buffer_store_dwordx4 v[20:23], v8, s[16:19], s45 offen offset:2560 sc1
    v_pk_mul_f32 v[176:177], v[176:177], v[10:11]
    v_pk_mul_f32 v[178:179], v[178:179], v[10:11]
    v_cvt_pk_bf16_f32 v24, v176, v177
    v_cvt_pk_bf16_f32 v25, v178, v179
    v_pk_mul_f32 v[184:185], v[184:185], v[10:11]
    v_pk_mul_f32 v[186:187], v[186:187], v[10:11]
    v_cvt_pk_bf16_f32 v26, v184, v185
    v_cvt_pk_bf16_f32 v27, v186, v187
    buffer_store_dwordx4 v[24:27], v8, s[16:19], s45 offen offset:3072 sc1
    v_pk_mul_f32 v[180:181], v[180:181], v[10:11]
    v_pk_mul_f32 v[182:183], v[182:183], v[10:11]
    v_cvt_pk_bf16_f32 v28, v180, v181
    v_cvt_pk_bf16_f32 v29, v182, v183
    v_pk_mul_f32 v[188:189], v[188:189], v[10:11]
    v_pk_mul_f32 v[190:191], v[190:191], v[10:11]
    v_cvt_pk_bf16_f32 v30, v188, v189
    v_cvt_pk_bf16_f32 v31, v190, v191
    buffer_store_dwordx4 v[28:31], v8, s[16:19], s45 offen offset:3584 sc1
K2_DONE_30:
K2_SLOW:
    s_cmp_eq_u32 s66, 0
    s_cbranch_scc1 K2_TO_K3
    s_waitcnt vmcnt(0)
    s_bitcmp1_b32 s66, 0
    s_cbranch_scc0 K2_SLOW_L
    s_and_b32 s66, s66, 2
    v_accvgpr_mov_b32 a192, a32
    v_accvgpr_mov_b32 a193, a33
    v_accvgpr_mov_b32 a194, a34
    v_accvgpr_mov_b32 a195, a35
    v_accvgpr_mov_b32 a196, a36
    v_accvgpr_mov_b32 a197, a37
    v_accvgpr_mov_b32 a198, a38
    v_accvgpr_mov_b32 a199, a39
    v_accvgpr_mov_b32 a200, a40
    v_accvgpr_mov_b32 a201, a41
    v_accvgpr_mov_b32 a202, a42
    v_accvgpr_mov_b32 a203, a43
    v_accvgpr_mov_b32 a204, a44
    v_accvgpr_mov_b32 a205, a45
    v_accvgpr_mov_b32 a206, a46
    v_accvgpr_mov_b32 a207, a47
    v_accvgpr_mov_b32 a208, a48
    v_accvgpr_mov_b32 a209, a49
    v_accvgpr_mov_b32 a210, a50
    v_accvgpr_mov_b32 a211, a51
    v_accvgpr_mov_b32 a212, a52
    v_accvgpr_mov_b32 a213, a53
    v_accvgpr_mov_b32 a214, a54
    v_accvgpr_mov_b32 a215, a55
    v_accvgpr_mov_b32 a216, a56
    v_accvgpr_mov_b32 a217, a57
    v_accvgpr_mov_b32 a218, a58
    v_accvgpr_mov_b32 a219, a59
    v_accvgpr_mov_b32 a220, a60
    v_accvgpr_mov_b32 a221, a61
    v_accvgpr_mov_b32 a222, a62
    v_accvgpr_mov_b32 a223, a63
    s_sub_u32 s24, s22, 4
    s_mov_b32 s46, s41
    s_branch K2_SLOW_GO
K2_SLOW_L:
    s_mov_b32 s66, 0
    v_accvgpr_mov_b32 a192, a0
    v_accvgpr_mov_b32 a193, a1
    v_accvgpr_mov_b32 a194, a2
    v_accvgpr_mov_b32 a195, a3
    v_accvgpr_mov_b32 a196, a4
    v_accvgpr_mov_b32 a197, a5
    v_accvgpr_mov_b32 a198, a6
    v_accvgpr_mov_b32 a199, a7
    v_accvgpr_mov_b32 a200, a8
    v_accvgpr_mov_b32 a201, a9
    v_accvgpr_mov_b32 a202, a10
    v_accvgpr_mov_b32 a203, a11
    v_accvgpr_mov_b32 a204, a12
    v_accvgpr_mov_b32 a205, a13
    v_accvgpr_mov_b32 a206, a14
    v_accvgpr_mov_b32 a207, a15
    v_accvgpr_mov_b32 a208, a16
    v_accvgpr_mov_b32 a209, a17
    v_accvgpr_mov_b32 a210, a18
    v_accvgpr_mov_b32 a211, a19
    v_accvgpr_mov_b32 a212, a20
    v_accvgpr_mov_b32 a213, a21
    v_accvgpr_mov_b32 a214, a22
    v_accvgpr_mov_b32 a215, a23
    v_accvgpr_mov_b32 a216, a24
    v_accvgpr_mov_b32 a217, a25
    v_accvgpr_mov_b32 a218, a26
    v_accvgpr_mov_b32 a219, a27
    v_accvgpr_mov_b32 a220, a28
    v_accvgpr_mov_b32 a221, a29
    v_accvgpr_mov_b32 a222, a30
    v_accvgpr_mov_b32 a223, a31
    s_sub_u32 s24, s23, 4
    s_mov_b32 s46, s40
K2_SLOW_GO:
    s_add_u32 s24, s24, s20
    v_mov_b32 v128, 0
    v_mov_b32 v129, 0
    v_mov_b32 v130, 0
    v_mov_b32 v131, 0
    v_mov_b32 v132, 0
    v_mov_b32 v133, 0
    v_mov_b32 v134, 0
    v_mov_b32 v135, 0
    v_mov_b32 v136, 0
    v_mov_b32 v137, 0
    v_mov_b32 v138, 0
    v_mov_b32 v139, 0
    v_mov_b32 v140, 0
    v_mov_b32 v141, 0
    v_mov_b32 v142, 0
    v_mov_b32 v143, 0
    v_mov_b32 v144, 0
    v_mov_b32 v145, 0
    v_mov_b32 v146, 0
    v_mov_b32 v147, 0
    v_mov_b32 v148, 0
    v_mov_b32 v149, 0
    v_mov_b32 v150, 0
    v_mov_b32 v151, 0
    v_mov_b32 v152, 0
    v_mov_b32 v153, 0
    v_mov_b32 v154, 0
    v_mov_b32 v155, 0
    v_mov_b32 v156, 0
    v_mov_b32 v157, 0
    v_mov_b32 v158, 0
    v_mov_b32 v159, 0
    v_mov_b32 v160, 0
    v_mov_b32 v161, 0
    v_mov_b32 v162, 0
    v_mov_b32 v163, 0
    v_mov_b32 v164, 0
    v_mov_b32 v165, 0
    v_mov_b32 v166, 0
    v_mov_b32 v167, 0
    v_mov_b32 v168, 0
    v_mov_b32 v169, 0
    v_mov_b32 v170, 0
    v_mov_b32 v171, 0
    v_mov_b32 v172, 0
    v_mov_b32 v173, 0
    v_mov_b32 v174, 0
    v_mov_b32 v175, 0
    v_mov_b32 v176, 0
    v_mov_b32 v177, 0
    v_mov_b32 v178, 0
    v_mov_b32 v179, 0
    v_mov_b32 v180, 0
    v_mov_b32 v181, 0
    v_mov_b32 v182, 0
    v_mov_b32 v183, 0
    v_mov_b32 v184, 0
    v_mov_b32 v185, 0
    v_mov_b32 v186, 0
    v_mov_b32 v187, 0
    v_mov_b32 v188, 0
    v_mov_b32 v189, 0
    v_mov_b32 v190, 0
    v_mov_b32 v191, 0
    v_mov_b32 v114, 0
    v_mov_b32 v115, 0
    v_and_b32 v6, 31, v1
    v_lshrrev_b32 v7, 5, v1
    v_lshlrev_b32 v7, 2, v7
    v_sub_u32 v6, v6, v7
    v_mov_b32 v7, 0xf149f2ca
    v_cmp_le_i32 vcc, 0, v6
    s_nop 1
    v_cndmask_b32 v80, v7, v114, vcc
    v_cmp_le_i32 vcc, 1, v6
    s_nop 1
    v_cndmask_b32 v81, v7, v114, vcc
    v_cmp_le_i32 vcc, 2, v6
    s_nop 1
    v_cndmask_b32 v82, v7, v114, vcc
    v_cmp_le_i32 vcc, 3, v6
    s_nop 1
    v_cndmask_b32 v83, v7, v114, vcc
    v_cmp_le_i32 vcc, 16, v6
    s_nop 1
    v_cndmask_b32 v84, v7, v114, vcc
    v_cmp_le_i32 vcc, 17, v6
    s_nop 1
    v_cndmask_b32 v85, v7, v114, vcc
    v_cmp_le_i32 vcc, 18, v6
    s_nop 1
    v_cndmask_b32 v86, v7, v114, vcc
    v_cmp_le_i32 vcc, 19, v6
    s_nop 1
    v_cndmask_b32 v87, v7, v114, vcc
    v_cmp_le_i32 vcc, 8, v6
    s_nop 1
    v_cndmask_b32 v88, v7, v114, vcc
    v_cmp_le_i32 vcc, 9, v6
    s_nop 1
    v_cndmask_b32 v89, v7, v114, vcc
    v_cmp_le_i32 vcc, 10, v6
    s_nop 1
    v_cndmask_b32 v90, v7, v114, vcc
    v_cmp_le_i32 vcc, 11, v6
    s_nop 1
    v_cndmask_b32 v91, v7, v114, vcc
    v_cmp_le_i32 vcc, 24, v6
    s_nop 1
    v_cndmask_b32 v92, v7, v114, vcc
    v_cmp_le_i32 vcc, 25, v6
    s_nop 1
    v_cndmask_b32 v93, v7, v114, vcc
    v_cmp_le_i32 vcc, 26, v6
    s_nop 1
    v_cndmask_b32 v94, v7, v114, vcc
    v_cmp_le_i32 vcc, 27, v6
    s_nop 1
    v_cndmask_b32 v95, v7, v114, vcc
    v_mov_b32 v112, 0xff800000
    s_mov_b32 s25, 0
K2_SLOW_LOOP:
    s_lshl_b32 s26, s25, 13
    s_add_u32 s27, s26, 0x1000
    buffer_load_dwordx4 a[64:67], v4, s[4:7], s26 offen offset:0
    buffer_load_dwordx4 a[68:71], v4, s[4:7], s26 offen offset:1024
    buffer_load_dwordx4 a[72:75], v4, s[4:7], s26 offen offset:2048
    buffer_load_dwordx4 a[76:79], v4, s[4:7], s26 offen offset:3072
    buffer_load_dwordx4 a[80:83], v4, s[4:7], s27 offen offset:0
    buffer_load_dwordx4 a[84:87], v4, s[4:7], s27 offen offset:1024
    buffer_load_dwordx4 a[88:91], v4, s[4:7], s27 offen offset:2048
    buffer_load_dwordx4 a[92:95], v4, s[4:7], s27 offen offset:3072
    buffer_load_dwordx4 a[128:131], v4, s[8:11], s26 offen offset:0
    buffer_load_dwordx4 a[132:135], v4, s[8:11], s26 offen offset:1024
    buffer_load_dwordx4 a[136:139], v4, s[8:11], s26 offen offset:2048
    buffer_load_dwordx4 a[140:143], v4, s[8:11], s26 offen offset:3072
    buffer_load_dwordx4 a[144:147], v4, s[8:11], s27 offen offset:0
    buffer_load_dwordx4 a[148:151], v4, s[8:11], s27 offen offset:1024
    buffer_load_dwordx4 a[152:155], v4, s[8:11], s27 offen offset:2048
    buffer_load_dwordx4 a[156:159], v4, s[8:11], s27 offen offset:3072
    s_waitcnt vmcnt(0)
    s_cmp_eq_u32 s25, s24
    s_cbranch_scc1 K2_ST_31
    v_mfma_f32_32x32x16_bf16 v[32:47], a[64:67], a[192:195], 0
    s_branch K2_SJ_32
K2_ST_31:
    v_mfma_f32_32x32x16_bf16 v[32:47], a[64:67], a[192:195], v[80:95]
K2_SJ_32:
    v_mfma_f32_32x32x16_bf16 v[32:47], a[68:71], a[196:199], v[32:47]
    v_mfma_f32_32x32x16_bf16 v[32:47], a[72:75], a[200:203], v[32:47]
    v_mfma_f32_32x32x16_bf16 v[32:47], a[76:79], a[204:207], v[32:47]
    v_mfma_f32_32x32x16_bf16 v[32:47], a[80:83], a[208:211], v[32:47]
    v_mfma_f32_32x32x16_bf16 v[32:47], a[84:87], a[212:215], v[32:47]
    v_mfma_f32_32x32x16_bf16 v[32:47], a[88:91], a[216:219], v[32:47]
    v_mfma_f32_32x32x16_bf16 v[32:47], a[92:95], a[220:223], v[32:47]
    s_nop 15
    v_max3_f32 v116, v32, v33, v112
    v_max3_f32 v116, v34, v35, v116
    v_max3_f32 v116, v36, v37, v116
    v_max3_f32 v116, v38, v39, v116
    v_max3_f32 v116, v40, v41, v116
    v_max3_f32 v116, v42, v43, v116
    v_max3_f32 v116, v44, v45, v116
    v_max3_f32 v116, v46, v47, v116
    v_mov_b32 v10, v116
    s_nop 1
    v_permlane32_swap_b32 v116, v10
    s_nop 1
    v_max_f32 v116, v116, v10
    v_sub_f32 v10, v112, v116
    v_mov_b32 v112, v116
    v_exp_f32 v10, v10
    v_sub_f32 v32, v32, v112
    v_sub_f32 v33, v33, v112
    v_sub_f32 v34, v34, v112
    v_sub_f32 v35, v35, v112
    v_sub_f32 v36, v36, v112
    v_sub_f32 v37, v37, v112
    v_sub_f32 v38, v38, v112
    v_sub_f32 v39, v39, v112
    v_sub_f32 v40, v40, v112
    v_sub_f32 v41, v41, v112
    v_sub_f32 v42, v42, v112
    v_sub_f32 v43, v43, v112
    v_sub_f32 v44, v44, v112
    v_sub_f32 v45, v45, v112
    v_sub_f32 v46, v46, v112
    v_sub_f32 v47, v47, v112
    v_exp_f32 v32, v32
    v_exp_f32 v33, v33
    v_exp_f32 v34, v34
    v_exp_f32 v35, v35
    v_exp_f32 v36, v36
    v_exp_f32 v37, v37
    v_exp_f32 v38, v38
    v_exp_f32 v39, v39
    v_exp_f32 v40, v40
    v_exp_f32 v41, v41
    v_exp_f32 v42, v42
    v_exp_f32 v43, v43
    v_exp_f32 v44, v44
    v_exp_f32 v45, v45
    v_exp_f32 v46, v46
    v_exp_f32 v47, v47
    v_mul_f32 v114, v114, v10
    v_add_f32 v114, v114, v32
    v_add_f32 v114, v114, v33
    v_add_f32 v114, v114, v34
    v_add_f32 v114, v114, v35
    v_add_f32 v114, v114, v36
    v_add_f32 v114, v114, v37
    v_add_f32 v114, v114, v38
    v_add_f32 v114, v114, v39
    v_add_f32 v114, v114, v40
    v_add_f32 v114, v114, v41
    v_add_f32 v114, v114, v42
    v_add_f32 v114, v114, v43
    v_add_f32 v114, v114, v44
    v_add_f32 v114, v114, v45
    v_add_f32 v114, v114, v46
    v_add_f32 v114, v114, v47
    v_cvt_pk_bf16_f32 v64, v32, v33
    v_cvt_pk_bf16_f32 v65, v34, v35
    v_cvt_pk_bf16_f32 v66, v36, v37
    v_cvt_pk_bf16_f32 v67, v38, v39
    v_cvt_pk_bf16_f32 v68, v40, v41
    v_cvt_pk_bf16_f32 v69, v42, v43
    v_cvt_pk_bf16_f32 v70, v44, v45
    v_cvt_pk_bf16_f32 v71, v46, v47
    v_mul_f32 v128, v128, v10
    v_mul_f32 v129, v129, v10
    v_mul_f32 v130, v130, v10
    v_mul_f32 v131, v131, v10
    v_mul_f32 v132, v132, v10
    v_mul_f32 v133, v133, v10
    v_mul_f32 v134, v134, v10
    v_mul_f32 v135, v135, v10
    v_mul_f32 v136, v136, v10
    v_mul_f32 v137, v137, v10
    v_mul_f32 v138, v138, v10
    v_mul_f32 v139, v139, v10
    v_mul_f32 v140, v140, v10
    v_mul_f32 v141, v141, v10
    v_mul_f32 v142, v142, v10
    v_mul_f32 v143, v143, v10
    v_mul_f32 v144, v144, v10
    v_mul_f32 v145, v145, v10
    v_mul_f32 v146, v146, v10
    v_mul_f32 v147, v147, v10
    v_mul_f32 v148, v148, v10
    v_mul_f32 v149, v149, v10
    v_mul_f32 v150, v150, v10
    v_mul_f32 v151, v151, v10
    v_mul_f32 v152, v152, v10
    v_mul_f32 v153, v153, v10
    v_mul_f32 v154, v154, v10
    v_mul_f32 v155, v155, v10
    v_mul_f32 v156, v156, v10
    v_mul_f32 v157, v157, v10
    v_mul_f32 v158, v158, v10
    v_mul_f32 v159, v159, v10
    v_mul_f32 v160, v160, v10
    v_mul_f32 v161, v161, v10
    v_mul_f32 v162, v162, v10
    v_mul_f32 v163, v163, v10
    v_mul_f32 v164, v164, v10
    v_mul_f32 v165, v165, v10
    v_mul_f32 v166, v166, v10
    v_mul_f32 v167, v167, v10
    v_mul_f32 v168, v168, v10
    v_mul_f32 v169, v169, v10
    v_mul_f32 v170, v170, v10
    v_mul_f32 v171, v171, v10
    v_mul_f32 v172, v172, v10
    v_mul_f32 v173, v173, v10
    v_mul_f32 v174, v174, v10
    v_mul_f32 v175, v175, v10
    v_mul_f32 v176, v176, v10
    v_mul_f32 v177, v177, v10
    v_mul_f32 v178, v178, v10
    v_mul_f32 v179, v179, v10
    v_mul_f32 v180, v180, v10
    v_mul_f32 v181, v181, v10
    v_mul_f32 v182, v182, v10
    v_mul_f32 v183, v183, v10
    v_mul_f32 v184, v184, v10
    v_mul_f32 v185, v185, v10
    v_mul_f32 v186, v186, v10
    v_mul_f32 v187, v187, v10
    v_mul_f32 v188, v188, v10
    v_mul_f32 v189, v189, v10
    v_mul_f32 v190, v190, v10
    v_mul_f32 v191, v191, v10
    s_nop 1
    v_mfma_f32_32x32x16_bf16 v[128:143], a[128:131], v[64:67], v[128:143]
    v_mfma_f32_32x32x16_bf16 v[144:159], a[136:139], v[64:67], v[144:159]
    v_mfma_f32_32x32x16_bf16 v[160:175], a[144:147], v[64:67], v[160:175]
    v_mfma_f32_32x32x16_bf16 v[176:191], a[152:155], v[64:67], v[176:191]
    v_mfma_f32_32x32x16_bf16 v[128:143], a[132:135], v[68:71], v[128:143]
    v_mfma_f32_32x32x16_bf16 v[144:159], a[140:143], v[68:71], v[144:159]
    v_mfma_f32_32x32x16_bf16 v[160:175], a[148:151], v[68:71], v[160:175]
    v_mfma_f32_32x32x16_bf16 v[176:191], a[156:159], v[68:71], v[176:191]
    s_nop 15
    s_add_u32 s25, s25, 1
    s_cmp_le_u32 s25, s24
    s_cbranch_scc1 K2_SLOW_LOOP
    s_lshl_b32 s45, s46, 18
    s_add_u32 s45, s45, s44
    v_add_f32 v114, v114, v115
    v_mov_b32 v10, v114
    s_nop 1
    v_permlane32_swap_b32 v114, v10
    s_nop 1
    v_add_f32 v114, v114, v10
    v_rcp_f32 v10, v114
    s_nop 0
    v_mov_b32 v11, v10
    v_pk_mul_f32 v[128:129], v[128:129], v[10:11]
    v_pk_mul_f32 v[130:131], v[130:131], v[10:11]
    v_cvt_pk_bf16_f32 v16, v128, v129
    v_cvt_pk_bf16_f32 v17, v130, v131
    v_pk_mul_f32 v[136:137], v[136:137], v[10:11]
    v_pk_mul_f32 v[138:139], v[138:139], v[10:11]
    v_cvt_pk_bf16_f32 v18, v136, v137
    v_cvt_pk_bf16_f32 v19, v138, v139
    buffer_store_dwordx4 v[16:19], v8, s[16:19], s45 offen offset:0 sc1
    v_pk_mul_f32 v[132:133], v[132:133], v[10:11]
    v_pk_mul_f32 v[134:135], v[134:135], v[10:11]
    v_cvt_pk_bf16_f32 v20, v132, v133
    v_cvt_pk_bf16_f32 v21, v134, v135
    v_pk_mul_f32 v[140:141], v[140:141], v[10:11]
    v_pk_mul_f32 v[142:143], v[142:143], v[10:11]
    v_cvt_pk_bf16_f32 v22, v140, v141
    v_cvt_pk_bf16_f32 v23, v142, v143
    buffer_store_dwordx4 v[20:23], v8, s[16:19], s45 offen offset:512 sc1
    v_pk_mul_f32 v[144:145], v[144:145], v[10:11]
    v_pk_mul_f32 v[146:147], v[146:147], v[10:11]
    v_cvt_pk_bf16_f32 v24, v144, v145
    v_cvt_pk_bf16_f32 v25, v146, v147
    v_pk_mul_f32 v[152:153], v[152:153], v[10:11]
    v_pk_mul_f32 v[154:155], v[154:155], v[10:11]
    v_cvt_pk_bf16_f32 v26, v152, v153
    v_cvt_pk_bf16_f32 v27, v154, v155
    buffer_store_dwordx4 v[24:27], v8, s[16:19], s45 offen offset:1024 sc1
    v_pk_mul_f32 v[148:149], v[148:149], v[10:11]
    v_pk_mul_f32 v[150:151], v[150:151], v[10:11]
    v_cvt_pk_bf16_f32 v28, v148, v149
    v_cvt_pk_bf16_f32 v29, v150, v151
    v_pk_mul_f32 v[156:157], v[156:157], v[10:11]
    v_pk_mul_f32 v[158:159], v[158:159], v[10:11]
    v_cvt_pk_bf16_f32 v30, v156, v157
    v_cvt_pk_bf16_f32 v31, v158, v159
    buffer_store_dwordx4 v[28:31], v8, s[16:19], s45 offen offset:1536 sc1
    v_pk_mul_f32 v[160:161], v[160:161], v[10:11]
    v_pk_mul_f32 v[162:163], v[162:163], v[10:11]
    v_cvt_pk_bf16_f32 v16, v160, v161
    v_cvt_pk_bf16_f32 v17, v162, v163
    v_pk_mul_f32 v[168:169], v[168:169], v[10:11]
    v_pk_mul_f32 v[170:171], v[170:171], v[10:11]
    v_cvt_pk_bf16_f32 v18, v168, v169
    v_cvt_pk_bf16_f32 v19, v170, v171
    buffer_store_dwordx4 v[16:19], v8, s[16:19], s45 offen offset:2048 sc1
    v_pk_mul_f32 v[164:165], v[164:165], v[10:11]
    v_pk_mul_f32 v[166:167], v[166:167], v[10:11]
    v_cvt_pk_bf16_f32 v20, v164, v165
    v_cvt_pk_bf16_f32 v21, v166, v167
    v_pk_mul_f32 v[172:173], v[172:173], v[10:11]
    v_pk_mul_f32 v[174:175], v[174:175], v[10:11]
    v_cvt_pk_bf16_f32 v22, v172, v173
    v_cvt_pk_bf16_f32 v23, v174, v175
    buffer_store_dwordx4 v[20:23], v8, s[16:19], s45 offen offset:2560 sc1
    v_pk_mul_f32 v[176:177], v[176:177], v[10:11]
    v_pk_mul_f32 v[178:179], v[178:179], v[10:11]
    v_cvt_pk_bf16_f32 v24, v176, v177
    v_cvt_pk_bf16_f32 v25, v178, v179
    v_pk_mul_f32 v[184:185], v[184:185], v[10:11]
    v_pk_mul_f32 v[186:187], v[186:187], v[10:11]
    v_cvt_pk_bf16_f32 v26, v184, v185
    v_cvt_pk_bf16_f32 v27, v186, v187
    buffer_store_dwordx4 v[24:27], v8, s[16:19], s45 offen offset:3072 sc1
    v_pk_mul_f32 v[180:181], v[180:181], v[10:11]
    v_pk_mul_f32 v[182:183], v[182:183], v[10:11]
    v_cvt_pk_bf16_f32 v28, v180, v181
    v_cvt_pk_bf16_f32 v29, v182, v183
    v_pk_mul_f32 v[188:189], v[188:189], v[10:11]
    v_pk_mul_f32 v[190:191], v[190:191], v[10:11]
    v_cvt_pk_bf16_f32 v30, v188, v189
    v_cvt_pk_bf16_f32 v31, v190, v191
    buffer_store_dwordx4 v[28:31], v8, s[16:19], s45 offen offset:3584 sc1
    s_branch K2_SLOW
K2_TO_K3:
    s_lshr_b32 s92, s38, 3
    s_lshl_b32 s90, s21, 2
    s_add_u32 s90, s90, s92
    s_lshl_b32 s90, s90, 7
    s_sub_u32 s91, 15, s21
    s_lshl_b32 s91, s91, 2
    s_add_u32 s91, s91, s92
    s_lshl_b32 s91, s91, 7
    s_barrier
K3F:
    s_load_dwordx2 s[36:37], s[0:1], 96
    s_load_dwordx2 s[42:43], s[0:1], 0
    s_load_dwordx2 s[44:45], s[0:1], 80
    v_lshrrev_b32 v1, 6, v0
    s_nop 0
    v_readfirstlane_b32 s20, v1
    v_and_b32 v1, 63, v0
    s_and_b32 s46, s2, 7
    s_lshr_b32 s47, s2, 3
    s_and_b32 s23, s46, 3
    s_and_b32 s21, s47, 3
    s_lshr_b32 s47, s47, 2
    s_lshr_b32 s46, s46, 2
    s_lshl_b32 s46, s46, 3
    s_add_u32 s22, s46, s47
    s_lshr_b32 s30, s20, 1
    s_and_b32 s31, s20, 1
    v_lshlrev_b32 v2, 4, v1
    v_add_u32 v8, 131072, v2
    v_add_u32 v9, 44032, v2
    s_lshl_b32 s46, s30, 12
    v_add_u32 v10, s46, v2
    v_add_u32 v11, 0x10000, v10
    s_lshl_b32 s46, s31, 12
    s_add_u32 s46, s46, 8192
    v_add_u32 v12, s46, v2
    v_add_u32 v13, 0x10000, v12
    s_lshl_b32 s29, s20, 11
    s_waitcnt lgkmcnt(0)
    s_add_u32 s4, s36, 67108864
    s_addc_u32 s5, s37, 0
    s_and_b32 s5, s5, 0xffff
    s_mov_b32 s6, 0x1000000
    s_mov_b32 s7, 0x20000
    s_add_u32 s8, s36, 83886080
    s_addc_u32 s9, s37, 0
    s_and_b32 s9, s9, 0xffff
    s_mov_b32 s10, 5636096
    s_mov_b32 s11, 0x20000
    s_lshl_b32 s58, s21, 1
    s_add_u32 s58, s58, s30
    s_mul_i32 s58, s58, 704512
    s_add_u32 s58, s58, 100663296
    s_add_u32 s12, s36, s58
    s_addc_u32 s13, s37, 0
    s_and_b32 s13, s13, 0xffff
    s_mov_b32 s14, 700416
    s_mov_b32 s15, 0x20000
    s_mov_b32 s48, s42
    s_and_b32 s49, s43, 0xffff
    s_mov_b32 s50, 2097152
    s_mov_b32 s51, 0x20000
    s_mov_b32 s52, s44
    s_and_b32 s53, s45, 0xffff
    s_mov_b32 s54, 2097152
    s_mov_b32 s55, 0x20000
    s_add_u32 s64, s36, 118489088
    s_addc_u32 s65, s37, 0
    s_and_b32 s65, s65, 0xffff
    s_mov_b32 s66, 0x1000000
    s_mov_b32 s67, 0x20000
    s_lshl_b32 s58, s22, 3
    s_lshl_b32 s59, s20, 1
    s_add_u32 s58, s58, s59
    s_lshl_b32 s24, s58, 17
    s_lshl_b32 s59, s23, 15
    s_add_u32 s24, s24, s59
    s_mul_i32 s25, s58, 44032
    s_mul_i32 s59, s23, 11264
    s_add_u32 s25, s25, s59
    s_lshl_b32 s59, s31, 11
    s_lshl_b32 s26, s23, 17
    s_add_u32 s26, s26, s59
    s_mul_i32 s27, s23, 45056
    s_add_u32 s27, s27, 524288
    s_add_u32 s27, s27, s59
    v_and_b32 v3, 15, v1
    v_lshlrev_b32 v21, 10, v3
    v_lshrrev_b32 v3, 4, v1
    v_lshl_add_u32 v21, v3, 3, v21
    s_lshl_b32 s56, s22, 7
    s_lshl_b32 s57, s23, 5
    s_add_u32 s56, s56, s57
    s_lshl_b32 s57, s31, 4
    s_add_u32 s56, s56, s57
    s_lshl_b32 s56, s56, 10
    s_lshl_b32 s57, s21, 8
    s_add_u32 s56, s56, s57
    s_lshl_b32 s57, s30, 7
    s_add_u32 s56, s56, s57
    s_add_u32 m0, s29, 0
    s_nop 0
    buffer_load_dwordx4 v2, s[8:11], s25 offen lds
    s_add_u32 m0, m0, 1024
    s_nop 0
    buffer_load_dwordx4 v9, s[8:11], s25 offen lds
    s_add_u32 m0, s29, 8192
    s_add_u32 s25, s25, 1024
    buffer_load_dwordx4 v2, s[12:15], s27 offen lds
    buffer_load_dwordx4 v2, s[12:15], s27 offen offset:1024 lds
    s_add_u32 s27, s27, 4096
    s_add_u32 m0, s29, 16384
    s_nop 0
    buffer_load_dwordx4 v2, s[8:11], s25 offen lds
    s_add_u32 m0, m0, 1024
    s_nop 0
    buffer_load_dwordx4 v9, s[8:11], s25 offen lds
    s_add_u32 m0, s29, 24576
    s_add_u32 s25, s25, 1024
    buffer_load_dwordx4 v2, s[12:15], s27 offen lds
    buffer_load_dwordx4 v2, s[12:15], s27 offen offset:1024 lds
    s_add_u32 s27, s27, 4096
    s_add_u32 m0, s29, 32768
    s_nop 0
    buffer_load_dwordx4 v2, s[8:11], s25 offen lds
    s_add_u32 m0, m0, 1024
    s_nop 0
    buffer_load_dwordx4 v9, s[8:11], s25 offen lds
    s_add_u32 m0, s29, 40960
    s_add_u32 s25, s25, 1024
    buffer_load_dwordx4 v2, s[12:15], s27 offen lds
    buffer_load_dwordx4 v2, s[12:15], s27 offen offset:1024 lds
    s_add_u32 s27, s27, 4096
    s_add_u32 m0, s29, 49152
    s_nop 0
    buffer_load_dwordx4 v2, s[8:11], s25 offen lds
    s_add_u32 m0, m0, 1024
    s_nop 0
    buffer_load_dwordx4 v9, s[8:11], s25 offen lds
    s_add_u32 m0, s29, 57344
    s_add_u32 s25, s25, 1024
    buffer_load_dwordx4 v2, s[12:15], s27 offen lds
    buffer_load_dwordx4 v2, s[12:15], s27 offen offset:1024 lds
    s_add_u32 s27, s27, 4096
    s_add_u32 m0, s29, 65536
    s_nop 0
    buffer_load_dwordx4 v2, s[8:11], s25 offen lds
    s_add_u32 m0, m0, 1024
    s_nop 0
    buffer_load_dwordx4 v9, s[8:11], s25 offen lds
    s_add_u32 m0, s29, 73728
    s_add_u32 s25, s25, 1024
    buffer_load_dwordx4 v2, s[12:15], s27 offen lds
    buffer_load_dwordx4 v2, s[12:15], s27 offen offset:1024 lds
    s_add_u32 s27, s27, 4096
    s_add_u32 m0, s29, 81920
    s_nop 0
    buffer_load_dwordx4 v2, s[8:11], s25 offen lds
    s_add_u32 m0, m0, 1024
    s_nop 0
    buffer_load_dwordx4 v9, s[8:11], s25 offen lds
    s_add_u32 m0, s29, 90112
    s_add_u32 s25, s25, 1024
    buffer_load_dwordx4 v2, s[12:15], s27 offen lds
    buffer_load_dwordx4 v2, s[12:15], s27 offen offset:1024 lds
    s_add_u32 s27, s27, 4096
    s_add_u32 m0, s29, 98304
    s_nop 0
    buffer_load_dwordx4 v2, s[8:11], s25 offen lds
    s_add_u32 m0, m0, 1024
    s_nop 0
    buffer_load_dwordx4 v9, s[8:11], s25 offen lds
    s_add_u32 m0, s29, 106496
    s_add_u32 s25, s25, 1024
    buffer_load_dwordx4 v2, s[12:15], s27 offen lds
    buffer_load_dwordx4 v2, s[12:15], s27 offen offset:1024 lds
    s_add_u32 s27, s27, 4096
    s_waitcnt vmcnt(28)
    s_barrier
    s_add_u32 s68, s36, 117448704
    s_addc_u32 s69, s37, 0
    s_cmp_lg_u32 s20, 0
    s_cbranch_scc1 K3_SIGD
    v_mov_b32 v40, s90
    v_mov_b32 v43, s91
    v_mov_b32 v41, 1
    s_mov_b64 exec, 1
    global_atomic_add v40, v41, s[68:69] sc1
    global_atomic_add v43, v41, s[68:69] sc1
    s_mov_b64 exec, -1
K3_SIGD:
    s_waitcnt vmcnt(24)
    s_barrier
    ds_read_b128 v[64:67], v10 offset:0
    ds_read_b128 v[68:71], v10 offset:1024
    ds_read_b128 v[72:75], v10 offset:2048
    ds_read_b128 v[76:79], v10 offset:3072
    ds_read_b128 v[80:83], v12 offset:0
    ds_read_b128 v[84:87], v12 offset:1024
    ds_read_b128 v[88:91], v12 offset:2048
    ds_read_b128 v[92:95], v12 offset:3072
    s_waitcnt vmcnt(20)
    s_waitcnt lgkmcnt(0)
    s_barrier
    v_mfma_f32_16x16x32_bf16 v[160:163], v[80:83], v[64:67], 0
    ds_read_b128 v[96:99], v10 offset:16384
    v_mfma_f32_16x16x32_bf16 v[176:179], v[84:87], v[64:67], 0
    ds_read_b128 v[100:103], v10 offset:17408
    v_mfma_f32_16x16x32_bf16 v[192:195], v[88:91], v[64:67], 0
    ds_read_b128 v[104:107], v10 offset:18432
    v_mfma_f32_16x16x32_bf16 v[208:211], v[92:95], v[64:67], 0
    ds_read_b128 v[108:111], v10 offset:19456
    v_mfma_f32_16x16x32_bf16 v[164:167], v[80:83], v[68:71], 0
    ds_read_b128 v[112:115], v12 offset:16384
    v_mfma_f32_16x16x32_bf16 v[180:183], v[84:87], v[68:71], 0
    ds_read_b128 v[116:119], v12 offset:17408
    v_mfma_f32_16x16x32_bf16 v[196:199], v[88:91], v[68:71], 0
    ds_read_b128 v[120:123], v12 offset:18432
    v_mfma_f32_16x16x32_bf16 v[212:215], v[92:95], v[68:71], 0
    ds_read_b128 v[124:127], v12 offset:19456
    v_mfma_f32_16x16x32_bf16 v[168:171], v[80:83], v[72:75], 0
    s_add_u32 m0, s29, 114688
    s_nop 0
    buffer_load_dwordx4 v2, s[8:11], s25 offen lds
    v_mfma_f32_16x16x32_bf16 v[184:187], v[84:87], v[72:75], 0
    v_mfma_f32_16x16x32_bf16 v[200:203], v[88:91], v[72:75], 0
    s_add_u32 m0, m0, 1024
    s_nop 0
    buffer_load_dwordx4 v9, s[8:11], s25 offen lds
    v_mfma_f32_16x16x32_bf16 v[216:219], v[92:95], v[72:75], 0
    v_mfma_f32_16x16x32_bf16 v[172:175], v[80:83], v[76:79], 0
    s_add_u32 m0, s29, 122880
    s_add_u32 s25, s25, 1024
    buffer_load_dwordx4 v2, s[12:15], s27 offen lds
    v_mfma_f32_16x16x32_bf16 v[188:191], v[84:87], v[76:79], 0
    v_mfma_f32_16x16x32_bf16 v[204:207], v[88:91], v[76:79], 0
    buffer_load_dwordx4 v2, s[12:15], s27 offen offset:1024 lds
    s_add_u32 s27, s27, 4096
    v_mfma_f32_16x16x32_bf16 v[220:223], v[92:95], v[76:79], 0
    s_waitcnt vmcnt(20)
    s_waitcnt lgkmcnt(0)
    s_barrier
    v_mfma_f32_16x16x32_bf16 v[160:163], v[112:115], v[96:99], v[160:163]
    ds_read_b128 v[64:67], v10 offset:32768
    v_mfma_f32_16x16x32_bf16 v[176:179], v[116:119], v[96:99], v[176:179]
    ds_read_b128 v[68:71], v10 offset:33792
    v_mfma_f32_16x16x32_bf16 v[192:195], v[120:123], v[96:99], v[192:195]
    ds_read_b128 v[72:75], v10 offset:34816
    v_mfma_f32_16x16x32_bf16 v[208:211], v[124:127], v[96:99], v[208:211]
    ds_read_b128 v[76:79], v10 offset:35840
    v_mfma_f32_16x16x32_bf16 v[164:167], v[112:115], v[100:103], v[164:167]
    ds_read_b128 v[80:83], v12 offset:32768
    v_mfma_f32_16x16x32_bf16 v[180:183], v[116:119], v[100:103], v[180:183]
    ds_read_b128 v[84:87], v12 offset:33792
    v_mfma_f32_16x16x32_bf16 v[196:199], v[120:123], v[100:103], v[196:199]
    ds_read_b128 v[88:91], v12 offset:34816
    v_mfma_f32_16x16x32_bf16 v[212:215], v[124:127], v[100:103], v[212:215]
    ds_read_b128 v[92:95], v12 offset:35840
    v_mfma_f32_16x16x32_bf16 v[168:171], v[112:115], v[104:107], v[168:171]
    s_add_u32 m0, s29, 0
    s_nop 0
    buffer_load_dwordx4 v2, s[8:11], s25 offen lds
    v_mfma_f32_16x16x32_bf16 v[184:187], v[116:119], v[104:107], v[184:187]
    v_mfma_f32_16x16x32_bf16 v[200:203], v[120:123], v[104:107], v[200:203]
    s_add_u32 m0, m0, 1024
    s_nop 0
    buffer_load_dwordx4 v9, s[8:11], s25 offen lds
    v_mfma_f32_16x16x32_bf16 v[216:219], v[124:127], v[104:107], v[216:219]
    v_mfma_f32_16x16x32_bf16 v[172:175], v[112:115], v[108:111], v[172:175]
    s_add_u32 m0, s29, 8192
    s_add_u32 s25, s25, 1024
    buffer_load_dwordx4 v2, s[12:15], s27 offen lds
    v_mfma_f32_16x16x32_bf16 v[188:191], v[116:119], v[108:111], v[188:191]
    v_mfma_f32_16x16x32_bf16 v[204:207], v[120:123], v[108:111], v[204:207]
    buffer_load_dwordx4 v2, s[12:15], s27 offen offset:1024 lds
    s_add_u32 s27, s27, 4096
    v_mfma_f32_16x16x32_bf16 v[220:223], v[124:127], v[108:111], v[220:223]
    s_waitcnt vmcnt(20)
    s_waitcnt lgkmcnt(0)
    s_barrier
    v_mfma_f32_16x16x32_bf16 v[160:163], v[80:83], v[64:67], v[160:163]
    ds_read_b128 v[96:99], v10 offset:49152
    v_mfma_f32_16x16x32_bf16 v[176:179], v[84:87], v[64:67], v[176:179]
    ds_read_b128 v[100:103], v10 offset:50176
    v_mfma_f32_16x16x32_bf16 v[192:195], v[88:91], v[64:67], v[192:195]
    ds_read_b128 v[104:107], v10 offset:51200
    v_mfma_f32_16x16x32_bf16 v[208:211], v[92:95], v[64:67], v[208:211]
    ds_read_b128 v[108:111], v10 offset:52224
    v_mfma_f32_16x16x32_bf16 v[164:167], v[80:83], v[68:71], v[164:167]
    ds_read_b128 v[112:115], v12 offset:49152
    v_mfma_f32_16x16x32_bf16 v[180:183], v[84:87], v[68:71], v[180:183]
    ds_read_b128 v[116:119], v12 offset:50176
    v_mfma_f32_16x16x32_bf16 v[196:199], v[88:91], v[68:71], v[196:199]
    ds_read_b128 v[120:123], v12 offset:51200
    v_mfma_f32_16x16x32_bf16 v[212:215], v[92:95], v[68:71], v[212:215]
    ds_read_b128 v[124:127], v12 offset:52224
    v_mfma_f32_16x16x32_bf16 v[168:171], v[80:83], v[72:75], v[168:171]
    s_add_u32 m0, s29, 16384
    s_nop 0
    buffer_load_dwordx4 v2, s[8:11], s25 offen lds
    v_mfma_f32_16x16x32_bf16 v[184:187], v[84:87], v[72:75], v[184:187]
    v_mfma_f32_16x16x32_bf16 v[200:203], v[88:91], v[72:75], v[200:203]
    s_add_u32 m0, m0, 1024
    s_nop 0
    buffer_load_dwordx4 v9, s[8:11], s25 offen lds
    v_mfma_f32_16x16x32_bf16 v[216:219], v[92:95], v[72:75], v[216:219]
    v_mfma_f32_16x16x32_bf16 v[172:175], v[80:83], v[76:79], v[172:175]
    s_add_u32 m0, s29, 24576
    s_add_u32 s25, s25, 1024
    buffer_load_dwordx4 v2, s[12:15], s27 offen lds
    v_mfma_f32_16x16x32_bf16 v[188:191], v[84:87], v[76:79], v[188:191]
    v_mfma_f32_16x16x32_bf16 v[204:207], v[88:91], v[76:79], v[204:207]
    buffer_load_dwordx4 v2, s[12:15], s27 offen offset:1024 lds
    s_add_u32 s27, s27, 4096
    v_mfma_f32_16x16x32_bf16 v[220:223], v[92:95], v[76:79], v[220:223]
    s_waitcnt vmcnt(20)
    s_waitcnt lgkmcnt(0)
    s_barrier
    v_mfma_f32_16x16x32_bf16 v[160:163], v[112:115], v[96:99], v[160:163]
    ds_read_b128 v[64:67], v11 offset:0
    v_mfma_f32_16x16x32_bf16 v[176:179], v[116:119], v[96:99], v[176:179]
    ds_read_b128 v[68:71], v11 offset:1024
    v_mfma_f32_16x16x32_bf16 v[192:195], v[120:123], v[96:99], v[192:195]
    ds_read_b128 v[72:75], v11 offset:2048
    v_mfma_f32_16x16x32_bf16 v[208:211], v[124:127], v[96:99], v[208:211]
    ds_read_b128 v[76:79], v11 offset:3072
    v_mfma_f32_16x16x32_bf16 v[164:167], v[112:115], v[100:103], v[164:167]
    ds_read_b128 v[80:83], v13 offset:0
    v_mfma_f32_16x16x32_bf16 v[180:183], v[116:119], v[100:103], v[180:183]
    ds_read_b128 v[84:87], v13 offset:1024
    v_mfma_f32_16x16x32_bf16 v[196:199], v[120:123], v[100:103], v[196:199]
    ds_read_b128 v[88:91], v13 offset:2048
    v_mfma_f32_16x16x32_bf16 v[212:215], v[124:127], v[100:103], v[212:215]
    ds_read_b128 v[92:95], v13 offset:3072
    v_mfma_f32_16x16x32_bf16 v[168:171], v[112:115], v[104:107], v[168:171]
    s_add_u32 m0, s29, 32768
    s_nop 0
    buffer_load_dwordx4 v2, s[8:11], s25 offen lds
    v_mfma_f32_16x16x32_bf16 v[184:187], v[116:119], v[104:107], v[184:187]
    v_mfma_f32_16x16x32_bf16 v[200:203], v[120:123], v[104:107], v[200:203]
    s_add_u32 m0, m0, 1024
    s_nop 0
    buffer_load_dwordx4 v9, s[8:11], s25 offen lds
    v_mfma_f32_16x16x32_bf16 v[216:219], v[124:127], v[104:107], v[216:219]
    v_mfma_f32_16x16x32_bf16 v[172:175], v[112:115], v[108:111], v[172:175]
    s_add_u32 m0, s29, 40960
    s_add_u32 s25, s25, 1024
    buffer_load_dwordx4 v2, s[12:15], s27 offen lds
    v_mfma_f32_16x16x32_bf16 v[188:191], v[116:119], v[108:111], v[188:191]
    v_mfma_f32_16x16x32_bf16 v[204:207], v[120:123], v[108:111], v[204:207]
    buffer_load_dwordx4 v2, s[12:15], s27 offen offset:1024 lds
    s_add_u32 s27, s27, 4096
    v_mfma_f32_16x16x32_bf16 v[220:223], v[124:127], v[108:111], v[220:223]
    s_waitcnt vmcnt(20)
    s_waitcnt lgkmcnt(0)
    s_cmp_lg_u32 s20, 0
    s_cbranch_scc1 K3_DW
    s_lshl_b32 s61, s22, 2
    s_add_u32 s61, s61, s23
    s_lshl_b32 s61, s61, 7
    v_mov_b32 v40, s61
    s_mov_b32 s70, 0x80000
    s_mov_b64 exec, 1
K3_DL:
    global_load_dword v42, v40, s[68:69] sc1
    s_sub_u32 s70, s70, 1
    s_cbranch_scc1 K3_DX
    s_waitcnt vmcnt(0)
    v_cmp_gt_u32 vcc, 8, v42
    s_nop 4
    s_cbranch_vccnz K3_DL
K3_DX:
    s_waitcnt vmcnt(0)
    s_mov_b64 exec, -1
K3_DW:
    s_barrier
    v_mfma_f32_16x16x32_bf16 v[160:163], v[80:83], v[64:67], v[160:163]
    ds_read_b128 v[96:99], v11 offset:16384
    v_mfma_f32_16x16x32_bf16 v[176:179], v[84:87], v[64:67], v[176:179]
    ds_read_b128 v[100:103], v11 offset:17408
    v_mfma_f32_16x16x32_bf16 v[192:195], v[88:91], v[64:67], v[192:195]
    ds_read_b128 v[104:107], v11 offset:18432
    v_mfma_f32_16x16x32_bf16 v[208:211], v[92:95], v[64:67], v[208:211]
    ds_read_b128 v[108:111], v11 offset:19456
    v_mfma_f32_16x16x32_bf16 v[164:167], v[80:83], v[68:71], v[164:167]
    ds_read_b128 v[112:115], v13 offset:16384
    v_mfma_f32_16x16x32_bf16 v[180:183], v[84:87], v[68:71], v[180:183]
    ds_read_b128 v[116:119], v13 offset:17408
    v_mfma_f32_16x16x32_bf16 v[196:199], v[88:91], v[68:71], v[196:199]
    ds_read_b128 v[120:123], v13 offset:18432
    v_mfma_f32_16x16x32_bf16 v[212:215], v[92:95], v[68:71], v[212:215]
    ds_read_b128 v[124:127], v13 offset:19456
    v_mfma_f32_16x16x32_bf16 v[168:171], v[80:83], v[72:75], v[168:171]
    s_add_u32 m0, s29, 49152
    s_nop 0
    buffer_load_dwordx4 v2, s[4:7], s24 offen sc1 lds
    v_mfma_f32_16x16x32_bf16 v[184:187], v[84:87], v[72:75], v[184:187]
    v_mfma_f32_16x16x32_bf16 v[200:203], v[88:91], v[72:75], v[200:203]
    s_add_u32 m0, m0, 1024
    s_nop 0
    buffer_load_dwordx4 v8, s[4:7], s24 offen sc1 lds
    v_mfma_f32_16x16x32_bf16 v[216:219], v[92:95], v[72:75], v[216:219]
    v_mfma_f32_16x16x32_bf16 v[172:175], v[80:83], v[76:79], v[172:175]
    s_add_u32 m0, s29, 57344
    s_add_u32 s24, s24, 1024
    buffer_load_dwordx4 v2, s[12:15], s26 offen lds
    v_mfma_f32_16x16x32_bf16 v[188:191], v[84:87], v[76:79], v[188:191]
    v_mfma_f32_16x16x32_bf16 v[204:207], v[88:91], v[76:79], v[204:207]
    buffer_load_dwordx4 v2, s[12:15], s26 offen offset:1024 lds
    s_add_u32 s26, s26, 4096
    v_mfma_f32_16x16x32_bf16 v[220:223], v[92:95], v[76:79], v[220:223]
    s_waitcnt vmcnt(20)
    s_waitcnt lgkmcnt(0)
    s_barrier
    v_mfma_f32_16x16x32_bf16 v[160:163], v[112:115], v[96:99], v[160:163]
    ds_read_b128 v[64:67], v11 offset:32768
    v_mfma_f32_16x16x32_bf16 v[176:179], v[116:119], v[96:99], v[176:179]
    ds_read_b128 v[68:71], v11 offset:33792
    v_mfma_f32_16x16x32_bf16 v[192:195], v[120:123], v[96:99], v[192:195]
    ds_read_b128 v[72:75], v11 offset:34816
    v_mfma_f32_16x16x32_bf16 v[208:211], v[124:127], v[96:99], v[208:211]
    ds_read_b128 v[76:79], v11 offset:35840
    v_mfma_f32_16x16x32_bf16 v[164:167], v[112:115], v[100:103], v[164:167]
    ds_read_b128 v[80:83], v13 offset:32768
    v_mfma_f32_16x16x32_bf16 v[180:183], v[116:119], v[100:103], v[180:183]
    ds_read_b128 v[84:87], v13 offset:33792
    v_mfma_f32_16x16x32_bf16 v[196:199], v[120:123], v[100:103], v[196:199]
    ds_read_b128 v[88:91], v13 offset:34816
    v_mfma_f32_16x16x32_bf16 v[212:215], v[124:127], v[100:103], v[212:215]
    ds_read_b128 v[92:95], v13 offset:35840
    v_mfma_f32_16x16x32_bf16 v[168:171], v[112:115], v[104:107], v[168:171]
    s_add_u32 m0, s29, 65536
    s_nop 0
    buffer_load_dwordx4 v2, s[4:7], s24 offen sc1 lds
    v_mfma_f32_16x16x32_bf16 v[184:187], v[116:119], v[104:107], v[184:187]
    v_mfma_f32_16x16x32_bf16 v[200:203], v[120:123], v[104:107], v[200:203]
    s_add_u32 m0, m0, 1024
    s_nop 0
    buffer_load_dwordx4 v8, s[4:7], s24 offen sc1 lds
    v_mfma_f32_16x16x32_bf16 v[216:219], v[124:127], v[104:107], v[216:219]
    v_mfma_f32_16x16x32_bf16 v[172:175], v[112:115], v[108:111], v[172:175]
    s_add_u32 m0, s29, 73728
    s_add_u32 s24, s24, 1024
    buffer_load_dwordx4 v2, s[12:15], s26 offen lds
    v_mfma_f32_16x16x32_bf16 v[188:191], v[116:119], v[108:111], v[188:191]
    v_mfma_f32_16x16x32_bf16 v[204:207], v[120:123], v[108:111], v[204:207]
    buffer_load_dwordx4 v2, s[12:15], s26 offen offset:1024 lds
    s_add_u32 s26, s26, 4096
    v_mfma_f32_16x16x32_bf16 v[220:223], v[124:127], v[108:111], v[220:223]
    s_waitcnt vmcnt(20)
    s_waitcnt lgkmcnt(0)
    s_barrier
    v_mfma_f32_16x16x32_bf16 v[160:163], v[80:83], v[64:67], v[160:163]
    ds_read_b128 v[96:99], v11 offset:49152
    v_mfma_f32_16x16x32_bf16 v[176:179], v[84:87], v[64:67], v[176:179]
    ds_read_b128 v[100:103], v11 offset:50176
    v_mfma_f32_16x16x32_bf16 v[192:195], v[88:91], v[64:67], v[192:195]
    ds_read_b128 v[104:107], v11 offset:51200
    v_mfma_f32_16x16x32_bf16 v[208:211], v[92:95], v[64:67], v[208:211]
    ds_read_b128 v[108:111], v11 offset:52224
    v_mfma_f32_16x16x32_bf16 v[164:167], v[80:83], v[68:71], v[164:167]
    ds_read_b128 v[112:115], v13 offset:49152
    v_mfma_f32_16x16x32_bf16 v[180:183], v[84:87], v[68:71], v[180:183]
    ds_read_b128 v[116:119], v13 offset:50176
    v_mfma_f32_16x16x32_bf16 v[196:199], v[88:91], v[68:71], v[196:199]
    ds_read_b128 v[120:123], v13 offset:51200
    v_mfma_f32_16x16x32_bf16 v[212:215], v[92:95], v[68:71], v[212:215]
    ds_read_b128 v[124:127], v13 offset:52224
    v_mfma_f32_16x16x32_bf16 v[168:171], v[80:83], v[72:75], v[168:171]
    s_add_u32 m0, s29, 81920
    s_nop 0
    buffer_load_dwordx4 v2, s[4:7], s24 offen sc1 lds
    v_mfma_f32_16x16x32_bf16 v[184:187], v[84:87], v[72:75], v[184:187]
    v_mfma_f32_16x16x32_bf16 v[200:203], v[88:91], v[72:75], v[200:203]
    s_add_u32 m0, m0, 1024
    s_nop 0
    buffer_load_dwordx4 v8, s[4:7], s24 offen sc1 lds
    v_mfma_f32_16x16x32_bf16 v[216:219], v[92:95], v[72:75], v[216:219]
    v_mfma_f32_16x16x32_bf16 v[172:175], v[80:83], v[76:79], v[172:175]
    s_add_u32 m0, s29, 90112
    s_add_u32 s24, s24, 1024
    buffer_load_dwordx4 v2, s[12:15], s26 offen lds
    v_mfma_f32_16x16x32_bf16 v[188:191], v[84:87], v[76:79], v[188:191]
    v_mfma_f32_16x16x32_bf16 v[204:207], v[88:91], v[76:79], v[204:207]
    buffer_load_dwordx4 v2, s[12:15], s26 offen offset:1024 lds
    s_add_u32 s26, s26, 4096
    v_mfma_f32_16x16x32_bf16 v[220:223], v[92:95], v[76:79], v[220:223]
    s_waitcnt vmcnt(20)
    s_waitcnt lgkmcnt(0)
    s_barrier
    v_mfma_f32_16x16x32_bf16 v[160:163], v[112:115], v[96:99], v[160:163]
    ds_read_b128 v[64:67], v10 offset:0
    v_mfma_f32_16x16x32_bf16 v[176:179], v[116:119], v[96:99], v[176:179]
    ds_read_b128 v[68:71], v10 offset:1024
    v_mfma_f32_16x16x32_bf16 v[192:195], v[120:123], v[96:99], v[192:195]
    ds_read_b128 v[72:75], v10 offset:2048
    v_mfma_f32_16x16x32_bf16 v[208:211], v[124:127], v[96:99], v[208:211]
    ds_read_b128 v[76:79], v10 offset:3072
    v_mfma_f32_16x16x32_bf16 v[164:167], v[112:115], v[100:103], v[164:167]
    ds_read_b128 v[80:83], v12 offset:0
    v_mfma_f32_16x16x32_bf16 v[180:183], v[116:119], v[100:103], v[180:183]
    ds_read_b128 v[84:87], v12 offset:1024
    v_mfma_f32_16x16x32_bf16 v[196:199], v[120:123], v[100:103], v[196:199]
    ds_read_b128 v[88:91], v12 offset:2048
    v_mfma_f32_16x16x32_bf16 v[212:215], v[124:127], v[100:103], v[212:215]
    ds_read_b128 v[92:95], v12 offset:3072
    v_mfma_f32_16x16x32_bf16 v[168:171], v[112:115], v[104:107], v[168:171]
    s_add_u32 m0, s29, 98304
    s_nop 0
    buffer_load_dwordx4 v2, s[4:7], s24 offen sc1 lds
    v_mfma_f32_16x16x32_bf16 v[184:187], v[116:119], v[104:107], v[184:187]
    v_mfma_f32_16x16x32_bf16 v[200:203], v[120:123], v[104:107], v[200:203]
    s_add_u32 m0, m0, 1024
    s_nop 0
    buffer_load_dwordx4 v8, s[4:7], s24 offen sc1 lds
    v_mfma_f32_16x16x32_bf16 v[216:219], v[124:127], v[104:107], v[216:219]
    v_mfma_f32_16x16x32_bf16 v[172:175], v[112:115], v[108:111], v[172:175]
    s_add_u32 m0, s29, 106496
    s_add_u32 s24, s24, 1024
    buffer_load_dwordx4 v2, s[12:15], s26 offen lds
    v_mfma_f32_16x16x32_bf16 v[188:191], v[116:119], v[108:111], v[188:191]
    v_mfma_f32_16x16x32_bf16 v[204:207], v[120:123], v[108:111], v[204:207]
    buffer_load_dwordx4 v2, s[12:15], s26 offen offset:1024 lds
    s_add_u32 s26, s26, 4096
    v_mfma_f32_16x16x32_bf16 v[220:223], v[124:127], v[108:111], v[220:223]
    s_waitcnt vmcnt(20)
    s_waitcnt lgkmcnt(0)
    s_barrier
    v_mfma_f32_16x16x32_bf16 v[160:163], v[80:83], v[64:67], v[160:163]
    ds_read_b128 v[96:99], v10 offset:16384
    v_mfma_f32_16x16x32_bf16 v[176:179], v[84:87], v[64:67], v[176:179]
    ds_read_b128 v[100:103], v10 offset:17408
    v_mfma_f32_16x16x32_bf16 v[192:195], v[88:91], v[64:67], v[192:195]
    ds_read_b128 v[104:107], v10 offset:18432
    v_mfma_f32_16x16x32_bf16 v[208:211], v[92:95], v[64:67], v[208:211]
    ds_read_b128 v[108:111], v10 offset:19456
    v_mfma_f32_16x16x32_bf16 v[164:167], v[80:83], v[68:71], v[164:167]
    ds_read_b128 v[112:115], v12 offset:16384
    v_mfma_f32_16x16x32_bf16 v[180:183], v[84:87], v[68:71], v[180:183]
    ds_read_b128 v[116:119], v12 offset:17408
    v_mfma_f32_16x16x32_bf16 v[196:199], v[88:91], v[68:71], v[196:199]
    ds_read_b128 v[120:123], v12 offset:18432
    v_mfma_f32_16x16x32_bf16 v[212:215], v[92:95], v[68:71], v[212:215]
    ds_read_b128 v[124:127], v12 offset:19456
    v_mfma_f32_16x16x32_bf16 v[168:171], v[80:83], v[72:75], v[168:171]
    s_add_u32 m0, s29, 114688
    s_nop 0
    buffer_load_dwordx4 v2, s[4:7], s24 offen sc1 lds
    v_mfma_f32_16x16x32_bf16 v[184:187], v[84:87], v[72:75], v[184:187]
    v_mfma_f32_16x16x32_bf16 v[200:203], v[88:91], v[72:75], v[200:203]
    s_add_u32 m0, m0, 1024
    s_nop 0
    buffer_load_dwordx4 v8, s[4:7], s24 offen sc1 lds
    v_mfma_f32_16x16x32_bf16 v[216:219], v[92:95], v[72:75], v[216:219]
    v_mfma_f32_16x16x32_bf16 v[172:175], v[80:83], v[76:79], v[172:175]
    s_add_u32 m0, s29, 122880
    s_add_u32 s24, s24, 1024
    buffer_load_dwordx4 v2, s[12:15], s26 offen lds
    v_mfma_f32_16x16x32_bf16 v[188:191], v[84:87], v[76:79], v[188:191]
    v_mfma_f32_16x16x32_bf16 v[204:207], v[88:91], v[76:79], v[204:207]
    buffer_load_dwordx4 v2, s[12:15], s26 offen offset:1024 lds
    s_add_u32 s26, s26, 4096
    v_mfma_f32_16x16x32_bf16 v[220:223], v[92:95], v[76:79], v[220:223]
    s_waitcnt vmcnt(20)
    s_waitcnt lgkmcnt(0)
    s_barrier
    v_mfma_f32_16x16x32_bf16 v[160:163], v[112:115], v[96:99], v[160:163]
    ds_read_b128 v[64:67], v10 offset:32768
    v_mfma_f32_16x16x32_bf16 v[176:179], v[116:119], v[96:99], v[176:179]
    ds_read_b128 v[68:71], v10 offset:33792
    v_mfma_f32_16x16x32_bf16 v[192:195], v[120:123], v[96:99], v[192:195]
    ds_read_b128 v[72:75], v10 offset:34816
    v_mfma_f32_16x16x32_bf16 v[208:211], v[124:127], v[96:99], v[208:211]
    ds_read_b128 v[76:79], v10 offset:35840
    v_mfma_f32_16x16x32_bf16 v[164:167], v[112:115], v[100:103], v[164:167]
    ds_read_b128 v[80:83], v12 offset:32768
    v_mfma_f32_16x16x32_bf16 v[180:183], v[116:119], v[100:103], v[180:183]
    ds_read_b128 v[84:87], v12 offset:33792
    v_mfma_f32_16x16x32_bf16 v[196:199], v[120:123], v[100:103], v[196:199]
    ds_read_b128 v[88:91], v12 offset:34816
    v_mfma_f32_16x16x32_bf16 v[212:215], v[124:127], v[100:103], v[212:215]
    ds_read_b128 v[92:95], v12 offset:35840
    v_mfma_f32_16x16x32_bf16 v[168:171], v[112:115], v[104:107], v[168:171]
    s_add_u32 m0, s29, 0
    s_nop 0
    buffer_load_dwordx4 v2, s[4:7], s24 offen sc1 lds
    v_mfma_f32_16x16x32_bf16 v[184:187], v[116:119], v[104:107], v[184:187]
    v_mfma_f32_16x16x32_bf16 v[200:203], v[120:123], v[104:107], v[200:203]
    s_add_u32 m0, m0, 1024
    s_nop 0
    buffer_load_dwordx4 v8, s[4:7], s24 offen sc1 lds
    v_mfma_f32_16x16x32_bf16 v[216:219], v[124:127], v[104:107], v[216:219]
    v_mfma_f32_16x16x32_bf16 v[172:175], v[112:115], v[108:111], v[172:175]
    s_add_u32 m0, s29, 8192
    s_add_u32 s24, s24, 1024
    buffer_load_dwordx4 v2, s[12:15], s26 offen lds
    v_mfma_f32_16x16x32_bf16 v[188:191], v[116:119], v[108:111], v[188:191]
    v_mfma_f32_16x16x32_bf16 v[204:207], v[120:123], v[108:111], v[204:207]
    buffer_load_dwordx4 v2, s[12:15], s26 offen offset:1024 lds
    s_add_u32 s26, s26, 4096
    v_mfma_f32_16x16x32_bf16 v[220:223], v[124:127], v[108:111], v[220:223]
    s_waitcnt vmcnt(20)
    s_waitcnt lgkmcnt(0)
    s_barrier
    v_mfma_f32_16x16x32_bf16 v[160:163], v[80:83], v[64:67], v[160:163]
    ds_read_b128 v[96:99], v10 offset:49152
    v_mfma_f32_16x16x32_bf16 v[176:179], v[84:87], v[64:67], v[176:179]
    ds_read_b128 v[100:103], v10 offset:50176
    v_mfma_f32_16x16x32_bf16 v[192:195], v[88:91], v[64:67], v[192:195]
    ds_read_b128 v[104:107], v10 offset:51200
    v_mfma_f32_16x16x32_bf16 v[208:211], v[92:95], v[64:67], v[208:211]
    ds_read_b128 v[108:111], v10 offset:52224
    v_mfma_f32_16x16x32_bf16 v[164:167], v[80:83], v[68:71], v[164:167]
    ds_read_b128 v[112:115], v12 offset:49152
    v_mfma_f32_16x16x32_bf16 v[180:183], v[84:87], v[68:71], v[180:183]
    ds_read_b128 v[116:119], v12 offset:50176
    v_mfma_f32_16x16x32_bf16 v[196:199], v[88:91], v[68:71], v[196:199]
    ds_read_b128 v[120:123], v12 offset:51200
    v_mfma_f32_16x16x32_bf16 v[212:215], v[92:95], v[68:71], v[212:215]
    ds_read_b128 v[124:127], v12 offset:52224
    v_mfma_f32_16x16x32_bf16 v[168:171], v[80:83], v[72:75], v[168:171]
    s_add_u32 m0, s29, 16384
    s_nop 0
    buffer_load_dwordx4 v2, s[4:7], s24 offen sc1 lds
    v_mfma_f32_16x16x32_bf16 v[184:187], v[84:87], v[72:75], v[184:187]
    v_mfma_f32_16x16x32_bf16 v[200:203], v[88:91], v[72:75], v[200:203]
    s_add_u32 m0, m0, 1024
    s_nop 0
    buffer_load_dwordx4 v8, s[4:7], s24 offen sc1 lds
    v_mfma_f32_16x16x32_bf16 v[216:219], v[92:95], v[72:75], v[216:219]
    v_mfma_f32_16x16x32_bf16 v[172:175], v[80:83], v[76:79], v[172:175]
    s_add_u32 m0, s29, 24576
    s_add_u32 s24, s24, 1024
    buffer_load_dwordx4 v2, s[12:15], s26 offen lds
    v_mfma_f32_16x16x32_bf16 v[188:191], v[84:87], v[76:79], v[188:191]
    v_mfma_f32_16x16x32_bf16 v[204:207], v[88:91], v[76:79], v[204:207]
    buffer_load_dwordx4 v2, s[12:15], s26 offen offset:1024 lds
    s_add_u32 s26, s26, 4096
    v_mfma_f32_16x16x32_bf16 v[220:223], v[92:95], v[76:79], v[220:223]
    s_waitcnt vmcnt(20)
    s_waitcnt lgkmcnt(0)
    s_barrier
    v_mfma_f32_16x16x32_bf16 v[160:163], v[112:115], v[96:99], v[160:163]
    ds_read_b128 v[64:67], v11 offset:0
    v_mfma_f32_16x16x32_bf16 v[176:179], v[116:119], v[96:99], v[176:179]
    ds_read_b128 v[68:71], v11 offset:1024
    v_mfma_f32_16x16x32_bf16 v[192:195], v[120:123], v[96:99], v[192:195]
    ds_read_b128 v[72:75], v11 offset:2048
    v_mfma_f32_16x16x32_bf16 v[208:211], v[124:127], v[96:99], v[208:211]
    ds_read_b128 v[76:79], v11 offset:3072
    v_mfma_f32_16x16x32_bf16 v[164:167], v[112:115], v[100:103], v[164:167]
    ds_read_b128 v[80:83], v13 offset:0
    v_mfma_f32_16x16x32_bf16 v[180:183], v[116:119], v[100:103], v[180:183]
    ds_read_b128 v[84:87], v13 offset:1024
    v_mfma_f32_16x16x32_bf16 v[196:199], v[120:123], v[100:103], v[196:199]
    ds_read_b128 v[88:91], v13 offset:2048
    v_mfma_f32_16x16x32_bf16 v[212:215], v[124:127], v[100:103], v[212:215]
    ds_read_b128 v[92:95], v13 offset:3072
    v_mfma_f32_16x16x32_bf16 v[168:171], v[112:115], v[104:107], v[168:171]
    s_add_u32 m0, s29, 32768
    s_nop 0
    buffer_load_dwordx4 v2, s[4:7], s24 offen sc1 lds
    v_mfma_f32_16x16x32_bf16 v[184:187], v[116:119], v[104:107], v[184:187]
    v_mfma_f32_16x16x32_bf16 v[200:203], v[120:123], v[104:107], v[200:203]
    s_add_u32 m0, m0, 1024
    s_nop 0
    buffer_load_dwordx4 v8, s[4:7], s24 offen sc1 lds
    v_mfma_f32_16x16x32_bf16 v[216:219], v[124:127], v[104:107], v[216:219]
    v_mfma_f32_16x16x32_bf16 v[172:175], v[112:115], v[108:111], v[172:175]
    s_add_u32 m0, s29, 40960
    s_add_u32 s24, s24, 1024
    buffer_load_dwordx4 v2, s[12:15], s26 offen lds
    v_mfma_f32_16x16x32_bf16 v[188:191], v[116:119], v[108:111], v[188:191]
    v_mfma_f32_16x16x32_bf16 v[204:207], v[120:123], v[108:111], v[204:207]
    buffer_load_dwordx4 v2, s[12:15], s26 offen offset:1024 lds
    s_add_u32 s26, s26, 4096
    v_mfma_f32_16x16x32_bf16 v[220:223], v[124:127], v[108:111], v[220:223]
    s_waitcnt vmcnt(20)
    s_waitcnt lgkmcnt(0)
    s_barrier
    v_mfma_f32_16x16x32_bf16 v[160:163], v[80:83], v[64:67], v[160:163]
    ds_read_b128 v[96:99], v11 offset:16384
    v_mfma_f32_16x16x32_bf16 v[176:179], v[84:87], v[64:67], v[176:179]
    ds_read_b128 v[100:103], v11 offset:17408
    v_mfma_f32_16x16x32_bf16 v[192:195], v[88:91], v[64:67], v[192:195]
    ds_read_b128 v[104:107], v11 offset:18432
    v_mfma_f32_16x16x32_bf16 v[208:211], v[92:95], v[64:67], v[208:211]
    ds_read_b128 v[108:111], v11 offset:19456
    v_mfma_f32_16x16x32_bf16 v[164:167], v[80:83], v[68:71], v[164:167]
    ds_read_b128 v[112:115], v13 offset:16384
    v_mfma_f32_16x16x32_bf16 v[180:183], v[84:87], v[68:71], v[180:183]
    ds_read_b128 v[116:119], v13 offset:17408
    v_mfma_f32_16x16x32_bf16 v[196:199], v[88:91], v[68:71], v[196:199]
    ds_read_b128 v[120:123], v13 offset:18432
    v_mfma_f32_16x16x32_bf16 v[212:215], v[92:95], v[68:71], v[212:215]
    ds_read_b128 v[124:127], v13 offset:19456
    v_mfma_f32_16x16x32_bf16 v[168:171], v[80:83], v[72:75], v[168:171]
    s_add_u32 m0, s29, 49152
    s_nop 0
    buffer_load_dwordx4 v2, s[4:7], s24 offen sc1 lds
    v_mfma_f32_16x16x32_bf16 v[184:187], v[84:87], v[72:75], v[184:187]
    v_mfma_f32_16x16x32_bf16 v[200:203], v[88:91], v[72:75], v[200:203]
    s_add_u32 m0, m0, 1024
    s_nop 0
    buffer_load_dwordx4 v8, s[4:7], s24 offen sc1 lds
    v_mfma_f32_16x16x32_bf16 v[216:219], v[92:95], v[72:75], v[216:219]
    v_mfma_f32_16x16x32_bf16 v[172:175], v[80:83], v[76:79], v[172:175]
    s_add_u32 m0, s29, 57344
    s_add_u32 s24, s24, 1024
    buffer_load_dwordx4 v2, s[12:15], s26 offen lds
    v_mfma_f32_16x16x32_bf16 v[188:191], v[84:87], v[76:79], v[188:191]
    v_mfma_f32_16x16x32_bf16 v[204:207], v[88:91], v[76:79], v[204:207]
    buffer_load_dwordx4 v2, s[12:15], s26 offen offset:1024 lds
    s_add_u32 s26, s26, 4096
    v_mfma_f32_16x16x32_bf16 v[220:223], v[92:95], v[76:79], v[220:223]
    s_waitcnt vmcnt(20)
    s_waitcnt lgkmcnt(0)
    s_barrier
    v_mfma_f32_16x16x32_bf16 v[160:163], v[112:115], v[96:99], v[160:163]
    ds_read_b128 v[64:67], v11 offset:32768
    v_mfma_f32_16x16x32_bf16 v[176:179], v[116:119], v[96:99], v[176:179]
    ds_read_b128 v[68:71], v11 offset:33792
    v_mfma_f32_16x16x32_bf16 v[192:195], v[120:123], v[96:99], v[192:195]
    ds_read_b128 v[72:75], v11 offset:34816
    v_mfma_f32_16x16x32_bf16 v[208:211], v[124:127], v[96:99], v[208:211]
    ds_read_b128 v[76:79], v11 offset:35840
    v_mfma_f32_16x16x32_bf16 v[164:167], v[112:115], v[100:103], v[164:167]
    ds_read_b128 v[80:83], v13 offset:32768
    v_mfma_f32_16x16x32_bf16 v[180:183], v[116:119], v[100:103], v[180:183]
    ds_read_b128 v[84:87], v13 offset:33792
    v_mfma_f32_16x16x32_bf16 v[196:199], v[120:123], v[100:103], v[196:199]
    ds_read_b128 v[88:91], v13 offset:34816
    v_mfma_f32_16x16x32_bf16 v[212:215], v[124:127], v[100:103], v[212:215]
    ds_read_b128 v[92:95], v13 offset:35840
    v_mfma_f32_16x16x32_bf16 v[168:171], v[112:115], v[104:107], v[168:171]
    s_add_u32 m0, s29, 65536
    s_nop 0
    buffer_load_dwordx4 v2, s[4:7], s24 offen sc1 lds
    v_mfma_f32_16x16x32_bf16 v[184:187], v[116:119], v[104:107], v[184:187]
    v_mfma_f32_16x16x32_bf16 v[200:203], v[120:123], v[104:107], v[200:203]
    s_add_u32 m0, m0, 1024
    s_nop 0
    buffer_load_dwordx4 v8, s[4:7], s24 offen sc1 lds
    v_mfma_f32_16x16x32_bf16 v[216:219], v[124:127], v[104:107], v[216:219]
    v_mfma_f32_16x16x32_bf16 v[172:175], v[112:115], v[108:111], v[172:175]
    s_add_u32 m0, s29, 73728
    s_add_u32 s24, s24, 1024
    buffer_load_dwordx4 v2, s[12:15], s26 offen lds
    v_mfma_f32_16x16x32_bf16 v[188:191], v[116:119], v[108:111], v[188:191]
    v_mfma_f32_16x16x32_bf16 v[204:207], v[120:123], v[108:111], v[204:207]
    buffer_load_dwordx4 v2, s[12:15], s26 offen offset:1024 lds
    s_add_u32 s26, s26, 4096
    v_mfma_f32_16x16x32_bf16 v[220:223], v[124:127], v[108:111], v[220:223]
    s_waitcnt vmcnt(20)
    s_waitcnt lgkmcnt(0)
    s_barrier
    v_mfma_f32_16x16x32_bf16 v[160:163], v[80:83], v[64:67], v[160:163]
    ds_read_b128 v[96:99], v11 offset:49152
    v_mfma_f32_16x16x32_bf16 v[176:179], v[84:87], v[64:67], v[176:179]
    ds_read_b128 v[100:103], v11 offset:50176
    v_mfma_f32_16x16x32_bf16 v[192:195], v[88:91], v[64:67], v[192:195]
    ds_read_b128 v[104:107], v11 offset:51200
    v_mfma_f32_16x16x32_bf16 v[208:211], v[92:95], v[64:67], v[208:211]
    ds_read_b128 v[108:111], v11 offset:52224
    v_mfma_f32_16x16x32_bf16 v[164:167], v[80:83], v[68:71], v[164:167]
    ds_read_b128 v[112:115], v13 offset:49152
    v_mfma_f32_16x16x32_bf16 v[180:183], v[84:87], v[68:71], v[180:183]
    ds_read_b128 v[116:119], v13 offset:50176
    v_mfma_f32_16x16x32_bf16 v[196:199], v[88:91], v[68:71], v[196:199]
    ds_read_b128 v[120:123], v13 offset:51200
    v_mfma_f32_16x16x32_bf16 v[212:215], v[92:95], v[68:71], v[212:215]
    ds_read_b128 v[124:127], v13 offset:52224
    v_mfma_f32_16x16x32_bf16 v[168:171], v[80:83], v[72:75], v[168:171]
    s_add_u32 m0, s29, 81920
    s_nop 0
    buffer_load_dwordx4 v2, s[4:7], s24 offen sc1 lds
    v_mfma_f32_16x16x32_bf16 v[184:187], v[84:87], v[72:75], v[184:187]
    v_mfma_f32_16x16x32_bf16 v[200:203], v[88:91], v[72:75], v[200:203]
    s_add_u32 m0, m0, 1024
    s_nop 0
    buffer_load_dwordx4 v8, s[4:7], s24 offen sc1 lds
    v_mfma_f32_16x16x32_bf16 v[216:219], v[92:95], v[72:75], v[216:219]
    v_mfma_f32_16x16x32_bf16 v[172:175], v[80:83], v[76:79], v[172:175]
    s_add_u32 m0, s29, 90112
    s_add_u32 s24, s24, 1024
    buffer_load_dwordx4 v2, s[12:15], s26 offen lds
    v_mfma_f32_16x16x32_bf16 v[188:191], v[84:87], v[76:79], v[188:191]
    v_mfma_f32_16x16x32_bf16 v[204:207], v[88:91], v[76:79], v[204:207]
    buffer_load_dwordx4 v2, s[12:15], s26 offen offset:1024 lds
    s_add_u32 s26, s26, 4096
    v_mfma_f32_16x16x32_bf16 v[220:223], v[92:95], v[76:79], v[220:223]
    s_waitcnt vmcnt(20)
    s_waitcnt lgkmcnt(0)
    s_barrier
    v_mfma_f32_16x16x32_bf16 v[160:163], v[112:115], v[96:99], v[160:163]
    ds_read_b128 v[64:67], v10 offset:0
    v_mfma_f32_16x16x32_bf16 v[176:179], v[116:119], v[96:99], v[176:179]
    ds_read_b128 v[68:71], v10 offset:1024
    v_mfma_f32_16x16x32_bf16 v[192:195], v[120:123], v[96:99], v[192:195]
    ds_read_b128 v[72:75], v10 offset:2048
    v_mfma_f32_16x16x32_bf16 v[208:211], v[124:127], v[96:99], v[208:211]
    ds_read_b128 v[76:79], v10 offset:3072
    v_mfma_f32_16x16x32_bf16 v[164:167], v[112:115], v[100:103], v[164:167]
    ds_read_b128 v[80:83], v12 offset:0
    v_mfma_f32_16x16x32_bf16 v[180:183], v[116:119], v[100:103], v[180:183]
    ds_read_b128 v[84:87], v12 offset:1024
    v_mfma_f32_16x16x32_bf16 v[196:199], v[120:123], v[100:103], v[196:199]
    ds_read_b128 v[88:91], v12 offset:2048
    v_mfma_f32_16x16x32_bf16 v[212:215], v[124:127], v[100:103], v[212:215]
    ds_read_b128 v[92:95], v12 offset:3072
    v_mfma_f32_16x16x32_bf16 v[168:171], v[112:115], v[104:107], v[168:171]
    s_add_u32 m0, s29, 98304
    s_nop 0
    buffer_load_dwordx4 v2, s[4:7], s24 offen sc1 lds
    v_mfma_f32_16x16x32_bf16 v[184:187], v[116:119], v[104:107], v[184:187]
    v_mfma_f32_16x16x32_bf16 v[200:203], v[120:123], v[104:107], v[200:203]
    s_add_u32 m0, m0, 1024
    s_nop 0
    buffer_load_dwordx4 v8, s[4:7], s24 offen sc1 lds
    v_mfma_f32_16x16x32_bf16 v[216:219], v[124:127], v[104:107], v[216:219]
    v_mfma_f32_16x16x32_bf16 v[172:175], v[112:115], v[108:111], v[172:175]
    s_add_u32 m0, s29, 106496
    s_add_u32 s24, s24, 1024
    buffer_load_dwordx4 v2, s[12:15], s26 offen lds
    v_mfma_f32_16x16x32_bf16 v[188:191], v[116:119], v[108:111], v[188:191]
    v_mfma_f32_16x16x32_bf16 v[204:207], v[120:123], v[108:111], v[204:207]
    buffer_load_dwordx4 v2, s[12:15], s26 offen offset:1024 lds
    s_add_u32 s26, s26, 4096
    v_mfma_f32_16x16x32_bf16 v[220:223], v[124:127], v[108:111], v[220:223]
    s_waitcnt vmcnt(20)
    s_waitcnt lgkmcnt(0)
    s_barrier
    v_mfma_f32_16x16x32_bf16 v[160:163], v[80:83], v[64:67], v[160:163]
    ds_read_b128 v[96:99], v10 offset:16384
    v_mfma_f32_16x16x32_bf16 v[176:179], v[84:87], v[64:67], v[176:179]
    ds_read_b128 v[100:103], v10 offset:17408
    v_mfma_f32_16x16x32_bf16 v[192:195], v[88:91], v[64:67], v[192:195]
    ds_read_b128 v[104:107], v10 offset:18432
    v_mfma_f32_16x16x32_bf16 v[208:211], v[92:95], v[64:67], v[208:211]
    ds_read_b128 v[108:111], v10 offset:19456
    v_mfma_f32_16x16x32_bf16 v[164:167], v[80:83], v[68:71], v[164:167]
    ds_read_b128 v[112:115], v12 offset:16384
    v_mfma_f32_16x16x32_bf16 v[180:183], v[84:87], v[68:71], v[180:183]
    ds_read_b128 v[116:119], v12 offset:17408
    v_mfma_f32_16x16x32_bf16 v[196:199], v[88:91], v[68:71], v[196:199]
    ds_read_b128 v[120:123], v12 offset:18432
    v_mfma_f32_16x16x32_bf16 v[212:215], v[92:95], v[68:71], v[212:215]
    ds_read_b128 v[124:127], v12 offset:19456
    v_mfma_f32_16x16x32_bf16 v[168:171], v[80:83], v[72:75], v[168:171]
    s_add_u32 m0, s29, 114688
    s_nop 0
    buffer_load_dwordx4 v2, s[4:7], s24 offen sc1 lds
    v_mfma_f32_16x16x32_bf16 v[184:187], v[84:87], v[72:75], v[184:187]
    v_mfma_f32_16x16x32_bf16 v[200:203], v[88:91], v[72:75], v[200:203]
    s_add_u32 m0, m0, 1024
    s_nop 0
    buffer_load_dwordx4 v8, s[4:7], s24 offen sc1 lds
    v_mfma_f32_16x16x32_bf16 v[216:219], v[92:95], v[72:75], v[216:219]
    v_mfma_f32_16x16x32_bf16 v[172:175], v[80:83], v[76:79], v[172:175]
    s_add_u32 m0, s29, 122880
    s_add_u32 s24, s24, 1024
    buffer_load_dwordx4 v2, s[12:15], s26 offen lds
    v_mfma_f32_16x16x32_bf16 v[188:191], v[84:87], v[76:79], v[188:191]
    v_mfma_f32_16x16x32_bf16 v[204:207], v[88:91], v[76:79], v[204:207]
    buffer_load_dwordx4 v2, s[12:15], s26 offen offset:1024 lds
    s_add_u32 s26, s26, 4096
    v_mfma_f32_16x16x32_bf16 v[220:223], v[92:95], v[76:79], v[220:223]
    s_waitcnt vmcnt(20)
    s_waitcnt lgkmcnt(0)
    s_barrier
    v_mfma_f32_16x16x32_bf16 v[160:163], v[112:115], v[96:99], v[160:163]
    ds_read_b128 v[64:67], v10 offset:32768
    v_mfma_f32_16x16x32_bf16 v[176:179], v[116:119], v[96:99], v[176:179]
    ds_read_b128 v[68:71], v10 offset:33792
    v_mfma_f32_16x16x32_bf16 v[192:195], v[120:123], v[96:99], v[192:195]
    ds_read_b128 v[72:75], v10 offset:34816
    v_mfma_f32_16x16x32_bf16 v[208:211], v[124:127], v[96:99], v[208:211]
    ds_read_b128 v[76:79], v10 offset:35840
    v_mfma_f32_16x16x32_bf16 v[164:167], v[112:115], v[100:103], v[164:167]
    ds_read_b128 v[80:83], v12 offset:32768
    v_mfma_f32_16x16x32_bf16 v[180:183], v[116:119], v[100:103], v[180:183]
    ds_read_b128 v[84:87], v12 offset:33792
    v_mfma_f32_16x16x32_bf16 v[196:199], v[120:123], v[100:103], v[196:199]
    ds_read_b128 v[88:91], v12 offset:34816
    v_mfma_f32_16x16x32_bf16 v[212:215], v[124:127], v[100:103], v[212:215]
    ds_read_b128 v[92:95], v12 offset:35840
    v_mfma_f32_16x16x32_bf16 v[168:171], v[112:115], v[104:107], v[168:171]
    s_add_u32 m0, s29, 0
    s_nop 0
    buffer_load_dwordx4 v2, s[4:7], s24 offen sc1 lds
    v_mfma_f32_16x16x32_bf16 v[184:187], v[116:119], v[104:107], v[184:187]
    v_mfma_f32_16x16x32_bf16 v[200:203], v[120:123], v[104:107], v[200:203]
    s_add_u32 m0, m0, 1024
    s_nop 0
    buffer_load_dwordx4 v8, s[4:7], s24 offen sc1 lds
    v_mfma_f32_16x16x32_bf16 v[216:219], v[124:127], v[104:107], v[216:219]
    v_mfma_f32_16x16x32_bf16 v[172:175], v[112:115], v[108:111], v[172:175]
    s_add_u32 m0, s29, 8192
    s_add_u32 s24, s24, 1024
    buffer_load_dwordx4 v2, s[12:15], s26 offen lds
    v_mfma_f32_16x16x32_bf16 v[188:191], v[116:119], v[108:111], v[188:191]
    v_mfma_f32_16x16x32_bf16 v[204:207], v[120:123], v[108:111], v[204:207]
    buffer_load_dwordx4 v2, s[12:15], s26 offen offset:1024 lds
    s_add_u32 s26, s26, 4096
    v_mfma_f32_16x16x32_bf16 v[220:223], v[124:127], v[108:111], v[220:223]
    s_waitcnt vmcnt(20)
    s_waitcnt lgkmcnt(0)
    s_barrier
    v_mfma_f32_16x16x32_bf16 v[160:163], v[80:83], v[64:67], v[160:163]
    ds_read_b128 v[96:99], v10 offset:49152
    v_mfma_f32_16x16x32_bf16 v[176:179], v[84:87], v[64:67], v[176:179]
    ds_read_b128 v[100:103], v10 offset:50176
    v_mfma_f32_16x16x32_bf16 v[192:195], v[88:91], v[64:67], v[192:195]
    ds_read_b128 v[104:107], v10 offset:51200
    v_mfma_f32_16x16x32_bf16 v[208:211], v[92:95], v[64:67], v[208:211]
    ds_read_b128 v[108:111], v10 offset:52224
    v_mfma_f32_16x16x32_bf16 v[164:167], v[80:83], v[68:71], v[164:167]
    ds_read_b128 v[112:115], v12 offset:49152
    v_mfma_f32_16x16x32_bf16 v[180:183], v[84:87], v[68:71], v[180:183]
    ds_read_b128 v[116:119], v12 offset:50176
    v_mfma_f32_16x16x32_bf16 v[196:199], v[88:91], v[68:71], v[196:199]
    ds_read_b128 v[120:123], v12 offset:51200
    v_mfma_f32_16x16x32_bf16 v[212:215], v[92:95], v[68:71], v[212:215]
    ds_read_b128 v[124:127], v12 offset:52224
    v_mfma_f32_16x16x32_bf16 v[168:171], v[80:83], v[72:75], v[168:171]
    s_add_u32 m0, s29, 16384
    s_nop 0
    buffer_load_dwordx4 v2, s[4:7], s24 offen sc1 lds
    v_mfma_f32_16x16x32_bf16 v[184:187], v[84:87], v[72:75], v[184:187]
    v_mfma_f32_16x16x32_bf16 v[200:203], v[88:91], v[72:75], v[200:203]
    s_add_u32 m0, m0, 1024
    s_nop 0
    buffer_load_dwordx4 v8, s[4:7], s24 offen sc1 lds
    v_mfma_f32_16x16x32_bf16 v[216:219], v[92:95], v[72:75], v[216:219]
    v_mfma_f32_16x16x32_bf16 v[172:175], v[80:83], v[76:79], v[172:175]
    s_add_u32 m0, s29, 24576
    s_add_u32 s24, s24, 1024
    buffer_load_dwordx4 v2, s[12:15], s26 offen lds
    v_mfma_f32_16x16x32_bf16 v[188:191], v[84:87], v[76:79], v[188:191]
    v_mfma_f32_16x16x32_bf16 v[204:207], v[88:91], v[76:79], v[204:207]
    buffer_load_dwordx4 v2, s[12:15], s26 offen offset:1024 lds
    s_add_u32 s26, s26, 4096
    v_mfma_f32_16x16x32_bf16 v[220:223], v[92:95], v[76:79], v[220:223]
    s_waitcnt vmcnt(20)
    s_waitcnt lgkmcnt(0)
    s_barrier
    v_mfma_f32_16x16x32_bf16 v[160:163], v[112:115], v[96:99], v[160:163]
    ds_read_b128 v[64:67], v11 offset:0
    v_mfma_f32_16x16x32_bf16 v[176:179], v[116:119], v[96:99], v[176:179]
    ds_read_b128 v[68:71], v11 offset:1024
    v_mfma_f32_16x16x32_bf16 v[192:195], v[120:123], v[96:99], v[192:195]
    ds_read_b128 v[72:75], v11 offset:2048
    v_mfma_f32_16x16x32_bf16 v[208:211], v[124:127], v[96:99], v[208:211]
    ds_read_b128 v[76:79], v11 offset:3072
    v_mfma_f32_16x16x32_bf16 v[164:167], v[112:115], v[100:103], v[164:167]
    ds_read_b128 v[80:83], v13 offset:0
    v_mfma_f32_16x16x32_bf16 v[180:183], v[116:119], v[100:103], v[180:183]
    ds_read_b128 v[84:87], v13 offset:1024
    v_mfma_f32_16x16x32_bf16 v[196:199], v[120:123], v[100:103], v[196:199]
    ds_read_b128 v[88:91], v13 offset:2048
    v_mfma_f32_16x16x32_bf16 v[212:215], v[124:127], v[100:103], v[212:215]
    ds_read_b128 v[92:95], v13 offset:3072
    v_mfma_f32_16x16x32_bf16 v[168:171], v[112:115], v[104:107], v[168:171]
    s_add_u32 m0, s29, 32768
    s_nop 0
    buffer_load_dwordx4 v2, s[4:7], s24 offen sc1 lds
    v_mfma_f32_16x16x32_bf16 v[184:187], v[116:119], v[104:107], v[184:187]
    v_mfma_f32_16x16x32_bf16 v[200:203], v[120:123], v[104:107], v[200:203]
    s_add_u32 m0, m0, 1024
    s_nop 0
    buffer_load_dwordx4 v8, s[4:7], s24 offen sc1 lds
    v_mfma_f32_16x16x32_bf16 v[216:219], v[124:127], v[104:107], v[216:219]
    v_mfma_f32_16x16x32_bf16 v[172:175], v[112:115], v[108:111], v[172:175]
    s_add_u32 m0, s29, 40960
    s_add_u32 s24, s24, 1024
    buffer_load_dwordx4 v2, s[12:15], s26 offen lds
    v_mfma_f32_16x16x32_bf16 v[188:191], v[116:119], v[108:111], v[188:191]
    v_mfma_f32_16x16x32_bf16 v[204:207], v[120:123], v[108:111], v[204:207]
    buffer_load_dwordx4 v2, s[12:15], s26 offen offset:1024 lds
    s_add_u32 s26, s26, 4096
    v_mfma_f32_16x16x32_bf16 v[220:223], v[124:127], v[108:111], v[220:223]
    s_waitcnt vmcnt(20)
    s_waitcnt lgkmcnt(0)
    s_barrier
    v_mfma_f32_16x16x32_bf16 v[160:163], v[80:83], v[64:67], v[160:163]
    ds_read_b128 v[96:99], v11 offset:16384
    v_mfma_f32_16x16x32_bf16 v[176:179], v[84:87], v[64:67], v[176:179]
    ds_read_b128 v[100:103], v11 offset:17408
    v_mfma_f32_16x16x32_bf16 v[192:195], v[88:91], v[64:67], v[192:195]
    ds_read_b128 v[104:107], v11 offset:18432
    v_mfma_f32_16x16x32_bf16 v[208:211], v[92:95], v[64:67], v[208:211]
    ds_read_b128 v[108:111], v11 offset:19456
    v_mfma_f32_16x16x32_bf16 v[164:167], v[80:83], v[68:71], v[164:167]
    ds_read_b128 v[112:115], v13 offset:16384
    v_mfma_f32_16x16x32_bf16 v[180:183], v[84:87], v[68:71], v[180:183]
    ds_read_b128 v[116:119], v13 offset:17408
    v_mfma_f32_16x16x32_bf16 v[196:199], v[88:91], v[68:71], v[196:199]
    ds_read_b128 v[120:123], v13 offset:18432
    v_mfma_f32_16x16x32_bf16 v[212:215], v[92:95], v[68:71], v[212:215]
    ds_read_b128 v[124:127], v13 offset:19456
    v_mfma_f32_16x16x32_bf16 v[168:171], v[80:83], v[72:75], v[168:171]
    s_add_u32 m0, s29, 49152
    s_nop 0
    buffer_load_dwordx4 v2, s[4:7], s24 offen sc1 lds
    v_mfma_f32_16x16x32_bf16 v[184:187], v[84:87], v[72:75], v[184:187]
    v_mfma_f32_16x16x32_bf16 v[200:203], v[88:91], v[72:75], v[200:203]
    s_add_u32 m0, m0, 1024
    s_nop 0
    buffer_load_dwordx4 v8, s[4:7], s24 offen sc1 lds
    v_mfma_f32_16x16x32_bf16 v[216:219], v[92:95], v[72:75], v[216:219]
    v_mfma_f32_16x16x32_bf16 v[172:175], v[80:83], v[76:79], v[172:175]
    s_add_u32 m0, s29, 57344
    s_add_u32 s24, s24, 1024
    buffer_load_dwordx4 v2, s[12:15], s26 offen lds
    v_mfma_f32_16x16x32_bf16 v[188:191], v[84:87], v[76:79], v[188:191]
    v_mfma_f32_16x16x32_bf16 v[204:207], v[88:91], v[76:79], v[204:207]
    buffer_load_dwordx4 v2, s[12:15], s26 offen offset:1024 lds
    s_add_u32 s26, s26, 4096
    v_mfma_f32_16x16x32_bf16 v[220:223], v[92:95], v[76:79], v[220:223]
    s_waitcnt vmcnt(20)
    s_waitcnt lgkmcnt(0)
    s_barrier
    v_mfma_f32_16x16x32_bf16 v[160:163], v[112:115], v[96:99], v[160:163]
    ds_read_b128 v[64:67], v11 offset:32768
    v_mfma_f32_16x16x32_bf16 v[176:179], v[116:119], v[96:99], v[176:179]
    ds_read_b128 v[68:71], v11 offset:33792
    v_mfma_f32_16x16x32_bf16 v[192:195], v[120:123], v[96:99], v[192:195]
    ds_read_b128 v[72:75], v11 offset:34816
    v_mfma_f32_16x16x32_bf16 v[208:211], v[124:127], v[96:99], v[208:211]
    ds_read_b128 v[76:79], v11 offset:35840
    v_mfma_f32_16x16x32_bf16 v[164:167], v[112:115], v[100:103], v[164:167]
    ds_read_b128 v[80:83], v13 offset:32768
    v_mfma_f32_16x16x32_bf16 v[180:183], v[116:119], v[100:103], v[180:183]
    ds_read_b128 v[84:87], v13 offset:33792
    v_mfma_f32_16x16x32_bf16 v[196:199], v[120:123], v[100:103], v[196:199]
    ds_read_b128 v[88:91], v13 offset:34816
    v_mfma_f32_16x16x32_bf16 v[212:215], v[124:127], v[100:103], v[212:215]
    ds_read_b128 v[92:95], v13 offset:35840
    v_mfma_f32_16x16x32_bf16 v[168:171], v[112:115], v[104:107], v[168:171]
    s_add_u32 m0, s29, 65536
    s_nop 0
    buffer_load_dwordx4 v2, s[4:7], s24 offen sc1 lds
    v_mfma_f32_16x16x32_bf16 v[184:187], v[116:119], v[104:107], v[184:187]
    v_mfma_f32_16x16x32_bf16 v[200:203], v[120:123], v[104:107], v[200:203]
    s_add_u32 m0, m0, 1024
    s_nop 0
    buffer_load_dwordx4 v8, s[4:7], s24 offen sc1 lds
    v_mfma_f32_16x16x32_bf16 v[216:219], v[124:127], v[104:107], v[216:219]
    v_mfma_f32_16x16x32_bf16 v[172:175], v[112:115], v[108:111], v[172:175]
    s_add_u32 m0, s29, 73728
    s_add_u32 s24, s24, 1024
    buffer_load_dwordx4 v2, s[12:15], s26 offen lds
    v_mfma_f32_16x16x32_bf16 v[188:191], v[116:119], v[108:111], v[188:191]
    v_mfma_f32_16x16x32_bf16 v[204:207], v[120:123], v[108:111], v[204:207]
    buffer_load_dwordx4 v2, s[12:15], s26 offen offset:1024 lds
    s_add_u32 s26, s26, 4096
    v_mfma_f32_16x16x32_bf16 v[220:223], v[124:127], v[108:111], v[220:223]
    s_waitcnt vmcnt(20)
    s_waitcnt lgkmcnt(0)
    s_barrier
    v_mfma_f32_16x16x32_bf16 v[160:163], v[80:83], v[64:67], v[160:163]
    ds_read_b128 v[96:99], v11 offset:49152
    v_mfma_f32_16x16x32_bf16 v[176:179], v[84:87], v[64:67], v[176:179]
    ds_read_b128 v[100:103], v11 offset:50176
    v_mfma_f32_16x16x32_bf16 v[192:195], v[88:91], v[64:67], v[192:195]
    ds_read_b128 v[104:107], v11 offset:51200
    v_mfma_f32_16x16x32_bf16 v[208:211], v[92:95], v[64:67], v[208:211]
    ds_read_b128 v[108:111], v11 offset:52224
    v_mfma_f32_16x16x32_bf16 v[164:167], v[80:83], v[68:71], v[164:167]
    ds_read_b128 v[112:115], v13 offset:49152
    v_mfma_f32_16x16x32_bf16 v[180:183], v[84:87], v[68:71], v[180:183]
    ds_read_b128 v[116:119], v13 offset:50176
    v_mfma_f32_16x16x32_bf16 v[196:199], v[88:91], v[68:71], v[196:199]
    ds_read_b128 v[120:123], v13 offset:51200
    v_mfma_f32_16x16x32_bf16 v[212:215], v[92:95], v[68:71], v[212:215]
    ds_read_b128 v[124:127], v13 offset:52224
    v_mfma_f32_16x16x32_bf16 v[168:171], v[80:83], v[72:75], v[168:171]
    s_add_u32 m0, s29, 81920
    s_nop 0
    buffer_load_dwordx4 v2, s[4:7], s24 offen sc1 lds
    v_mfma_f32_16x16x32_bf16 v[184:187], v[84:87], v[72:75], v[184:187]
    v_mfma_f32_16x16x32_bf16 v[200:203], v[88:91], v[72:75], v[200:203]
    s_add_u32 m0, m0, 1024
    s_nop 0
    buffer_load_dwordx4 v8, s[4:7], s24 offen sc1 lds
    v_mfma_f32_16x16x32_bf16 v[216:219], v[92:95], v[72:75], v[216:219]
    v_mfma_f32_16x16x32_bf16 v[172:175], v[80:83], v[76:79], v[172:175]
    s_add_u32 m0, s29, 90112
    s_add_u32 s24, s24, 1024
    buffer_load_dwordx4 v2, s[12:15], s26 offen lds
    v_mfma_f32_16x16x32_bf16 v[188:191], v[84:87], v[76:79], v[188:191]
    v_mfma_f32_16x16x32_bf16 v[204:207], v[88:91], v[76:79], v[204:207]
    buffer_load_dwordx4 v2, s[12:15], s26 offen offset:1024 lds
    s_add_u32 s26, s26, 4096
    v_mfma_f32_16x16x32_bf16 v[220:223], v[92:95], v[76:79], v[220:223]
    s_waitcnt vmcnt(20)
    s_waitcnt lgkmcnt(0)
    s_barrier
    v_mfma_f32_16x16x32_bf16 v[160:163], v[112:115], v[96:99], v[160:163]
    ds_read_b128 v[64:67], v10 offset:0
    v_mfma_f32_16x16x32_bf16 v[176:179], v[116:119], v[96:99], v[176:179]
    ds_read_b128 v[68:71], v10 offset:1024
    v_mfma_f32_16x16x32_bf16 v[192:195], v[120:123], v[96:99], v[192:195]
    ds_read_b128 v[72:75], v10 offset:2048
    v_mfma_f32_16x16x32_bf16 v[208:211], v[124:127], v[96:99], v[208:211]
    ds_read_b128 v[76:79], v10 offset:3072
    v_mfma_f32_16x16x32_bf16 v[164:167], v[112:115], v[100:103], v[164:167]
    ds_read_b128 v[80:83], v12 offset:0
    v_mfma_f32_16x16x32_bf16 v[180:183], v[116:119], v[100:103], v[180:183]
    ds_read_b128 v[84:87], v12 offset:1024
    v_mfma_f32_16x16x32_bf16 v[196:199], v[120:123], v[100:103], v[196:199]
    ds_read_b128 v[88:91], v12 offset:2048
    v_mfma_f32_16x16x32_bf16 v[212:215], v[124:127], v[100:103], v[212:215]
    ds_read_b128 v[92:95], v12 offset:3072
    v_mfma_f32_16x16x32_bf16 v[168:171], v[112:115], v[104:107], v[168:171]
    s_add_u32 m0, s29, 98304
    s_nop 0
    buffer_load_dwordx4 v2, s[4:7], s24 offen sc1 lds
    v_mfma_f32_16x16x32_bf16 v[184:187], v[116:119], v[104:107], v[184:187]
    v_mfma_f32_16x16x32_bf16 v[200:203], v[120:123], v[104:107], v[200:203]
    s_add_u32 m0, m0, 1024
    s_nop 0
    buffer_load_dwordx4 v8, s[4:7], s24 offen sc1 lds
    v_mfma_f32_16x16x32_bf16 v[216:219], v[124:127], v[104:107], v[216:219]
    v_mfma_f32_16x16x32_bf16 v[172:175], v[112:115], v[108:111], v[172:175]
    s_add_u32 m0, s29, 106496
    s_add_u32 s24, s24, 1024
    buffer_load_dwordx4 v2, s[12:15], s26 offen lds
    v_mfma_f32_16x16x32_bf16 v[188:191], v[116:119], v[108:111], v[188:191]
    v_mfma_f32_16x16x32_bf16 v[204:207], v[120:123], v[108:111], v[204:207]
    buffer_load_dwordx4 v2, s[12:15], s26 offen offset:1024 lds
    s_add_u32 s26, s26, 4096
    v_mfma_f32_16x16x32_bf16 v[220:223], v[124:127], v[108:111], v[220:223]
    s_waitcnt vmcnt(20)
    s_waitcnt lgkmcnt(0)
    s_barrier
    v_mfma_f32_16x16x32_bf16 v[160:163], v[80:83], v[64:67], v[160:163]
    ds_read_b128 v[96:99], v10 offset:16384
    v_mfma_f32_16x16x32_bf16 v[176:179], v[84:87], v[64:67], v[176:179]
    ds_read_b128 v[100:103], v10 offset:17408
    v_mfma_f32_16x16x32_bf16 v[192:195], v[88:91], v[64:67], v[192:195]
    ds_read_b128 v[104:107], v10 offset:18432
    v_mfma_f32_16x16x32_bf16 v[208:211], v[92:95], v[64:67], v[208:211]
    ds_read_b128 v[108:111], v10 offset:19456
    v_mfma_f32_16x16x32_bf16 v[164:167], v[80:83], v[68:71], v[164:167]
    ds_read_b128 v[112:115], v12 offset:16384
    v_mfma_f32_16x16x32_bf16 v[180:183], v[84:87], v[68:71], v[180:183]
    ds_read_b128 v[116:119], v12 offset:17408
    v_mfma_f32_16x16x32_bf16 v[196:199], v[88:91], v[68:71], v[196:199]
    ds_read_b128 v[120:123], v12 offset:18432
    v_mfma_f32_16x16x32_bf16 v[212:215], v[92:95], v[68:71], v[212:215]
    ds_read_b128 v[124:127], v12 offset:19456
    v_mfma_f32_16x16x32_bf16 v[168:171], v[80:83], v[72:75], v[168:171]
    s_add_u32 m0, s29, 114688
    s_nop 0
    buffer_load_dwordx4 v2, s[4:7], s24 offen sc1 lds
    v_mfma_f32_16x16x32_bf16 v[184:187], v[84:87], v[72:75], v[184:187]
    v_mfma_f32_16x16x32_bf16 v[200:203], v[88:91], v[72:75], v[200:203]
    s_add_u32 m0, m0, 1024
    s_nop 0
    buffer_load_dwordx4 v8, s[4:7], s24 offen sc1 lds
    v_mfma_f32_16x16x32_bf16 v[216:219], v[92:95], v[72:75], v[216:219]
    v_mfma_f32_16x16x32_bf16 v[172:175], v[80:83], v[76:79], v[172:175]
    s_add_u32 m0, s29, 122880
    s_add_u32 s24, s24, 1024
    buffer_load_dwordx4 v2, s[12:15], s26 offen lds
    v_mfma_f32_16x16x32_bf16 v[188:191], v[84:87], v[76:79], v[188:191]
    v_mfma_f32_16x16x32_bf16 v[204:207], v[88:91], v[76:79], v[204:207]
    buffer_load_dwordx4 v2, s[12:15], s26 offen offset:1024 lds
    s_add_u32 s26, s26, 4096
    v_mfma_f32_16x16x32_bf16 v[220:223], v[92:95], v[76:79], v[220:223]
    buffer_load_dwordx2 v[24:25], v21, s[48:51], s56 offen offset:0
    buffer_load_dwordx2 v[26:27], v21, s[48:51], s56 offen offset:32
    buffer_load_dwordx2 v[28:29], v21, s[48:51], s56 offen offset:64
    buffer_load_dwordx2 v[30:31], v21, s[48:51], s56 offen offset:96
    s_waitcnt vmcnt(20)
    s_waitcnt lgkmcnt(0)
    s_barrier
    v_mfma_f32_16x16x32_bf16 v[160:163], v[112:115], v[96:99], v[160:163]
    ds_read_b128 v[64:67], v10 offset:32768
    v_mfma_f32_16x16x32_bf16 v[176:179], v[116:119], v[96:99], v[176:179]
    ds_read_b128 v[68:71], v10 offset:33792
    v_mfma_f32_16x16x32_bf16 v[192:195], v[120:123], v[96:99], v[192:195]
    ds_read_b128 v[72:75], v10 offset:34816
    v_mfma_f32_16x16x32_bf16 v[208:211], v[124:127], v[96:99], v[208:211]
    ds_read_b128 v[76:79], v10 offset:35840
    v_mfma_f32_16x16x32_bf16 v[164:167], v[112:115], v[100:103], v[164:167]
    ds_read_b128 v[80:83], v12 offset:32768
    v_mfma_f32_16x16x32_bf16 v[180:183], v[116:119], v[100:103], v[180:183]
    ds_read_b128 v[84:87], v12 offset:33792
    v_mfma_f32_16x16x32_bf16 v[196:199], v[120:123], v[100:103], v[196:199]
    ds_read_b128 v[88:91], v12 offset:34816
    v_mfma_f32_16x16x32_bf16 v[212:215], v[124:127], v[100:103], v[212:215]
    ds_read_b128 v[92:95], v12 offset:35840
    v_mfma_f32_16x16x32_bf16 v[168:171], v[112:115], v[104:107], v[168:171]
    s_add_u32 m0, s29, 0
    s_nop 0
    buffer_load_dwordx4 v2, s[4:7], s24 offen sc1 lds
    v_mfma_f32_16x16x32_bf16 v[184:187], v[116:119], v[104:107], v[184:187]
    v_mfma_f32_16x16x32_bf16 v[200:203], v[120:123], v[104:107], v[200:203]
    s_add_u32 m0, m0, 1024
    s_nop 0
    buffer_load_dwordx4 v8, s[4:7], s24 offen sc1 lds
    v_mfma_f32_16x16x32_bf16 v[216:219], v[124:127], v[104:107], v[216:219]
    v_mfma_f32_16x16x32_bf16 v[172:175], v[112:115], v[108:111], v[172:175]
    s_add_u32 m0, s29, 8192
    s_add_u32 s24, s24, 1024
    buffer_load_dwordx4 v2, s[12:15], s26 offen lds
    v_mfma_f32_16x16x32_bf16 v[188:191], v[116:119], v[108:111], v[188:191]
    v_mfma_f32_16x16x32_bf16 v[204:207], v[120:123], v[108:111], v[204:207]
    buffer_load_dwordx4 v2, s[12:15], s26 offen offset:1024 lds
    s_add_u32 s26, s26, 4096
    v_mfma_f32_16x16x32_bf16 v[220:223], v[124:127], v[108:111], v[220:223]
    s_waitcnt vmcnt(20)
    s_waitcnt lgkmcnt(0)
    s_barrier
    v_mfma_f32_16x16x32_bf16 v[160:163], v[80:83], v[64:67], v[160:163]
    ds_read_b128 v[96:99], v10 offset:49152
    v_mfma_f32_16x16x32_bf16 v[176:179], v[84:87], v[64:67], v[176:179]
    ds_read_b128 v[100:103], v10 offset:50176
    v_mfma_f32_16x16x32_bf16 v[192:195], v[88:91], v[64:67], v[192:195]
    ds_read_b128 v[104:107], v10 offset:51200
    v_mfma_f32_16x16x32_bf16 v[208:211], v[92:95], v[64:67], v[208:211]
    ds_read_b128 v[108:111], v10 offset:52224
    v_mfma_f32_16x16x32_bf16 v[164:167], v[80:83], v[68:71], v[164:167]
    ds_read_b128 v[112:115], v12 offset:49152
    v_mfma_f32_16x16x32_bf16 v[180:183], v[84:87], v[68:71], v[180:183]
    ds_read_b128 v[116:119], v12 offset:50176
    v_mfma_f32_16x16x32_bf16 v[196:199], v[88:91], v[68:71], v[196:199]
    ds_read_b128 v[120:123], v12 offset:51200
    v_mfma_f32_16x16x32_bf16 v[212:215], v[92:95], v[68:71], v[212:215]
    ds_read_b128 v[124:127], v12 offset:52224
    v_mfma_f32_16x16x32_bf16 v[168:171], v[80:83], v[72:75], v[168:171]
    s_add_u32 m0, s29, 16384
    s_nop 0
    buffer_load_dwordx4 v2, s[4:7], s24 offen sc1 lds
    v_mfma_f32_16x16x32_bf16 v[184:187], v[84:87], v[72:75], v[184:187]
    v_mfma_f32_16x16x32_bf16 v[200:203], v[88:91], v[72:75], v[200:203]
    s_add_u32 m0, m0, 1024
    s_nop 0
    buffer_load_dwordx4 v8, s[4:7], s24 offen sc1 lds
    v_mfma_f32_16x16x32_bf16 v[216:219], v[92:95], v[72:75], v[216:219]
    v_mfma_f32_16x16x32_bf16 v[172:175], v[80:83], v[76:79], v[172:175]
    s_add_u32 m0, s29, 24576
    s_add_u32 s24, s24, 1024
    buffer_load_dwordx4 v2, s[12:15], s26 offen lds
    v_mfma_f32_16x16x32_bf16 v[188:191], v[84:87], v[76:79], v[188:191]
    v_mfma_f32_16x16x32_bf16 v[204:207], v[88:91], v[76:79], v[204:207]
    buffer_load_dwordx4 v2, s[12:15], s26 offen offset:1024 lds
    s_add_u32 s26, s26, 4096
    v_mfma_f32_16x16x32_bf16 v[220:223], v[92:95], v[76:79], v[220:223]
    s_waitcnt vmcnt(20)
    s_waitcnt lgkmcnt(0)
    s_barrier
    v_mfma_f32_16x16x32_bf16 v[160:163], v[112:115], v[96:99], v[160:163]
    ds_read_b128 v[64:67], v11 offset:0
    v_mfma_f32_16x16x32_bf16 v[176:179], v[116:119], v[96:99], v[176:179]
    ds_read_b128 v[68:71], v11 offset:1024
    v_mfma_f32_16x16x32_bf16 v[192:195], v[120:123], v[96:99], v[192:195]
    ds_read_b128 v[72:75], v11 offset:2048
    v_mfma_f32_16x16x32_bf16 v[208:211], v[124:127], v[96:99], v[208:211]
    ds_read_b128 v[76:79], v11 offset:3072
    v_mfma_f32_16x16x32_bf16 v[164:167], v[112:115], v[100:103], v[164:167]
    ds_read_b128 v[80:83], v13 offset:0
    v_mfma_f32_16x16x32_bf16 v[180:183], v[116:119], v[100:103], v[180:183]
    ds_read_b128 v[84:87], v13 offset:1024
    v_mfma_f32_16x16x32_bf16 v[196:199], v[120:123], v[100:103], v[196:199]
    ds_read_b128 v[88:91], v13 offset:2048
    v_mfma_f32_16x16x32_bf16 v[212:215], v[124:127], v[100:103], v[212:215]
    ds_read_b128 v[92:95], v13 offset:3072
    v_mfma_f32_16x16x32_bf16 v[168:171], v[112:115], v[104:107], v[168:171]
    s_add_u32 m0, s29, 32768
    s_nop 0
    buffer_load_dwordx4 v2, s[4:7], s24 offen sc1 lds
    v_mfma_f32_16x16x32_bf16 v[184:187], v[116:119], v[104:107], v[184:187]
    v_mfma_f32_16x16x32_bf16 v[200:203], v[120:123], v[104:107], v[200:203]
    s_add_u32 m0, m0, 1024
    s_nop 0
    buffer_load_dwordx4 v8, s[4:7], s24 offen sc1 lds
    v_mfma_f32_16x16x32_bf16 v[216:219], v[124:127], v[104:107], v[216:219]
    v_mfma_f32_16x16x32_bf16 v[172:175], v[112:115], v[108:111], v[172:175]
    s_add_u32 m0, s29, 40960
    s_add_u32 s24, s24, 1024
    buffer_load_dwordx4 v2, s[12:15], s26 offen lds
    v_mfma_f32_16x16x32_bf16 v[188:191], v[116:119], v[108:111], v[188:191]
    v_mfma_f32_16x16x32_bf16 v[204:207], v[120:123], v[108:111], v[204:207]
    buffer_load_dwordx4 v2, s[12:15], s26 offen offset:1024 lds
    s_add_u32 s26, s26, 4096
    v_mfma_f32_16x16x32_bf16 v[220:223], v[124:127], v[108:111], v[220:223]
    s_waitcnt vmcnt(20)
    s_waitcnt lgkmcnt(0)
    s_barrier
    v_mfma_f32_16x16x32_bf16 v[160:163], v[80:83], v[64:67], v[160:163]
    ds_read_b128 v[96:99], v11 offset:16384
    v_mfma_f32_16x16x32_bf16 v[176:179], v[84:87], v[64:67], v[176:179]
    ds_read_b128 v[100:103], v11 offset:17408
    v_mfma_f32_16x16x32_bf16 v[192:195], v[88:91], v[64:67], v[192:195]
    ds_read_b128 v[104:107], v11 offset:18432
    v_mfma_f32_16x16x32_bf16 v[208:211], v[92:95], v[64:67], v[208:211]
    ds_read_b128 v[108:111], v11 offset:19456
    v_mfma_f32_16x16x32_bf16 v[164:167], v[80:83], v[68:71], v[164:167]
    ds_read_b128 v[112:115], v13 offset:16384
    v_mfma_f32_16x16x32_bf16 v[180:183], v[84:87], v[68:71], v[180:183]
    ds_read_b128 v[116:119], v13 offset:17408
    v_mfma_f32_16x16x32_bf16 v[196:199], v[88:91], v[68:71], v[196:199]
    ds_read_b128 v[120:123], v13 offset:18432
    v_mfma_f32_16x16x32_bf16 v[212:215], v[92:95], v[68:71], v[212:215]
    ds_read_b128 v[124:127], v13 offset:19456
    v_mfma_f32_16x16x32_bf16 v[168:171], v[80:83], v[72:75], v[168:171]
    s_add_u32 m0, s29, 49152
    s_nop 0
    buffer_load_dwordx4 v2, s[4:7], s24 offen sc1 lds
    v_mfma_f32_16x16x32_bf16 v[184:187], v[84:87], v[72:75], v[184:187]
    v_mfma_f32_16x16x32_bf16 v[200:203], v[88:91], v[72:75], v[200:203]
    s_add_u32 m0, m0, 1024
    s_nop 0
    buffer_load_dwordx4 v8, s[4:7], s24 offen sc1 lds
    v_mfma_f32_16x16x32_bf16 v[216:219], v[92:95], v[72:75], v[216:219]
    v_mfma_f32_16x16x32_bf16 v[172:175], v[80:83], v[76:79], v[172:175]
    s_add_u32 m0, s29, 57344
    s_add_u32 s24, s24, 1024
    buffer_load_dwordx4 v2, s[12:15], s26 offen lds
    v_mfma_f32_16x16x32_bf16 v[188:191], v[84:87], v[76:79], v[188:191]
    v_mfma_f32_16x16x32_bf16 v[204:207], v[88:91], v[76:79], v[204:207]
    buffer_load_dwordx4 v2, s[12:15], s26 offen offset:1024 lds
    s_add_u32 s26, s26, 4096
    v_mfma_f32_16x16x32_bf16 v[220:223], v[92:95], v[76:79], v[220:223]
    s_waitcnt vmcnt(20)
    s_waitcnt lgkmcnt(0)
    s_barrier
    v_mfma_f32_16x16x32_bf16 v[160:163], v[112:115], v[96:99], v[160:163]
    ds_read_b128 v[64:67], v11 offset:32768
    v_mfma_f32_16x16x32_bf16 v[176:179], v[116:119], v[96:99], v[176:179]
    ds_read_b128 v[68:71], v11 offset:33792
    v_mfma_f32_16x16x32_bf16 v[192:195], v[120:123], v[96:99], v[192:195]
    ds_read_b128 v[72:75], v11 offset:34816
    v_mfma_f32_16x16x32_bf16 v[208:211], v[124:127], v[96:99], v[208:211]
    ds_read_b128 v[76:79], v11 offset:35840
    v_mfma_f32_16x16x32_bf16 v[164:167], v[112:115], v[100:103], v[164:167]
    ds_read_b128 v[80:83], v13 offset:32768
    v_mfma_f32_16x16x32_bf16 v[180:183], v[116:119], v[100:103], v[180:183]
    ds_read_b128 v[84:87], v13 offset:33792
    v_mfma_f32_16x16x32_bf16 v[196:199], v[120:123], v[100:103], v[196:199]
    ds_read_b128 v[88:91], v13 offset:34816
    v_mfma_f32_16x16x32_bf16 v[212:215], v[124:127], v[100:103], v[212:215]
    ds_read_b128 v[92:95], v13 offset:35840
    v_mfma_f32_16x16x32_bf16 v[168:171], v[112:115], v[104:107], v[168:171]
    s_add_u32 m0, s29, 65536
    s_nop 0
    buffer_load_dwordx4 v2, s[4:7], s24 offen sc1 lds
    v_mfma_f32_16x16x32_bf16 v[184:187], v[116:119], v[104:107], v[184:187]
    v_mfma_f32_16x16x32_bf16 v[200:203], v[120:123], v[104:107], v[200:203]
    s_add_u32 m0, m0, 1024
    s_nop 0
    buffer_load_dwordx4 v8, s[4:7], s24 offen sc1 lds
    v_mfma_f32_16x16x32_bf16 v[216:219], v[124:127], v[104:107], v[216:219]
    v_mfma_f32_16x16x32_bf16 v[172:175], v[112:115], v[108:111], v[172:175]
    s_add_u32 m0, s29, 73728
    s_add_u32 s24, s24, 1024
    buffer_load_dwordx4 v2, s[12:15], s26 offen lds
    v_mfma_f32_16x16x32_bf16 v[188:191], v[116:119], v[108:111], v[188:191]
    v_mfma_f32_16x16x32_bf16 v[204:207], v[120:123], v[108:111], v[204:207]
    buffer_load_dwordx4 v2, s[12:15], s26 offen offset:1024 lds
    s_add_u32 s26, s26, 4096
    v_mfma_f32_16x16x32_bf16 v[220:223], v[124:127], v[108:111], v[220:223]
    s_waitcnt vmcnt(20)
    s_waitcnt lgkmcnt(0)
    s_barrier
    v_mfma_f32_16x16x32_bf16 v[160:163], v[80:83], v[64:67], v[160:163]
    ds_read_b128 v[96:99], v11 offset:49152
    v_mfma_f32_16x16x32_bf16 v[176:179], v[84:87], v[64:67], v[176:179]
    ds_read_b128 v[100:103], v11 offset:50176
    v_mfma_f32_16x16x32_bf16 v[192:195], v[88:91], v[64:67], v[192:195]
    ds_read_b128 v[104:107], v11 offset:51200
    v_mfma_f32_16x16x32_bf16 v[208:211], v[92:95], v[64:67], v[208:211]
    ds_read_b128 v[108:111], v11 offset:52224
    v_mfma_f32_16x16x32_bf16 v[164:167], v[80:83], v[68:71], v[164:167]
    ds_read_b128 v[112:115], v13 offset:49152
    v_mfma_f32_16x16x32_bf16 v[180:183], v[84:87], v[68:71], v[180:183]
    ds_read_b128 v[116:119], v13 offset:50176
    v_mfma_f32_16x16x32_bf16 v[196:199], v[88:91], v[68:71], v[196:199]
    ds_read_b128 v[120:123], v13 offset:51200
    v_mfma_f32_16x16x32_bf16 v[212:215], v[92:95], v[68:71], v[212:215]
    ds_read_b128 v[124:127], v13 offset:52224
    v_mfma_f32_16x16x32_bf16 v[168:171], v[80:83], v[72:75], v[168:171]
    s_add_u32 m0, s29, 81920
    s_nop 0
    buffer_load_dwordx4 v2, s[4:7], s24 offen sc1 lds
    v_mfma_f32_16x16x32_bf16 v[184:187], v[84:87], v[72:75], v[184:187]
    v_mfma_f32_16x16x32_bf16 v[200:203], v[88:91], v[72:75], v[200:203]
    s_add_u32 m0, m0, 1024
    s_nop 0
    buffer_load_dwordx4 v8, s[4:7], s24 offen sc1 lds
    v_mfma_f32_16x16x32_bf16 v[216:219], v[92:95], v[72:75], v[216:219]
    v_mfma_f32_16x16x32_bf16 v[172:175], v[80:83], v[76:79], v[172:175]
    s_add_u32 m0, s29, 90112
    s_add_u32 s24, s24, 1024
    buffer_load_dwordx4 v2, s[12:15], s26 offen lds
    v_mfma_f32_16x16x32_bf16 v[188:191], v[84:87], v[76:79], v[188:191]
    v_mfma_f32_16x16x32_bf16 v[204:207], v[88:91], v[76:79], v[204:207]
    buffer_load_dwordx4 v2, s[12:15], s26 offen offset:1024 lds
    s_add_u32 s26, s26, 4096
    v_mfma_f32_16x16x32_bf16 v[220:223], v[92:95], v[76:79], v[220:223]
    s_waitcnt vmcnt(20)
    s_waitcnt lgkmcnt(0)
    s_barrier
    v_mfma_f32_16x16x32_bf16 v[160:163], v[112:115], v[96:99], v[160:163]
    ds_read_b128 v[64:67], v10 offset:0
    v_mfma_f32_16x16x32_bf16 v[176:179], v[116:119], v[96:99], v[176:179]
    ds_read_b128 v[68:71], v10 offset:1024
    v_mfma_f32_16x16x32_bf16 v[192:195], v[120:123], v[96:99], v[192:195]
    ds_read_b128 v[72:75], v10 offset:2048
    v_mfma_f32_16x16x32_bf16 v[208:211], v[124:127], v[96:99], v[208:211]
    ds_read_b128 v[76:79], v10 offset:3072
    v_mfma_f32_16x16x32_bf16 v[164:167], v[112:115], v[100:103], v[164:167]
    ds_read_b128 v[80:83], v12 offset:0
    v_mfma_f32_16x16x32_bf16 v[180:183], v[116:119], v[100:103], v[180:183]
    ds_read_b128 v[84:87], v12 offset:1024
    v_mfma_f32_16x16x32_bf16 v[196:199], v[120:123], v[100:103], v[196:199]
    ds_read_b128 v[88:91], v12 offset:2048
    v_mfma_f32_16x16x32_bf16 v[212:215], v[124:127], v[100:103], v[212:215]
    ds_read_b128 v[92:95], v12 offset:3072
    v_mfma_f32_16x16x32_bf16 v[168:171], v[112:115], v[104:107], v[168:171]
    s_add_u32 m0, s29, 98304
    s_nop 0
    buffer_load_dwordx4 v2, s[4:7], s24 offen sc1 lds
    v_mfma_f32_16x16x32_bf16 v[184:187], v[116:119], v[104:107], v[184:187]
    v_mfma_f32_16x16x32_bf16 v[200:203], v[120:123], v[104:107], v[200:203]
    s_add_u32 m0, m0, 1024
    s_nop 0
    buffer_load_dwordx4 v8, s[4:7], s24 offen sc1 lds
    v_mfma_f32_16x16x32_bf16 v[216:219], v[124:127], v[104:107], v[216:219]
    v_mfma_f32_16x16x32_bf16 v[172:175], v[112:115], v[108:111], v[172:175]
    s_add_u32 m0, s29, 106496
    s_add_u32 s24, s24, 1024
    buffer_load_dwordx4 v2, s[12:15], s26 offen lds
    v_mfma_f32_16x16x32_bf16 v[188:191], v[116:119], v[108:111], v[188:191]
    v_mfma_f32_16x16x32_bf16 v[204:207], v[120:123], v[108:111], v[204:207]
    buffer_load_dwordx4 v2, s[12:15], s26 offen offset:1024 lds
    s_add_u32 s26, s26, 4096
    v_mfma_f32_16x16x32_bf16 v[220:223], v[124:127], v[108:111], v[220:223]
    s_waitcnt vmcnt(20)
    s_waitcnt lgkmcnt(0)
    s_barrier
    v_mfma_f32_16x16x32_bf16 v[160:163], v[80:83], v[64:67], v[160:163]
    ds_read_b128 v[96:99], v10 offset:16384
    v_mfma_f32_16x16x32_bf16 v[176:179], v[84:87], v[64:67], v[176:179]
    ds_read_b128 v[100:103], v10 offset:17408
    v_mfma_f32_16x16x32_bf16 v[192:195], v[88:91], v[64:67], v[192:195]
    ds_read_b128 v[104:107], v10 offset:18432
    v_mfma_f32_16x16x32_bf16 v[208:211], v[92:95], v[64:67], v[208:211]
    ds_read_b128 v[108:111], v10 offset:19456
    v_mfma_f32_16x16x32_bf16 v[164:167], v[80:83], v[68:71], v[164:167]
    ds_read_b128 v[112:115], v12 offset:16384
    v_mfma_f32_16x16x32_bf16 v[180:183], v[84:87], v[68:71], v[180:183]
    ds_read_b128 v[116:119], v12 offset:17408
    v_mfma_f32_16x16x32_bf16 v[196:199], v[88:91], v[68:71], v[196:199]
    ds_read_b128 v[120:123], v12 offset:18432
    v_mfma_f32_16x16x32_bf16 v[212:215], v[92:95], v[68:71], v[212:215]
    ds_read_b128 v[124:127], v12 offset:19456
    v_mfma_f32_16x16x32_bf16 v[168:171], v[80:83], v[72:75], v[168:171]
    s_add_u32 m0, s29, 114688
    s_nop 0
    buffer_load_dwordx4 v2, s[4:7], s24 offen sc1 lds
    v_mfma_f32_16x16x32_bf16 v[184:187], v[84:87], v[72:75], v[184:187]
    v_mfma_f32_16x16x32_bf16 v[200:203], v[88:91], v[72:75], v[200:203]
    s_add_u32 m0, m0, 1024
    s_nop 0
    buffer_load_dwordx4 v8, s[4:7], s24 offen sc1 lds
    v_mfma_f32_16x16x32_bf16 v[216:219], v[92:95], v[72:75], v[216:219]
    v_mfma_f32_16x16x32_bf16 v[172:175], v[80:83], v[76:79], v[172:175]
    s_add_u32 m0, s29, 122880
    s_add_u32 s24, s24, 1024
    buffer_load_dwordx4 v2, s[12:15], s26 offen lds
    v_mfma_f32_16x16x32_bf16 v[188:191], v[84:87], v[76:79], v[188:191]
    v_mfma_f32_16x16x32_bf16 v[204:207], v[88:91], v[76:79], v[204:207]
    buffer_load_dwordx4 v2, s[12:15], s26 offen offset:1024 lds
    s_add_u32 s26, s26, 4096
    v_mfma_f32_16x16x32_bf16 v[220:223], v[92:95], v[76:79], v[220:223]
    s_waitcnt vmcnt(20)
    s_waitcnt lgkmcnt(0)
    s_barrier
    v_mfma_f32_16x16x32_bf16 v[160:163], v[112:115], v[96:99], v[160:163]
    ds_read_b128 v[64:67], v10 offset:32768
    v_mfma_f32_16x16x32_bf16 v[176:179], v[116:119], v[96:99], v[176:179]
    ds_read_b128 v[68:71], v10 offset:33792
    v_mfma_f32_16x16x32_bf16 v[192:195], v[120:123], v[96:99], v[192:195]
    ds_read_b128 v[72:75], v10 offset:34816
    v_mfma_f32_16x16x32_bf16 v[208:211], v[124:127], v[96:99], v[208:211]
    ds_read_b128 v[76:79], v10 offset:35840
    v_mfma_f32_16x16x32_bf16 v[164:167], v[112:115], v[100:103], v[164:167]
    ds_read_b128 v[80:83], v12 offset:32768
    v_mfma_f32_16x16x32_bf16 v[180:183], v[116:119], v[100:103], v[180:183]
    ds_read_b128 v[84:87], v12 offset:33792
    v_mfma_f32_16x16x32_bf16 v[196:199], v[120:123], v[100:103], v[196:199]
    ds_read_b128 v[88:91], v12 offset:34816
    v_mfma_f32_16x16x32_bf16 v[212:215], v[124:127], v[100:103], v[212:215]
    ds_read_b128 v[92:95], v12 offset:35840
    v_mfma_f32_16x16x32_bf16 v[168:171], v[112:115], v[104:107], v[168:171]
    s_add_u32 m0, s29, 0
    s_nop 0
    buffer_load_dwordx4 v2, s[4:7], s24 offen sc1 lds
    v_mfma_f32_16x16x32_bf16 v[184:187], v[116:119], v[104:107], v[184:187]
    v_mfma_f32_16x16x32_bf16 v[200:203], v[120:123], v[104:107], v[200:203]
    s_add_u32 m0, m0, 1024
    s_nop 0
    buffer_load_dwordx4 v8, s[4:7], s24 offen sc1 lds
    v_mfma_f32_16x16x32_bf16 v[216:219], v[124:127], v[104:107], v[216:219]
    v_mfma_f32_16x16x32_bf16 v[172:175], v[112:115], v[108:111], v[172:175]
    s_add_u32 m0, s29, 8192
    s_add_u32 s24, s24, 1024
    buffer_load_dwordx4 v2, s[12:15], s26 offen lds
    v_mfma_f32_16x16x32_bf16 v[188:191], v[116:119], v[108:111], v[188:191]
    v_mfma_f32_16x16x32_bf16 v[204:207], v[120:123], v[108:111], v[204:207]
    buffer_load_dwordx4 v2, s[12:15], s26 offen offset:1024 lds
    s_add_u32 s26, s26, 4096
    v_mfma_f32_16x16x32_bf16 v[220:223], v[124:127], v[108:111], v[220:223]
    s_waitcnt vmcnt(20)
    s_waitcnt lgkmcnt(0)
    s_barrier
    v_mfma_f32_16x16x32_bf16 v[160:163], v[80:83], v[64:67], v[160:163]
    ds_read_b128 v[96:99], v10 offset:49152
    v_mfma_f32_16x16x32_bf16 v[176:179], v[84:87], v[64:67], v[176:179]
    ds_read_b128 v[100:103], v10 offset:50176
    v_mfma_f32_16x16x32_bf16 v[192:195], v[88:91], v[64:67], v[192:195]
    ds_read_b128 v[104:107], v10 offset:51200
    v_mfma_f32_16x16x32_bf16 v[208:211], v[92:95], v[64:67], v[208:211]
    ds_read_b128 v[108:111], v10 offset:52224
    v_mfma_f32_16x16x32_bf16 v[164:167], v[80:83], v[68:71], v[164:167]
    ds_read_b128 v[112:115], v12 offset:49152
    v_mfma_f32_16x16x32_bf16 v[180:183], v[84:87], v[68:71], v[180:183]
    ds_read_b128 v[116:119], v12 offset:50176
    v_mfma_f32_16x16x32_bf16 v[196:199], v[88:91], v[68:71], v[196:199]
    ds_read_b128 v[120:123], v12 offset:51200
    v_mfma_f32_16x16x32_bf16 v[212:215], v[92:95], v[68:71], v[212:215]
    ds_read_b128 v[124:127], v12 offset:52224
    v_mfma_f32_16x16x32_bf16 v[168:171], v[80:83], v[72:75], v[168:171]
    s_add_u32 m0, s29, 16384
    s_nop 0
    buffer_load_dwordx4 v2, s[4:7], s24 offen sc1 lds
    v_mfma_f32_16x16x32_bf16 v[184:187], v[84:87], v[72:75], v[184:187]
    v_mfma_f32_16x16x32_bf16 v[200:203], v[88:91], v[72:75], v[200:203]
    s_add_u32 m0, m0, 1024
    s_nop 0
    buffer_load_dwordx4 v8, s[4:7], s24 offen sc1 lds
    v_mfma_f32_16x16x32_bf16 v[216:219], v[92:95], v[72:75], v[216:219]
    v_mfma_f32_16x16x32_bf16 v[172:175], v[80:83], v[76:79], v[172:175]
    s_add_u32 m0, s29, 24576
    s_add_u32 s24, s24, 1024
    buffer_load_dwordx4 v2, s[12:15], s26 offen lds
    v_mfma_f32_16x16x32_bf16 v[188:191], v[84:87], v[76:79], v[188:191]
    v_mfma_f32_16x16x32_bf16 v[204:207], v[88:91], v[76:79], v[204:207]
    buffer_load_dwordx4 v2, s[12:15], s26 offen offset:1024 lds
    s_add_u32 s26, s26, 4096
    v_mfma_f32_16x16x32_bf16 v[220:223], v[92:95], v[76:79], v[220:223]
    s_waitcnt vmcnt(20)
    s_waitcnt lgkmcnt(0)
    s_barrier
    v_mfma_f32_16x16x32_bf16 v[160:163], v[112:115], v[96:99], v[160:163]
    ds_read_b128 v[64:67], v11 offset:0
    v_mfma_f32_16x16x32_bf16 v[176:179], v[116:119], v[96:99], v[176:179]
    ds_read_b128 v[68:71], v11 offset:1024
    v_mfma_f32_16x16x32_bf16 v[192:195], v[120:123], v[96:99], v[192:195]
    ds_read_b128 v[72:75], v11 offset:2048
    v_mfma_f32_16x16x32_bf16 v[208:211], v[124:127], v[96:99], v[208:211]
    ds_read_b128 v[76:79], v11 offset:3072
    v_mfma_f32_16x16x32_bf16 v[164:167], v[112:115], v[100:103], v[164:167]
    ds_read_b128 v[80:83], v13 offset:0
    v_mfma_f32_16x16x32_bf16 v[180:183], v[116:119], v[100:103], v[180:183]
    ds_read_b128 v[84:87], v13 offset:1024
    v_mfma_f32_16x16x32_bf16 v[196:199], v[120:123], v[100:103], v[196:199]
    ds_read_b128 v[88:91], v13 offset:2048
    v_mfma_f32_16x16x32_bf16 v[212:215], v[124:127], v[100:103], v[212:215]
    ds_read_b128 v[92:95], v13 offset:3072
    v_mfma_f32_16x16x32_bf16 v[168:171], v[112:115], v[104:107], v[168:171]
    s_add_u32 m0, s29, 32768
    s_nop 0
    buffer_load_dwordx4 v2, s[4:7], s24 offen sc1 lds
    v_mfma_f32_16x16x32_bf16 v[184:187], v[116:119], v[104:107], v[184:187]
    v_mfma_f32_16x16x32_bf16 v[200:203], v[120:123], v[104:107], v[200:203]
    s_add_u32 m0, m0, 1024
    s_nop 0
    buffer_load_dwordx4 v8, s[4:7], s24 offen sc1 lds
    v_mfma_f32_16x16x32_bf16 v[216:219], v[124:127], v[104:107], v[216:219]
    v_mfma_f32_16x16x32_bf16 v[172:175], v[112:115], v[108:111], v[172:175]
    s_add_u32 m0, s29, 40960
    s_add_u32 s24, s24, 1024
    buffer_load_dwordx4 v2, s[12:15], s26 offen lds
    v_mfma_f32_16x16x32_bf16 v[188:191], v[116:119], v[108:111], v[188:191]
    v_mfma_f32_16x16x32_bf16 v[204:207], v[120:123], v[108:111], v[204:207]
    buffer_load_dwordx4 v2, s[12:15], s26 offen offset:1024 lds
    s_add_u32 s26, s26, 4096
    v_mfma_f32_16x16x32_bf16 v[220:223], v[124:127], v[108:111], v[220:223]
    s_waitcnt vmcnt(20)
    s_waitcnt lgkmcnt(0)
    s_barrier
    v_mfma_f32_16x16x32_bf16 v[160:163], v[80:83], v[64:67], v[160:163]
    ds_read_b128 v[96:99], v11 offset:16384
    v_mfma_f32_16x16x32_bf16 v[176:179], v[84:87], v[64:67], v[176:179]
    ds_read_b128 v[100:103], v11 offset:17408
    v_mfma_f32_16x16x32_bf16 v[192:195], v[88:91], v[64:67], v[192:195]
    ds_read_b128 v[104:107], v11 offset:18432
    v_mfma_f32_16x16x32_bf16 v[208:211], v[92:95], v[64:67], v[208:211]
    ds_read_b128 v[108:111], v11 offset:19456
    v_mfma_f32_16x16x32_bf16 v[164:167], v[80:83], v[68:71], v[164:167]
    ds_read_b128 v[112:115], v13 offset:16384
    v_mfma_f32_16x16x32_bf16 v[180:183], v[84:87], v[68:71], v[180:183]
    ds_read_b128 v[116:119], v13 offset:17408
    v_mfma_f32_16x16x32_bf16 v[196:199], v[88:91], v[68:71], v[196:199]
    ds_read_b128 v[120:123], v13 offset:18432
    v_mfma_f32_16x16x32_bf16 v[212:215], v[92:95], v[68:71], v[212:215]
    ds_read_b128 v[124:127], v13 offset:19456
    v_mfma_f32_16x16x32_bf16 v[168:171], v[80:83], v[72:75], v[168:171]
    v_mfma_f32_16x16x32_bf16 v[184:187], v[84:87], v[72:75], v[184:187]
    v_mfma_f32_16x16x32_bf16 v[200:203], v[88:91], v[72:75], v[200:203]
    v_mfma_f32_16x16x32_bf16 v[216:219], v[92:95], v[72:75], v[216:219]
    v_mfma_f32_16x16x32_bf16 v[172:175], v[80:83], v[76:79], v[172:175]
    v_mfma_f32_16x16x32_bf16 v[188:191], v[84:87], v[76:79], v[188:191]
    v_mfma_f32_16x16x32_bf16 v[204:207], v[88:91], v[76:79], v[204:207]
    v_mfma_f32_16x16x32_bf16 v[220:223], v[92:95], v[76:79], v[220:223]
    s_waitcnt vmcnt(16)
    s_waitcnt lgkmcnt(0)
    s_barrier
    v_mfma_f32_16x16x32_bf16 v[160:163], v[112:115], v[96:99], v[160:163]
    ds_read_b128 v[64:67], v11 offset:32768
    v_mfma_f32_16x16x32_bf16 v[176:179], v[116:119], v[96:99], v[176:179]
    ds_read_b128 v[68:71], v11 offset:33792
    v_mfma_f32_16x16x32_bf16 v[192:195], v[120:123], v[96:99], v[192:195]
    ds_read_b128 v[72:75], v11 offset:34816
    v_mfma_f32_16x16x32_bf16 v[208:211], v[124:127], v[96:99], v[208:211]
    ds_read_b128 v[76:79], v11 offset:35840
    v_mfma_f32_16x16x32_bf16 v[164:167], v[112:115], v[100:103], v[164:167]
    ds_read_b128 v[80:83], v13 offset:32768
    v_mfma_f32_16x16x32_bf16 v[180:183], v[116:119], v[100:103], v[180:183]
    ds_read_b128 v[84:87], v13 offset:33792
    v_mfma_f32_16x16x32_bf16 v[196:199], v[120:123], v[100:103], v[196:199]
    ds_read_b128 v[88:91], v13 offset:34816
    v_mfma_f32_16x16x32_bf16 v[212:215], v[124:127], v[100:103], v[212:215]
    ds_read_b128 v[92:95], v13 offset:35840
    v_mfma_f32_16x16x32_bf16 v[168:171], v[112:115], v[104:107], v[168:171]
    v_mfma_f32_16x16x32_bf16 v[184:187], v[116:119], v[104:107], v[184:187]
    v_mfma_f32_16x16x32_bf16 v[200:203], v[120:123], v[104:107], v[200:203]
    v_mfma_f32_16x16x32_bf16 v[216:219], v[124:127], v[104:107], v[216:219]
    v_mfma_f32_16x16x32_bf16 v[172:175], v[112:115], v[108:111], v[172:175]
    v_mfma_f32_16x16x32_bf16 v[188:191], v[116:119], v[108:111], v[188:191]
    v_mfma_f32_16x16x32_bf16 v[204:207], v[120:123], v[108:111], v[204:207]
    v_mfma_f32_16x16x32_bf16 v[220:223], v[124:127], v[108:111], v[220:223]
    s_waitcnt vmcnt(12)
    s_waitcnt lgkmcnt(0)
    s_barrier
    v_mfma_f32_16x16x32_bf16 v[160:163], v[80:83], v[64:67], v[160:163]
    ds_read_b128 v[96:99], v11 offset:49152
    v_mfma_f32_16x16x32_bf16 v[176:179], v[84:87], v[64:67], v[176:179]
    ds_read_b128 v[100:103], v11 offset:50176
    v_mfma_f32_16x16x32_bf16 v[192:195], v[88:91], v[64:67], v[192:195]
    ds_read_b128 v[104:107], v11 offset:51200
    v_mfma_f32_16x16x32_bf16 v[208:211], v[92:95], v[64:67], v[208:211]
    ds_read_b128 v[108:111], v11 offset:52224
    v_mfma_f32_16x16x32_bf16 v[164:167], v[80:83], v[68:71], v[164:167]
    ds_read_b128 v[112:115], v13 offset:49152
    v_mfma_f32_16x16x32_bf16 v[180:183], v[84:87], v[68:71], v[180:183]
    ds_read_b128 v[116:119], v13 offset:50176
    v_mfma_f32_16x16x32_bf16 v[196:199], v[88:91], v[68:71], v[196:199]
    ds_read_b128 v[120:123], v13 offset:51200
    v_mfma_f32_16x16x32_bf16 v[212:215], v[92:95], v[68:71], v[212:215]
    ds_read_b128 v[124:127], v13 offset:52224
    v_mfma_f32_16x16x32_bf16 v[168:171], v[80:83], v[72:75], v[168:171]
    v_mfma_f32_16x16x32_bf16 v[184:187], v[84:87], v[72:75], v[184:187]
    v_mfma_f32_16x16x32_bf16 v[200:203], v[88:91], v[72:75], v[200:203]
    v_mfma_f32_16x16x32_bf16 v[216:219], v[92:95], v[72:75], v[216:219]
    v_mfma_f32_16x16x32_bf16 v[172:175], v[80:83], v[76:79], v[172:175]
    v_mfma_f32_16x16x32_bf16 v[188:191], v[84:87], v[76:79], v[188:191]
    v_mfma_f32_16x16x32_bf16 v[204:207], v[88:91], v[76:79], v[204:207]
    v_mfma_f32_16x16x32_bf16 v[220:223], v[92:95], v[76:79], v[220:223]
    s_waitcnt vmcnt(8)
    s_waitcnt lgkmcnt(0)
    s_barrier
    v_mfma_f32_16x16x32_bf16 v[160:163], v[112:115], v[96:99], v[160:163]
    ds_read_b128 v[64:67], v10 offset:0
    v_mfma_f32_16x16x32_bf16 v[176:179], v[116:119], v[96:99], v[176:179]
    ds_read_b128 v[68:71], v10 offset:1024
    v_mfma_f32_16x16x32_bf16 v[192:195], v[120:123], v[96:99], v[192:195]
    ds_read_b128 v[72:75], v10 offset:2048
    v_mfma_f32_16x16x32_bf16 v[208:211], v[124:127], v[96:99], v[208:211]
    ds_read_b128 v[76:79], v10 offset:3072
    v_mfma_f32_16x16x32_bf16 v[164:167], v[112:115], v[100:103], v[164:167]
    ds_read_b128 v[80:83], v12 offset:0
    v_mfma_f32_16x16x32_bf16 v[180:183], v[116:119], v[100:103], v[180:183]
    ds_read_b128 v[84:87], v12 offset:1024
    v_mfma_f32_16x16x32_bf16 v[196:199], v[120:123], v[100:103], v[196:199]
    ds_read_b128 v[88:91], v12 offset:2048
    v_mfma_f32_16x16x32_bf16 v[212:215], v[124:127], v[100:103], v[212:215]
    ds_read_b128 v[92:95], v12 offset:3072
    v_mfma_f32_16x16x32_bf16 v[168:171], v[112:115], v[104:107], v[168:171]
    v_mfma_f32_16x16x32_bf16 v[184:187], v[116:119], v[104:107], v[184:187]
    v_mfma_f32_16x16x32_bf16 v[200:203], v[120:123], v[104:107], v[200:203]
    v_mfma_f32_16x16x32_bf16 v[216:219], v[124:127], v[104:107], v[216:219]
    v_mfma_f32_16x16x32_bf16 v[172:175], v[112:115], v[108:111], v[172:175]
    v_mfma_f32_16x16x32_bf16 v[188:191], v[116:119], v[108:111], v[188:191]
    v_mfma_f32_16x16x32_bf16 v[204:207], v[120:123], v[108:111], v[204:207]
    v_mfma_f32_16x16x32_bf16 v[220:223], v[124:127], v[108:111], v[220:223]
    s_waitcnt vmcnt(4)
    s_waitcnt lgkmcnt(0)
    s_barrier
    v_mfma_f32_16x16x32_bf16 v[160:163], v[80:83], v[64:67], v[160:163]
    ds_read_b128 v[96:99], v10 offset:16384
    v_mfma_f32_16x16x32_bf16 v[176:179], v[84:87], v[64:67], v[176:179]
    ds_read_b128 v[100:103], v10 offset:17408
    v_mfma_f32_16x16x32_bf16 v[192:195], v[88:91], v[64:67], v[192:195]
    ds_read_b128 v[104:107], v10 offset:18432
    v_mfma_f32_16x16x32_bf16 v[208:211], v[92:95], v[64:67], v[208:211]
    ds_read_b128 v[108:111], v10 offset:19456
    v_mfma_f32_16x16x32_bf16 v[164:167], v[80:83], v[68:71], v[164:167]
    ds_read_b128 v[112:115], v12 offset:16384
    v_mfma_f32_16x16x32_bf16 v[180:183], v[84:87], v[68:71], v[180:183]
    ds_read_b128 v[116:119], v12 offset:17408
    v_mfma_f32_16x16x32_bf16 v[196:199], v[88:91], v[68:71], v[196:199]
    ds_read_b128 v[120:123], v12 offset:18432
    v_mfma_f32_16x16x32_bf16 v[212:215], v[92:95], v[68:71], v[212:215]
    ds_read_b128 v[124:127], v12 offset:19456
    v_mfma_f32_16x16x32_bf16 v[168:171], v[80:83], v[72:75], v[168:171]
    v_mfma_f32_16x16x32_bf16 v[184:187], v[84:87], v[72:75], v[184:187]
    v_mfma_f32_16x16x32_bf16 v[200:203], v[88:91], v[72:75], v[200:203]
    v_mfma_f32_16x16x32_bf16 v[216:219], v[92:95], v[72:75], v[216:219]
    v_mfma_f32_16x16x32_bf16 v[172:175], v[80:83], v[76:79], v[172:175]
    v_mfma_f32_16x16x32_bf16 v[188:191], v[84:87], v[76:79], v[188:191]
    v_mfma_f32_16x16x32_bf16 v[204:207], v[88:91], v[76:79], v[204:207]
    v_mfma_f32_16x16x32_bf16 v[220:223], v[92:95], v[76:79], v[220:223]
    s_waitcnt vmcnt(0)
    s_waitcnt lgkmcnt(0)
    s_barrier
    v_mfma_f32_16x16x32_bf16 v[160:163], v[112:115], v[96:99], v[160:163]
    ds_read_b128 v[64:67], v10 offset:32768
    v_mfma_f32_16x16x32_bf16 v[176:179], v[116:119], v[96:99], v[176:179]
    ds_read_b128 v[68:71], v10 offset:33792
    v_mfma_f32_16x16x32_bf16 v[192:195], v[120:123], v[96:99], v[192:195]
    ds_read_b128 v[72:75], v10 offset:34816
    v_mfma_f32_16x16x32_bf16 v[208:211], v[124:127], v[96:99], v[208:211]
    ds_read_b128 v[76:79], v10 offset:35840
    v_mfma_f32_16x16x32_bf16 v[164:167], v[112:115], v[100:103], v[164:167]
    ds_read_b128 v[80:83], v12 offset:32768
    v_mfma_f32_16x16x32_bf16 v[180:183], v[116:119], v[100:103], v[180:183]
    ds_read_b128 v[84:87], v12 offset:33792
    v_mfma_f32_16x16x32_bf16 v[196:199], v[120:123], v[100:103], v[196:199]
    ds_read_b128 v[88:91], v12 offset:34816
    v_mfma_f32_16x16x32_bf16 v[212:215], v[124:127], v[100:103], v[212:215]
    ds_read_b128 v[92:95], v12 offset:35840
    v_mfma_f32_16x16x32_bf16 v[168:171], v[112:115], v[104:107], v[168:171]
    v_mfma_f32_16x16x32_bf16 v[184:187], v[116:119], v[104:107], v[184:187]
    v_mfma_f32_16x16x32_bf16 v[200:203], v[120:123], v[104:107], v[200:203]
    v_mfma_f32_16x16x32_bf16 v[216:219], v[124:127], v[104:107], v[216:219]
    v_mfma_f32_16x16x32_bf16 v[172:175], v[112:115], v[108:111], v[172:175]
    v_mfma_f32_16x16x32_bf16 v[188:191], v[116:119], v[108:111], v[188:191]
    v_mfma_f32_16x16x32_bf16 v[204:207], v[120:123], v[108:111], v[204:207]
    v_mfma_f32_16x16x32_bf16 v[220:223], v[124:127], v[108:111], v[220:223]
    s_waitcnt lgkmcnt(0)
    s_barrier
    v_mfma_f32_16x16x32_bf16 v[160:163], v[80:83], v[64:67], v[160:163]
    v_mfma_f32_16x16x32_bf16 v[176:179], v[84:87], v[64:67], v[176:179]
    v_mfma_f32_16x16x32_bf16 v[192:195], v[88:91], v[64:67], v[192:195]
    v_mfma_f32_16x16x32_bf16 v[208:211], v[92:95], v[64:67], v[208:211]
    v_mfma_f32_16x16x32_bf16 v[164:167], v[80:83], v[68:71], v[164:167]
    v_mfma_f32_16x16x32_bf16 v[180:183], v[84:87], v[68:71], v[180:183]
    v_mfma_f32_16x16x32_bf16 v[196:199], v[88:91], v[68:71], v[196:199]
    v_mfma_f32_16x16x32_bf16 v[212:215], v[92:95], v[68:71], v[212:215]
    v_mfma_f32_16x16x32_bf16 v[168:171], v[80:83], v[72:75], v[168:171]
    v_mfma_f32_16x16x32_bf16 v[184:187], v[84:87], v[72:75], v[184:187]
    v_mfma_f32_16x16x32_bf16 v[200:203], v[88:91], v[72:75], v[200:203]
    v_mfma_f32_16x16x32_bf16 v[216:219], v[92:95], v[72:75], v[216:219]
    v_mfma_f32_16x16x32_bf16 v[172:175], v[80:83], v[76:79], v[172:175]
    v_mfma_f32_16x16x32_bf16 v[188:191], v[84:87], v[76:79], v[188:191]
    v_mfma_f32_16x16x32_bf16 v[204:207], v[88:91], v[76:79], v[204:207]
    v_mfma_f32_16x16x32_bf16 v[220:223], v[92:95], v[76:79], v[220:223]
    s_barrier
    s_lshl_b32 s60, s22, 2
    s_add_u32 s60, s60, s21
    s_lshl_b32 s46, s31, 13
    v_add_u32 v14, s46, v2
    s_lshl_b32 s47, s31, 12
    s_lshl_b32 s61, s30, 1
    s_lshl_b32 s62, s60, 2
    s_add_u32 s62, s62, s61
    s_lshl_b32 s62, s62, 2
    s_add_u32 s62, s62, s23
    s_lshl_b32 s62, s62, 13
    s_add_u32 s62, s62, s47
    s_cmp_eq_u32 s61, s23
    s_cbranch_scc1 K3_OWN_33
    v_cvt_pk_bf16_f32 v32, v160, v161
    v_cvt_pk_bf16_f32 v33, v162, v163
    v_cvt_pk_bf16_f32 v34, v176, v177
    v_cvt_pk_bf16_f32 v35, v178, v179
    buffer_store_dwordx4 v[32:35], v2, s[64:67], s62 offen offset:0 sc1
    v_cvt_pk_bf16_f32 v36, v192, v193
    v_cvt_pk_bf16_f32 v37, v194, v195
    v_cvt_pk_bf16_f32 v38, v208, v209
    v_cvt_pk_bf16_f32 v39, v210, v211
    buffer_store_dwordx4 v[36:39], v2, s[64:67], s62 offen offset:1024 sc1
    v_cvt_pk_bf16_f32 v40, v164, v165
    v_cvt_pk_bf16_f32 v41, v166, v167
    v_cvt_pk_bf16_f32 v42, v180, v181
    v_cvt_pk_bf16_f32 v43, v182, v183
    buffer_store_dwordx4 v[40:43], v2, s[64:67], s62 offen offset:2048 sc1
    v_cvt_pk_bf16_f32 v44, v196, v197
    v_cvt_pk_bf16_f32 v45, v198, v199
    v_cvt_pk_bf16_f32 v46, v212, v213
    v_cvt_pk_bf16_f32 v47, v214, v215
    buffer_store_dwordx4 v[44:47], v2, s[64:67], s62 offen offset:3072 sc1
    s_branch K3_PUB_34
K3_OWN_33:
    ds_write_b128 v14, v[160:163] offset:0
    ds_write_b128 v14, v[176:179] offset:1024
    ds_write_b128 v14, v[192:195] offset:2048
    ds_write_b128 v14, v[208:211] offset:3072
    ds_write_b128 v14, v[164:167] offset:4096
    ds_write_b128 v14, v[180:183] offset:5120
    ds_write_b128 v14, v[196:199] offset:6144
    ds_write_b128 v14, v[212:215] offset:7168
K3_PUB_34:
    s_nop 1
    s_lshl_b32 s61, s30, 1
    s_add_u32 s61, s61, 1
    s_lshl_b32 s62, s60, 2
    s_add_u32 s62, s62, s61
    s_lshl_b32 s62, s62, 2
    s_add_u32 s62, s62, s23
    s_lshl_b32 s62, s62, 13
    s_add_u32 s62, s62, s47
    s_cmp_eq_u32 s61, s23
    s_cbranch_scc1 K3_OWN_35
    v_cvt_pk_bf16_f32 v32, v168, v169
    v_cvt_pk_bf16_f32 v33, v170, v171
    v_cvt_pk_bf16_f32 v34, v184, v185
    v_cvt_pk_bf16_f32 v35, v186, v187
    buffer_store_dwordx4 v[32:35], v2, s[64:67], s62 offen offset:0 sc1
    v_cvt_pk_bf16_f32 v36, v200, v201
    v_cvt_pk_bf16_f32 v37, v202, v203
    v_cvt_pk_bf16_f32 v38, v216, v217
    v_cvt_pk_bf16_f32 v39, v218, v219
    buffer_store_dwordx4 v[36:39], v2, s[64:67], s62 offen offset:1024 sc1
    v_cvt_pk_bf16_f32 v40, v172, v173
    v_cvt_pk_bf16_f32 v41, v174, v175
    v_cvt_pk_bf16_f32 v42, v188, v189
    v_cvt_pk_bf16_f32 v43, v190, v191
    buffer_store_dwordx4 v[40:43], v2, s[64:67], s62 offen offset:2048 sc1
    v_cvt_pk_bf16_f32 v44, v204, v205
    v_cvt_pk_bf16_f32 v45, v206, v207
    v_cvt_pk_bf16_f32 v46, v220, v221
    v_cvt_pk_bf16_f32 v47, v222, v223
    buffer_store_dwordx4 v[44:47], v2, s[64:67], s62 offen offset:3072 sc1
    s_branch K3_PUB_36
K3_OWN_35:
    ds_write_b128 v14, v[168:171] offset:0
    ds_write_b128 v14, v[184:187] offset:1024
    ds_write_b128 v14, v[200:203] offset:2048
    ds_write_b128 v14, v[216:219] offset:3072
    ds_write_b128 v14, v[172:175] offset:4096
    ds_write_b128 v14, v[188:191] offset:5120
    ds_write_b128 v14, v[204:207] offset:6144
    ds_write_b128 v14, v[220:223] offset:7168
K3_PUB_36:
    s_nop 1
    s_waitcnt vmcnt(0) lgkmcnt(0)
    s_barrier
    s_lshl_b32 s63, s60, 7
    v_mov_b32 v40, s63
    v_mov_b32 v41, 1
    s_add_u32 s68, s36, 117440512
    s_addc_u32 s69, s37, 0
    s_cmp_lg_u32 s20, 0
    s_cbranch_scc1 K3_PW
    s_mov_b64 exec, 1
    global_atomic_add v40, v41, s[68:69] sc1
    s_mov_b32 s70, 0x80000
K3_PL:
    global_load_dword v42, v40, s[68:69] sc1
    s_sub_u32 s70, s70, 1
    s_cbranch_scc1 K3_PX
    s_waitcnt vmcnt(0)
    v_cmp_gt_u32 vcc, 4, v42
    s_nop 4
    s_cbranch_vccnz K3_PL
K3_PX:
    s_waitcnt vmcnt(0)
    s_mov_b64 exec, -1
K3_PW:
    s_barrier
    s_lshl_b32 s46, s20, 12
    v_add_u32 v14, s46, v2
    ds_read_b128 v[64:67], v14 offset:0
    ds_read_b128 v[68:71], v14 offset:1024
    ds_read_b128 v[72:75], v14 offset:2048
    ds_read_b128 v[76:79], v14 offset:3072
    s_lshl_b32 s47, s20, 11
    s_add_u32 s61, s23, 1
    s_and_b32 s61, s61, 3
    s_lshl_b32 s62, s60, 2
    s_add_u32 s62, s62, s23
    s_lshl_b32 s62, s62, 2
    s_add_u32 s62, s62, s61
    s_lshl_b32 s62, s62, 13
    s_add_u32 s62, s62, s47
    buffer_load_dwordx4 v[96:99], v2, s[64:67], s62 offen offset:0 sc1
    buffer_load_dwordx4 v[100:103], v2, s[64:67], s62 offen offset:1024 sc1
    s_add_u32 s61, s23, 2
    s_and_b32 s61, s61, 3
    s_lshl_b32 s62, s60, 2
    s_add_u32 s62, s62, s23
    s_lshl_b32 s62, s62, 2
    s_add_u32 s62, s62, s61
    s_lshl_b32 s62, s62, 13
    s_add_u32 s62, s62, s47
    buffer_load_dwordx4 v[104:107], v2, s[64:67], s62 offen offset:0 sc1
    buffer_load_dwordx4 v[108:111], v2, s[64:67], s62 offen offset:1024 sc1
    s_add_u32 s61, s23, 3
    s_and_b32 s61, s61, 3
    s_lshl_b32 s62, s60, 2
    s_add_u32 s62, s62, s23
    s_lshl_b32 s62, s62, 2
    s_add_u32 s62, s62, s61
    s_lshl_b32 s62, s62, 13
    s_add_u32 s62, s62, s47
    buffer_load_dwordx4 v[112:115], v2, s[64:67], s62 offen offset:0 sc1
    buffer_load_dwordx4 v[116:119], v2, s[64:67], s62 offen offset:1024 sc1
    v_lshlrev_b32 v128, 16, v24
    v_and_b32 v129, 0xffff0000, v24
    v_lshlrev_b32 v130, 16, v25
    v_and_b32 v131, 0xffff0000, v25
    v_lshlrev_b32 v132, 16, v26
    v_and_b32 v133, 0xffff0000, v26
    v_lshlrev_b32 v134, 16, v27
    v_and_b32 v135, 0xffff0000, v27
    v_lshlrev_b32 v136, 16, v28
    v_and_b32 v137, 0xffff0000, v28
    v_lshlrev_b32 v138, 16, v29
    v_and_b32 v139, 0xffff0000, v29
    v_lshlrev_b32 v140, 16, v30
    v_and_b32 v141, 0xffff0000, v30
    v_lshlrev_b32 v142, 16, v31
    v_and_b32 v143, 0xffff0000, v31
    s_waitcnt lgkmcnt(0)
    v_add_f32 v64, v64, v128
    v_add_f32 v65, v65, v129
    v_add_f32 v66, v66, v130
    v_add_f32 v67, v67, v131
    v_add_f32 v68, v68, v132
    v_add_f32 v69, v69, v133
    v_add_f32 v70, v70, v134
    v_add_f32 v71, v71, v135
    v_add_f32 v72, v72, v136
    v_add_f32 v73, v73, v137
    v_add_f32 v74, v74, v138
    v_add_f32 v75, v75, v139
    v_add_f32 v76, v76, v140
    v_add_f32 v77, v77, v141
    v_add_f32 v78, v78, v142
    v_add_f32 v79, v79, v143
    s_waitcnt vmcnt(0)
    v_lshlrev_b32 v128, 16, v96
    v_and_b32 v129, 0xffff0000, v96
    v_add_f32 v64, v64, v128
    v_add_f32 v65, v65, v129
    v_lshlrev_b32 v128, 16, v97
    v_and_b32 v129, 0xffff0000, v97
    v_add_f32 v66, v66, v128
    v_add_f32 v67, v67, v129
    v_lshlrev_b32 v128, 16, v98
    v_and_b32 v129, 0xffff0000, v98
    v_add_f32 v68, v68, v128
    v_add_f32 v69, v69, v129
    v_lshlrev_b32 v128, 16, v99
    v_and_b32 v129, 0xffff0000, v99
    v_add_f32 v70, v70, v128
    v_add_f32 v71, v71, v129
    v_lshlrev_b32 v128, 16, v100
    v_and_b32 v129, 0xffff0000, v100
    v_add_f32 v72, v72, v128
    v_add_f32 v73, v73, v129
    v_lshlrev_b32 v128, 16, v101
    v_and_b32 v129, 0xffff0000, v101
    v_add_f32 v74, v74, v128
    v_add_f32 v75, v75, v129
    v_lshlrev_b32 v128, 16, v102
    v_and_b32 v129, 0xffff0000, v102
    v_add_f32 v76, v76, v128
    v_add_f32 v77, v77, v129
    v_lshlrev_b32 v128, 16, v103
    v_and_b32 v129, 0xffff0000, v103
    v_add_f32 v78, v78, v128
    v_add_f32 v79, v79, v129
    v_lshlrev_b32 v128, 16, v104
    v_and_b32 v129, 0xffff0000, v104
    v_add_f32 v64, v64, v128
    v_add_f32 v65, v65, v129
    v_lshlrev_b32 v128, 16, v105
    v_and_b32 v129, 0xffff0000, v105
    v_add_f32 v66, v66, v128
    v_add_f32 v67, v67, v129
    v_lshlrev_b32 v128, 16, v106
    v_and_b32 v129, 0xffff0000, v106
    v_add_f32 v68, v68, v128
    v_add_f32 v69, v69, v129
    v_lshlrev_b32 v128, 16, v107
    v_and_b32 v129, 0xffff0000, v107
    v_add_f32 v70, v70, v128
    v_add_f32 v71, v71, v129
    v_lshlrev_b32 v128, 16, v108
    v_and_b32 v129, 0xffff0000, v108
    v_add_f32 v72, v72, v128
    v_add_f32 v73, v73, v129
    v_lshlrev_b32 v128, 16, v109
    v_and_b32 v129, 0xffff0000, v109
    v_add_f32 v74, v74, v128
    v_add_f32 v75, v75, v129
    v_lshlrev_b32 v128, 16, v110
    v_and_b32 v129, 0xffff0000, v110
    v_add_f32 v76, v76, v128
    v_add_f32 v77, v77, v129
    v_lshlrev_b32 v128, 16, v111
    v_and_b32 v129, 0xffff0000, v111
    v_add_f32 v78, v78, v128
    v_add_f32 v79, v79, v129
    v_lshlrev_b32 v128, 16, v112
    v_and_b32 v129, 0xffff0000, v112
    v_add_f32 v64, v64, v128
    v_add_f32 v65, v65, v129
    v_lshlrev_b32 v128, 16, v113
    v_and_b32 v129, 0xffff0000, v113
    v_add_f32 v66, v66, v128
    v_add_f32 v67, v67, v129
    v_lshlrev_b32 v128, 16, v114
    v_and_b32 v129, 0xffff0000, v114
    v_add_f32 v68, v68, v128
    v_add_f32 v69, v69, v129
    v_lshlrev_b32 v128, 16, v115
    v_and_b32 v129, 0xffff0000, v115
    v_add_f32 v70, v70, v128
    v_add_f32 v71, v71, v129
    v_lshlrev_b32 v128, 16, v116
    v_and_b32 v129, 0xffff0000, v116
    v_add_f32 v72, v72, v128
    v_add_f32 v73, v73, v129
    v_lshlrev_b32 v128, 16, v117
    v_and_b32 v129, 0xffff0000, v117
    v_add_f32 v74, v74, v128
    v_add_f32 v75, v75, v129
    v_lshlrev_b32 v128, 16, v118
    v_and_b32 v129, 0xffff0000, v118
    v_add_f32 v76, v76, v128
    v_add_f32 v77, v77, v129
    v_lshlrev_b32 v128, 16, v119
    v_and_b32 v129, 0xffff0000, v119
    v_add_f32 v78, v78, v128
    v_add_f32 v79, v79, v129
    v_cvt_pk_bf16_f32 v144, v64, v65
    v_cvt_pk_bf16_f32 v145, v66, v67
    v_cvt_pk_bf16_f32 v146, v68, v69
    v_cvt_pk_bf16_f32 v147, v70, v71
    v_cvt_pk_bf16_f32 v148, v72, v73
    v_cvt_pk_bf16_f32 v149, v74, v75
    v_cvt_pk_bf16_f32 v150, v76, v77
    v_cvt_pk_bf16_f32 v151, v78, v79
    buffer_store_dwordx2 v[144:145], v21, s[52:55], s56 offen offset:0
    buffer_store_dwordx2 v[146:147], v21, s[52:55], s56 offen offset:32
    buffer_store_dwordx2 v[148:149], v21, s[52:55], s56 offen offset:64
    buffer_store_dwordx2 v[150:151], v21, s[52:55], s56 offen offset:96
    s_endpgm
K2_END:
    s_endpgm
TEXT_END:
    s_endpgm
.section .rodata,"a"
.p2align 6
.amdhsa_kernel ln_kernel
  .amdhsa_next_free_vgpr 64
  .amdhsa_next_free_sgpr 64
  .amdhsa_accum_offset 64
  .amdhsa_group_segment_fixed_size 0
  .amdhsa_kernarg_size 104
  .amdhsa_user_sgpr_count 2
  .amdhsa_user_sgpr_kernarg_segment_ptr 1
  .amdhsa_system_sgpr_workgroup_id_x 1
.end_amdhsa_kernel
.p2align 6
.amdhsa_kernel proj_kernel
  .amdhsa_next_free_vgpr 512
  .amdhsa_next_free_sgpr 102
  .amdhsa_accum_offset 256
  .amdhsa_group_segment_fixed_size 0
  .amdhsa_kernarg_size 104
  .amdhsa_user_sgpr_count 2
  .amdhsa_user_sgpr_kernarg_segment_ptr 1
  .amdhsa_system_sgpr_workgroup_id_x 1
.end_amdhsa_kernel
.p2align 6
.amdhsa_kernel attn_kernel
  .amdhsa_next_free_vgpr 512
  .amdhsa_next_free_sgpr 102
  .amdhsa_accum_offset 256
  .amdhsa_group_segment_fixed_size 0
  .amdhsa_kernarg_size 104
  .amdhsa_user_sgpr_count 2
  .amdhsa_user_sgpr_kernarg_segment_ptr 1
  .amdhsa_system_sgpr_workgroup_id_x 1
.end_amdhsa_kernel
```
